```python
import torch

def _softmax(x, axis=-1):
    return torch.softmax(x, dim=axis)
def _gelu(x):
    return torch.nn.functional.gelu(x, approximate="tanh")
def _silu(x):
    return torch.nn.functional.silu(x)
def _sigmoid(x):
    return torch.sigmoid(x)
def _layernorm(x, axis=-1, eps=1e-5):
    m = x.mean(dim=axis, keepdim=True)
    v = x.var(dim=axis, keepdim=True, unbiased=False)
    return (x - m) / torch.sqrt(v + eps)
def _scatter_add(tgt, idx, src, axis=0):
    return tgt.clone().index_add_(axis, idx, src)
def _segment_sum(src, seg, n):
    out = torch.zeros((n,) + src.shape[1:], dtype=src.dtype)
    return out.index_add_(0, seg, src)
def _pad(x, pw):
    flat = tuple(v for pair in reversed(pw) for v in pair)
    return torch.nn.functional.pad(x, flat)

kernel_name = 'standalone__mha_block_cached__near_ridge'

def setup_inputs():

    _w = (lambda a: (lambda t: t.to(torch.bfloat16) if t.is_floating_point() else t)(torch.as_tensor(a)))
    B, Sq, D = 32, 160, 640
    H, Sk, Dh = 32, 512, 128
    return {
        "x": _w((lambda *s: torch.randn(*s, dtype=torch.bfloat16) * 0.8)(B, Sq, D)),
        "k_cache": _w((lambda *s: torch.randn(*s, dtype=torch.bfloat16) * 0.8)(B, H, Sk, Dh)),
        "v_cache": _w((lambda *s: torch.randn(*s, dtype=torch.bfloat16) * 0.05)(B, H, Sk, Dh)),
        "wq": _w((lambda *s: torch.randn(*s, dtype=torch.bfloat16) * 0.8)(D, H * Dh) * (D ** -0.5)),
        "wo": _w((lambda *s: torch.randn(*s, dtype=torch.bfloat16) * 0.05)(H * Dh, D) * ((H * Dh) ** -0.5)),
    }

def reference(x, k_cache, v_cache, wq, wo):
    B, Sq, D = x.shape
    H, Dh = 32, 128
    q = (lambda x, *d: x.permute(*d))((x @ wq).reshape(B, Sq, H, Dh), 0, 2, 1, 3)
    scores = torch.einsum("bhqd,bhkd->bhqk", q, k_cache) * (Dh ** -0.5)
    p = _softmax(scores, axis=-1)
    o = torch.einsum("bhqk,bhkd->bhqd", p, v_cache)
    return (lambda x, *d: x.permute(*d))(o, 0, 2, 1, 3).reshape(B, Sq, H * Dh) @ wo
```

```asm
; @launch grid=(256,1,1) block=(512,1,1) lds=163840
.amdgcn_target "amdgcn-amd-amdhsa--gfx950"
.text
.globl standalone__mha_block_cached__near_ridge_kernel
.p2align 8
.type standalone__mha_block_cached__near_ridge_kernel,@function
standalone__mha_block_cached__near_ridge_kernel:
KSTART:
    s_cmp_lt_u32 s2, 256
    s_cbranch_scc1 L_go
    s_endpgm
L_go:
    s_load_dwordx16 s[56:71], s[0:1], 0
    v_lshrrev_b32 v1, 6, v0
    s_and_b32 s34, s2, 7
    s_lshl_b32 s34, s34, 2
    v_readfirstlane_b32 s32, v1
    s_lshr_b32 s41, s2, 6
    s_add_u32 s34, s34, s41
    s_bfe_u32 s35, s2, 0x30003
    s_and_b32 s34, s2, 6
    s_lshl_b32 s34, s34, 2
    s_lshr_b32 s41, s2, 5
    s_add_u32 s34, s34, s41
    s_and_b32 s35, s2, 1
    s_lshl_b32 s35, s35, 2
    s_bfe_u32 s41, s2, 0x20003
    s_add_u32 s35, s35, s41
    s_bfe_u32 s41, s32, 0x10001
    s_lshl_b32 s54, s35, 2
    s_add_u32 s54, s54, s41
    s_lshl_b32 s37, s54, 8
    s_cmp_lt_u32 s32, 4
    s_cbranch_scc1 L_w3
    s_and_b32 s42, s32, 1
    s_lshl_b32 s54, s42, 10
    s_lshl_b32 s39, s41, 13
    s_add_u32 s39, s39, s54
    s_mul_i32 s40, s41, 10240
    s_add_u32 s40, s40, s54
    s_mul_i32 s38, s34, 204800
    s_mul_i32 s54, s41, 102400
    s_add_u32 s38, s38, s54
    s_bfe_u32 s3, s2, 0x20003
    s_mul_i32 s3, s3, 5
    s_add_u32 s3, s3, 1
    s_lshr_b32 s3, s3, 1
    s_lshr_b32 s54, s2, 5
    s_add_u32 s3, s3, s54
    s_and_b32 s54, s2, 7
    s_add_u32 s3, s3, s54
    s_sub_u32 s54, s3, 10
    s_cmp_ge_u32 s3, 10
    s_cselect_b32 s3, s54, s3
    s_sub_u32 s54, s3, 10
    s_cmp_ge_u32 s3, 10
    s_cselect_b32 s3, s54, s3
    v_bfe_u32 v172, v0, 3, 4
    v_and_b32 v169, 7, v0
    v_lshrrev_b32 v170, 1, v172
    v_xor_b32 v170, v170, v169
    v_lshlrev_b32 v170, 4, v170
    v_and_b32 v171, 6, v172
    v_xor_b32 v171, v171, v169
    v_lshlrev_b32 v171, 4, v171
    v_and_b32 v169, 12, v172
    v_add_u32 v169, v169, v172
    v_lshl_add_u32 v190, v169, 13, v171
    v_mul_u32_u24 v169, 1280, v172
    v_add_u32 v191, v169, v170
    s_waitcnt lgkmcnt(0)
    s_mov_b32 s16, s62
    s_mov_b32 s17, s63
    s_mov_b32 s18, 5242880
    s_mov_b32 s19, 0x20000
    s_mov_b32 s20, s56
    s_mov_b32 s21, s57
    s_mov_b32 s22, 6553600
    s_mov_b32 s23, 0x20000
    s_cmp_ge_u32 s3, 10
    s_cselect_b32 s87, -10, 0
    s_add_u32 s87, s87, s3
    s_mul_i32 s87, s87, 524288
    s_add_u32 s87, s87, s37
    s_add_u32 m0, s39, 65536
    s_add_u32 s41, s87, 0
    buffer_load_dwordx4 v190, s[16:19], s41 offen lds
    s_add_u32 m0, s39, 67456
    s_add_u32 s41, s87, 0
    buffer_load_dwordx4 v190, s[16:19], s41 offen offset:128 lds
    s_add_u32 m0, s39, 69632
    s_add_u32 s41, s87, 32768
    buffer_load_dwordx4 v190, s[16:19], s41 offen lds
    s_add_u32 m0, s39, 71552
    s_add_u32 s41, s87, 32768
    buffer_load_dwordx4 v190, s[16:19], s41 offen offset:128 lds
    s_cmp_ge_u32 s3, 10
    s_cselect_b32 s87, -10, 0
    s_add_u32 s87, s87, s3
    s_mul_i32 s87, s87, 128
    s_add_u32 s87, s87, s38
    s_add_u32 m0, s40, 98304
    s_add_u32 s41, s87, 0
    buffer_load_dwordx4 v191, s[20:23], s41 offen lds
    s_add_u32 m0, s40, 100352
    s_add_u32 s41, s87, 20480
    buffer_load_dwordx4 v191, s[20:23], s41 offen lds
    s_add_u32 m0, s40, 102400
    s_add_u32 s41, s87, 40960
    buffer_load_dwordx4 v191, s[20:23], s41 offen lds
    s_add_u32 m0, s40, 104448
    s_add_u32 s41, s87, 61440
    buffer_load_dwordx4 v191, s[20:23], s41 offen lds
    s_add_u32 m0, s40, 106496
    s_add_u32 s41, s87, 81920
    buffer_load_dwordx4 v191, s[20:23], s41 offen lds
    s_cmp_ge_u32 s3, 10
    s_cselect_b32 s87, -10, 0
    s_add_u32 s87, s87, s3
    s_mul_i32 s87, s87, 524288
    s_add_u32 s87, s87, s37
    s_add_u32 m0, s39, 81920
    s_add_u32 s41, s87, 262144
    buffer_load_dwordx4 v190, s[16:19], s41 offen lds
    s_add_u32 m0, s39, 83840
    s_add_u32 s41, s87, 262144
    buffer_load_dwordx4 v190, s[16:19], s41 offen offset:128 lds
    s_add_u32 m0, s39, 86016
    s_add_u32 s41, s87, 294912
    buffer_load_dwordx4 v190, s[16:19], s41 offen lds
    s_add_u32 m0, s39, 87936
    s_add_u32 s41, s87, 294912
    buffer_load_dwordx4 v190, s[16:19], s41 offen offset:128 lds
    v_lshl_add_u32 v188, v172, 8, v170
    v_lshl_add_u32 v189, v172, 8, v171
    v_and_b32 v169, 63, v0
    v_lshlrev_b32 v169, 6, v169
    v_bfe_u32 v168, v0, 6, 1
    v_lshl_add_u32 v192, v168, 12, v169
    v_mov_b32 v193, 0
    v_mov_b32 v194, 0
    s_mov_b32 s8, s58
    s_mov_b32 s9, s59
    s_mov_b32 s10, 134217728
    s_mov_b32 s11, 0x20000
    s_mov_b32 s12, s60
    s_mov_b32 s13, s61
    s_mov_b32 s14, 134217728
    s_mov_b32 s15, 0x20000
    s_mov_b32 s28, s64
    s_mov_b32 s29, s65
    s_mov_b32 s30, 5242880
    s_mov_b32 s31, 0x20000
    s_mov_b32 s76, s66
    s_mov_b32 s77, s67
    s_mov_b32 s78, 6553600
    s_mov_b32 s79, 0x20000
    s_mov_b32 s80, s68
    s_mov_b32 s81, s69
    s_mov_b32 s82, 256
    s_mov_b32 s83, 0x20000
    s_mov_b32 s24, s70
    s_mov_b32 s25, s71
    s_mov_b32 s26, 50593792
    s_mov_b32 s27, 0x20000
    s_lshr_b32 s54, s37, 8
    s_lshl_b32 s55, s34, 5
    s_add_u32 s55, s55, s54
    s_lshl_b32 s36, s55, 17
    s_mul_i32 s48, s55, 40960
    s_lshl_b32 s53, s34, 1
    s_lshr_b32 s54, s35, 2
    s_add_u32 s53, s53, s54
    s_lshl_b32 s53, s53, 2
    s_mul_i32 s64, s55, 8
    s_lshr_b32 s54, s55, 2
    s_add_u32 s64, s64, s54
    s_and_b32 s64, s64, 15
    s_lshl_b32 s64, s64, 13
    s_mov_b32 s33, 0
    s_mov_b32 s91, 0
    s_mov_b32 s72, 0x3e0293ee
    s_mov_b32 s73, 0x22d2c1
    s_mov_b32 s74, 32768
    s_mov_b32 s75, 20480
    s_mov_b32 s88, s36
    s_mov_b32 s89, s36
    v_mbcnt_lo_u32_b32 v160, -1, 0
    v_mbcnt_hi_u32_b32 v160, -1, v160
    v_and_b32 v161, 15, v160
    v_lshrrev_b32 v162, 4, v160
    v_lshrrev_b32 v163, 1, v161
    v_xor_b32 v163, v163, v162
    v_lshlrev_b32 v163, 4, v163
    v_lshl_add_u32 v144, v161, 7, v163
    v_xor_b32 v145, 64, v144
    v_lshrrev_b32 v163, 2, v160
    v_and_b32 v164, 6, v163
    v_bfe_u32 v165, v160, 1, 1
    v_xor_b32 v164, v164, v165
    v_lshlrev_b32 v164, 4, v164
    v_lshl_add_u32 v164, v163, 7, v164
    v_and_b32 v165, 1, v160
    v_lshl_add_u32 v146, v165, 3, v164
    v_xor_b32 v147, 32, v146
    v_xor_b32 v148, 64, v146
    v_xor_b32 v149, 96, v146
    s_bfe_u32 s41, s32, 0x10001
    s_lshl_b32 s41, s41, 13
    s_and_b32 s42, s32, 1
    s_mul_i32 s42, s42, 2048
    s_add_u32 s42, s42, 6144
    s_add_u32 s48, s48, s42
    s_lshl_b32 s42, s42, 1
    s_sub_u32 s52, s41, s42
    s_add_u32 s42, s42, 98304
    v_add_u32 v146, s41, v146
    v_add_u32 v147, s41, v147
    v_add_u32 v148, s41, v148
    v_add_u32 v149, s41, v149
    v_add_u32 v144, s42, v144
    v_add_u32 v145, s42, v145
    v_add_u32 v148, 0x8000, v148
    v_add_u32 v149, 0x8000, v149
    v_add_u32 v146, 0x10000, v146
    v_bfe_u32 v140, v146, 3, 2
    v_and_b32 v146, 0xffffffe7, v146
    v_lshlrev_b32 v140, 4, v140
    v_xor_b32 v146, v146, v140
    v_xor_b32 v147, 64, v146
L_w2_round:
    s_setprio 1
    s_cmp_eq_u32 s33, 1
    s_cbranch_scc1 L_rw0
    s_waitcnt vmcnt(4)
L_rw0:
    s_waitcnt vmcnt(8) lgkmcnt(0)
    s_barrier
    ds_read_b128 v[96:99], v144
    ds_read_b128 v[100:103], v144 offset:2048
    ds_read_b64_tr_b16 v[64:65], v146
    ds_read_b64_tr_b16 v[66:67], v146 offset:4096
    ds_read_b64_tr_b16 v[68:69], v146 offset:8
    ds_read_b64_tr_b16 v[70:71], v146 offset:4104
    ds_read_b64_tr_b16 v[72:73], v147
    ds_read_b64_tr_b16 v[74:75], v147 offset:4096
    ds_read_b64_tr_b16 v[76:77], v147 offset:8
    ds_read_b64_tr_b16 v[78:79], v147 offset:4104
    ds_read_b64_tr_b16 v[80:81], v146 offset:2048
    ds_read_b64_tr_b16 v[82:83], v146 offset:6144
    ds_read_b64_tr_b16 v[84:85], v146 offset:2056
    ds_read_b64_tr_b16 v[86:87], v146 offset:6152
    ds_read_b64_tr_b16 v[88:89], v147 offset:2048
    ds_read_b64_tr_b16 v[90:91], v147 offset:6144
    ds_read_b64_tr_b16 v[92:93], v147 offset:2056
    ds_read_b64_tr_b16 v[94:95], v147 offset:6152
    s_cmp_lg_u32 s33, 0
    s_cbranch_scc1 L_r0a
    s_cmp_ge_u32 s3, 9
    s_cselect_b32 s87, -9, 1
    s_add_u32 s87, s87, s3
    s_mul_i32 s87, s87, 524288
    s_add_u32 s87, s87, s37
    s_add_u32 m0, s39, 16384
    s_add_u32 s41, s87, 0
    buffer_load_dwordx4 v190, s[16:19], s41 offen lds
    s_add_u32 m0, s39, 18304
    s_add_u32 s41, s87, 0
    buffer_load_dwordx4 v190, s[16:19], s41 offen offset:128 lds
    s_add_u32 m0, s39, 20480
    s_add_u32 s41, s87, 32768
    buffer_load_dwordx4 v190, s[16:19], s41 offen lds
    s_add_u32 m0, s39, 22400
    s_add_u32 s41, s87, 32768
    buffer_load_dwordx4 v190, s[16:19], s41 offen offset:128 lds
L_r0a:
    s_cmp_ge_u32 s3, 9
    s_cselect_b32 s87, -9, 1
    s_add_u32 s87, s87, s3
    s_mul_i32 s87, s87, 128
    s_add_u32 s87, s87, s38
    s_add_u32 m0, s40, 118784
    s_add_u32 s41, s87, 0
    buffer_load_dwordx4 v191, s[20:23], s41 offen lds
    s_add_u32 m0, s40, 120832
    s_add_u32 s41, s87, 20480
    buffer_load_dwordx4 v191, s[20:23], s41 offen lds
    s_add_u32 m0, s40, 122880
    s_add_u32 s41, s87, 40960
    buffer_load_dwordx4 v191, s[20:23], s41 offen lds
    s_add_u32 m0, s40, 124928
    s_add_u32 s41, s87, 61440
    buffer_load_dwordx4 v191, s[20:23], s41 offen lds
    s_add_u32 m0, s40, 126976
    s_add_u32 s41, s87, 81920
    buffer_load_dwordx4 v191, s[20:23], s41 offen lds
    s_cmp_lg_u32 s33, 0
    s_cbranch_scc1 L_r0b
    s_cmp_ge_u32 s3, 9
    s_cselect_b32 s87, -9, 1
    s_add_u32 s87, s87, s3
    s_mul_i32 s87, s87, 524288
    s_add_u32 s87, s87, s37
    s_add_u32 m0, s39, 49152
    s_add_u32 s41, s87, 262144
    buffer_load_dwordx4 v190, s[16:19], s41 offen lds
    s_add_u32 m0, s39, 51072
    s_add_u32 s41, s87, 262144
    buffer_load_dwordx4 v190, s[16:19], s41 offen offset:128 lds
    s_add_u32 m0, s39, 53248
    s_add_u32 s41, s87, 294912
    buffer_load_dwordx4 v190, s[16:19], s41 offen lds
    s_add_u32 m0, s39, 55168
    s_add_u32 s41, s87, 294912
    buffer_load_dwordx4 v190, s[16:19], s41 offen offset:128 lds
L_r0b:
    v_add_u32 v146, 0x4000, v146
    v_add_u32 v147, 0x4000, v147
    s_waitcnt vmcnt(13) lgkmcnt(0)
    s_barrier
    v_mfma_f32_16x16x32_bf16 v[0:3], v[64:67], v[96:99], 0
    ds_read_b128 v[228:231], v145
    ds_read_b128 v[232:235], v145 offset:2048
    s_cmp_ge_u32 s3, 8
    s_cselect_b32 s87, -8, 2
    s_add_u32 s87, s87, s3
    s_mul_i32 s87, s87, 524288
    s_add_u32 s87, s87, s37
    s_add_u32 m0, s39, 0
    s_add_u32 s41, s87, 0
    buffer_load_dwordx4 v190, s[16:19], s41 offen lds
    v_mfma_f32_16x16x32_bf16 v[4:7], v[64:67], v[100:103], 0
    ds_read_b64_tr_b16 v[196:197], v146
    s_add_u32 m0, s39, 1920
    s_add_u32 s41, s87, 0
    buffer_load_dwordx4 v190, s[16:19], s41 offen offset:128 lds
    v_mfma_f32_16x16x32_bf16 v[8:11], v[68:71], v[96:99], 0
    ds_read_b64_tr_b16 v[198:199], v146 offset:4096
    v_mfma_f32_16x16x32_bf16 v[12:15], v[68:71], v[100:103], 0
    ds_read_b64_tr_b16 v[200:201], v146 offset:8
    s_add_u32 m0, s39, 4096
    s_add_u32 s41, s87, 32768
    buffer_load_dwordx4 v190, s[16:19], s41 offen lds
    v_mfma_f32_16x16x32_bf16 v[16:19], v[72:75], v[96:99], 0
    ds_read_b64_tr_b16 v[202:203], v146 offset:4104
    s_add_u32 m0, s39, 6016
    s_add_u32 s41, s87, 32768
    buffer_load_dwordx4 v190, s[16:19], s41 offen offset:128 lds
    v_mfma_f32_16x16x32_bf16 v[20:23], v[72:75], v[100:103], 0
    ds_read_b64_tr_b16 v[204:205], v147
    ds_read_b64_tr_b16 v[206:207], v147 offset:4096
    v_mfma_f32_16x16x32_bf16 v[24:27], v[76:79], v[96:99], 0
    ds_read_b64_tr_b16 v[208:209], v147 offset:8
    s_cmp_ge_u32 s3, 8
    s_cselect_b32 s87, -8, 2
    s_add_u32 s87, s87, s3
    s_mul_i32 s87, s87, 128
    s_add_u32 s87, s87, s38
    s_add_u32 m0, s40, 139264
    s_add_u32 s41, s87, 0
    buffer_load_dwordx4 v191, s[20:23], s41 offen lds
    v_mfma_f32_16x16x32_bf16 v[28:31], v[76:79], v[100:103], 0
    ds_read_b64_tr_b16 v[210:211], v147 offset:4104
    s_add_u32 m0, s40, 141312
    s_add_u32 s41, s87, 20480
    buffer_load_dwordx4 v191, s[20:23], s41 offen lds
    v_mfma_f32_16x16x32_bf16 v[32:35], v[80:83], v[96:99], 0
    ds_read_b64_tr_b16 v[212:213], v146 offset:2048
    v_mfma_f32_16x16x32_bf16 v[36:39], v[80:83], v[100:103], 0
    ds_read_b64_tr_b16 v[214:215], v146 offset:6144
    s_add_u32 m0, s40, 143360
    s_add_u32 s41, s87, 40960
    buffer_load_dwordx4 v191, s[20:23], s41 offen lds
    v_mfma_f32_16x16x32_bf16 v[40:43], v[84:87], v[96:99], 0
    ds_read_b64_tr_b16 v[216:217], v146 offset:2056
    ds_read_b64_tr_b16 v[218:219], v146 offset:6152
    s_add_u32 m0, s40, 145408
    s_add_u32 s41, s87, 61440
    buffer_load_dwordx4 v191, s[20:23], s41 offen lds
    v_mfma_f32_16x16x32_bf16 v[44:47], v[84:87], v[100:103], 0
    ds_read_b64_tr_b16 v[220:221], v147 offset:2048
    v_mfma_f32_16x16x32_bf16 v[48:51], v[88:91], v[96:99], 0
    ds_read_b64_tr_b16 v[222:223], v147 offset:6144
    s_add_u32 m0, s40, 147456
    s_add_u32 s41, s87, 81920
    buffer_load_dwordx4 v191, s[20:23], s41 offen lds
    v_mfma_f32_16x16x32_bf16 v[52:55], v[88:91], v[100:103], 0
    ds_read_b64_tr_b16 v[224:225], v147 offset:2056
    v_mfma_f32_16x16x32_bf16 v[56:59], v[92:95], v[96:99], 0
    ds_read_b64_tr_b16 v[226:227], v147 offset:6152
    v_mfma_f32_16x16x32_bf16 v[60:63], v[92:95], v[100:103], 0
    v_add_u32 v146, 0xffff0000, v146
    v_add_u32 v147, 0xffff0000, v147
    v_add_u32 v144, 0x5000, v144
    v_add_u32 v145, 0x5000, v145
    s_cmp_eq_u32 s33, 0
    s_cbranch_scc1 L_rw2
    s_waitcnt vmcnt(9)
L_rw2:
    s_waitcnt vmcnt(13) lgkmcnt(0)
    s_barrier
    v_mfma_f32_16x16x32_bf16 v[0:3], v[196:199], v[228:231], v[0:3]
    ds_read_b128 v[96:99], v144
    ds_read_b128 v[100:103], v144 offset:2048
    s_cmp_ge_u32 s3, 8
    s_cselect_b32 s87, -8, 2
    s_add_u32 s87, s87, s3
    s_mul_i32 s87, s87, 524288
    s_add_u32 s87, s87, s37
    s_add_u32 m0, s39, 32768
    s_add_u32 s41, s87, 262144
    buffer_load_dwordx4 v190, s[16:19], s41 offen lds
    v_mfma_f32_16x16x32_bf16 v[4:7], v[196:199], v[232:235], v[4:7]
    ds_read_b64_tr_b16 v[64:65], v146
    s_add_u32 m0, s39, 34688
    s_add_u32 s41, s87, 262144
    buffer_load_dwordx4 v190, s[16:19], s41 offen offset:128 lds
    v_mfma_f32_16x16x32_bf16 v[8:11], v[200:203], v[228:231], v[8:11]
    ds_read_b64_tr_b16 v[66:67], v146 offset:4096
    v_mfma_f32_16x16x32_bf16 v[12:15], v[200:203], v[232:235], v[12:15]
    ds_read_b64_tr_b16 v[68:69], v146 offset:8
    s_add_u32 m0, s39, 36864
    s_add_u32 s41, s87, 294912
    buffer_load_dwordx4 v190, s[16:19], s41 offen lds
    v_mfma_f32_16x16x32_bf16 v[16:19], v[204:207], v[228:231], v[16:19]
    ds_read_b64_tr_b16 v[70:71], v146 offset:4104
    s_add_u32 m0, s39, 38784
    s_add_u32 s41, s87, 294912
    buffer_load_dwordx4 v190, s[16:19], s41 offen offset:128 lds
    v_mfma_f32_16x16x32_bf16 v[20:23], v[204:207], v[232:235], v[20:23]
    ds_read_b64_tr_b16 v[72:73], v147
    ds_read_b64_tr_b16 v[74:75], v147 offset:4096
    v_mfma_f32_16x16x32_bf16 v[24:27], v[208:211], v[228:231], v[24:27]
    ds_read_b64_tr_b16 v[76:77], v147 offset:8
    s_cmp_ge_u32 s3, 7
    s_cselect_b32 s87, -7, 3
    s_add_u32 s87, s87, s3
    s_mul_i32 s87, s87, 128
    s_add_u32 s87, s87, s38
    s_add_u32 m0, s40, 98304
    s_add_u32 s41, s87, 0
    buffer_load_dwordx4 v191, s[20:23], s41 offen lds
    v_mfma_f32_16x16x32_bf16 v[28:31], v[208:211], v[232:235], v[28:31]
    ds_read_b64_tr_b16 v[78:79], v147 offset:4104
    s_add_u32 m0, s40, 100352
    s_add_u32 s41, s87, 20480
    buffer_load_dwordx4 v191, s[20:23], s41 offen lds
    v_mfma_f32_16x16x32_bf16 v[32:35], v[212:215], v[228:231], v[32:35]
    ds_read_b64_tr_b16 v[80:81], v146 offset:2048
    v_mfma_f32_16x16x32_bf16 v[36:39], v[212:215], v[232:235], v[36:39]
    ds_read_b64_tr_b16 v[82:83], v146 offset:6144
    s_add_u32 m0, s40, 102400
    s_add_u32 s41, s87, 40960
    buffer_load_dwordx4 v191, s[20:23], s41 offen lds
    v_mfma_f32_16x16x32_bf16 v[40:43], v[216:219], v[228:231], v[40:43]
    ds_read_b64_tr_b16 v[84:85], v146 offset:2056
    ds_read_b64_tr_b16 v[86:87], v146 offset:6152
    s_add_u32 m0, s40, 104448
    s_add_u32 s41, s87, 61440
    buffer_load_dwordx4 v191, s[20:23], s41 offen lds
    v_mfma_f32_16x16x32_bf16 v[44:47], v[216:219], v[232:235], v[44:47]
    ds_read_b64_tr_b16 v[88:89], v147 offset:2048
    v_mfma_f32_16x16x32_bf16 v[48:51], v[220:223], v[228:231], v[48:51]
    ds_read_b64_tr_b16 v[90:91], v147 offset:6144
    s_add_u32 m0, s40, 106496
    s_add_u32 s41, s87, 81920
    buffer_load_dwordx4 v191, s[20:23], s41 offen lds
    v_mfma_f32_16x16x32_bf16 v[52:55], v[220:223], v[232:235], v[52:55]
    ds_read_b64_tr_b16 v[92:93], v147 offset:2056
    v_mfma_f32_16x16x32_bf16 v[56:59], v[224:227], v[228:231], v[56:59]
    ds_read_b64_tr_b16 v[94:95], v147 offset:6152
    v_mfma_f32_16x16x32_bf16 v[60:63], v[224:227], v[232:235], v[60:63]
    v_add_u32 v146, 0x8000, v146
    v_add_u32 v147, 0x8000, v147
    s_waitcnt vmcnt(18) lgkmcnt(0)
    s_barrier
    v_mfma_f32_16x16x32_bf16 v[0:3], v[64:67], v[96:99], v[0:3]
    ds_read_b128 v[228:231], v145
    ds_read_b128 v[232:235], v145 offset:2048
    s_cmp_ge_u32 s3, 7
    s_cselect_b32 s87, -7, 3
    s_add_u32 s87, s87, s3
    s_mul_i32 s87, s87, 524288
    s_add_u32 s87, s87, s37
    s_add_u32 m0, s39, 65536
    s_add_u32 s41, s87, 0
    buffer_load_dwordx4 v190, s[16:19], s41 offen lds
    v_mfma_f32_16x16x32_bf16 v[4:7], v[64:67], v[100:103], v[4:7]
    ds_read_b64_tr_b16 v[196:197], v146
    s_add_u32 m0, s39, 67456
    s_add_u32 s41, s87, 0
    buffer_load_dwordx4 v190, s[16:19], s41 offen offset:128 lds
    v_mfma_f32_16x16x32_bf16 v[8:11], v[68:71], v[96:99], v[8:11]
    ds_read_b64_tr_b16 v[198:199], v146 offset:4096
    s_add_u32 m0, s39, 69632
    s_add_u32 s41, s87, 32768
    buffer_load_dwordx4 v190, s[16:19], s41 offen lds
    v_mfma_f32_16x16x32_bf16 v[12:15], v[68:71], v[100:103], v[12:15]
    ds_read_b64_tr_b16 v[200:201], v146 offset:8
    s_add_u32 m0, s39, 71552
    s_add_u32 s41, s87, 32768
    buffer_load_dwordx4 v190, s[16:19], s41 offen offset:128 lds
    v_mfma_f32_16x16x32_bf16 v[16:19], v[72:75], v[96:99], v[16:19]
    ds_read_b64_tr_b16 v[202:203], v146 offset:4104
    s_cmp_ge_u32 s3, 7
    s_cselect_b32 s87, -7, 3
    s_add_u32 s87, s87, s3
    s_mul_i32 s87, s87, 524288
    s_add_u32 s87, s87, s37
    s_add_u32 m0, s39, 81920
    s_add_u32 s41, s87, 262144
    buffer_load_dwordx4 v190, s[16:19], s41 offen lds
    v_mfma_f32_16x16x32_bf16 v[20:23], v[72:75], v[100:103], v[20:23]
    ds_read_b64_tr_b16 v[204:205], v147
    ds_read_b64_tr_b16 v[206:207], v147 offset:4096
    s_add_u32 m0, s39, 83840
    s_add_u32 s41, s87, 262144
    buffer_load_dwordx4 v190, s[16:19], s41 offen offset:128 lds
    v_mfma_f32_16x16x32_bf16 v[24:27], v[76:79], v[96:99], v[24:27]
    ds_read_b64_tr_b16 v[208:209], v147 offset:8
    v_mfma_f32_16x16x32_bf16 v[28:31], v[76:79], v[100:103], v[28:31]
    ds_read_b64_tr_b16 v[210:211], v147 offset:4104
    s_add_u32 m0, s39, 86016
    s_add_u32 s41, s87, 294912
    buffer_load_dwordx4 v190, s[16:19], s41 offen lds
    v_mfma_f32_16x16x32_bf16 v[32:35], v[80:83], v[96:99], v[32:35]
    ds_read_b64_tr_b16 v[212:213], v146 offset:2048
    s_add_u32 m0, s39, 87936
    s_add_u32 s41, s87, 294912
    buffer_load_dwordx4 v190, s[16:19], s41 offen offset:128 lds
    v_mfma_f32_16x16x32_bf16 v[36:39], v[80:83], v[100:103], v[36:39]
    ds_read_b64_tr_b16 v[214:215], v146 offset:6144
    s_cmp_ge_u32 s3, 6
    s_cselect_b32 s87, -6, 4
    s_add_u32 s87, s87, s3
    s_mul_i32 s87, s87, 524288
    s_add_u32 s87, s87, s37
    s_add_u32 m0, s39, 16384
    s_add_u32 s41, s87, 0
    buffer_load_dwordx4 v190, s[16:19], s41 offen lds
    v_mfma_f32_16x16x32_bf16 v[40:43], v[84:87], v[96:99], v[40:43]
    ds_read_b64_tr_b16 v[216:217], v146 offset:2056
    ds_read_b64_tr_b16 v[218:219], v146 offset:6152
    s_add_u32 m0, s39, 18304
    s_add_u32 s41, s87, 0
    buffer_load_dwordx4 v190, s[16:19], s41 offen offset:128 lds
    v_mfma_f32_16x16x32_bf16 v[44:47], v[84:87], v[100:103], v[44:47]
    ds_read_b64_tr_b16 v[220:221], v147 offset:2048
    s_add_u32 m0, s39, 20480
    s_add_u32 s41, s87, 32768
    buffer_load_dwordx4 v190, s[16:19], s41 offen lds
    s_lshl_b32 s42, s33, 3
    s_add_u32 s42, s42, s32
    s_cmp_lg_u32 s42, 12
    s_cbranch_scc1 L_nofl1
    s_and_b32 s42, s35, 3
    s_lshl_b32 s42, 1, s42
    v_mov_b32 v186, s42
    v_mov_b32 v187, s53
    s_mov_b64 exec, 1
    buffer_atomic_or v186, v187, s[80:83], 0 offen sc1
    s_mov_b64 exec, -1
L_nofl1:
    v_mfma_f32_16x16x32_bf16 v[48:51], v[88:91], v[96:99], v[48:51]
    ds_read_b64_tr_b16 v[222:223], v147 offset:6144
    s_add_u32 m0, s39, 22400
    s_add_u32 s41, s87, 32768
    buffer_load_dwordx4 v190, s[16:19], s41 offen offset:128 lds
    v_mfma_f32_16x16x32_bf16 v[52:55], v[88:91], v[100:103], v[52:55]
    ds_read_b64_tr_b16 v[224:225], v147 offset:2056
    v_mfma_f32_16x16x32_bf16 v[56:59], v[92:95], v[96:99], v[56:59]
    ds_read_b64_tr_b16 v[226:227], v147 offset:6152
    v_mfma_f32_16x16x32_bf16 v[60:63], v[92:95], v[100:103], v[60:63]
    v_add_u32 v146, 0xffff4000, v146
    v_add_u32 v147, 0xffff4000, v147
    v_add_u32 v144, 0x5000, v144
    v_add_u32 v145, 0x5000, v145
    s_waitcnt vmcnt(21) lgkmcnt(0)
    s_barrier
    v_mfma_f32_16x16x32_bf16 v[0:3], v[196:199], v[228:231], v[0:3]
    ds_read_b128 v[96:99], v144
    ds_read_b128 v[100:103], v144 offset:2048
    s_cmp_ge_u32 s3, 6
    s_cselect_b32 s87, -6, 4
    s_add_u32 s87, s87, s3
    s_mul_i32 s87, s87, 524288
    s_add_u32 s87, s87, s37
    s_add_u32 m0, s39, 49152
    s_add_u32 s41, s87, 262144
    buffer_load_dwordx4 v190, s[16:19], s41 offen lds
    v_mfma_f32_16x16x32_bf16 v[4:7], v[196:199], v[232:235], v[4:7]
    ds_read_b64_tr_b16 v[64:65], v146
    s_add_u32 m0, s39, 51072
    s_add_u32 s41, s87, 262144
    buffer_load_dwordx4 v190, s[16:19], s41 offen offset:128 lds
    v_mfma_f32_16x16x32_bf16 v[8:11], v[200:203], v[228:231], v[8:11]
    ds_read_b64_tr_b16 v[66:67], v146 offset:4096
    v_mfma_f32_16x16x32_bf16 v[12:15], v[200:203], v[232:235], v[12:15]
    ds_read_b64_tr_b16 v[68:69], v146 offset:8
    s_add_u32 m0, s39, 53248
    s_add_u32 s41, s87, 294912
    buffer_load_dwordx4 v190, s[16:19], s41 offen lds
    v_mfma_f32_16x16x32_bf16 v[16:19], v[204:207], v[228:231], v[16:19]
    ds_read_b64_tr_b16 v[70:71], v146 offset:4104
    s_add_u32 m0, s39, 55168
    s_add_u32 s41, s87, 294912
    buffer_load_dwordx4 v190, s[16:19], s41 offen offset:128 lds
    v_mfma_f32_16x16x32_bf16 v[20:23], v[204:207], v[232:235], v[20:23]
    ds_read_b64_tr_b16 v[72:73], v147
    ds_read_b64_tr_b16 v[74:75], v147 offset:4096
    v_mfma_f32_16x16x32_bf16 v[24:27], v[208:211], v[228:231], v[24:27]
    ds_read_b64_tr_b16 v[76:77], v147 offset:8
    s_cmp_ge_u32 s3, 6
    s_cselect_b32 s87, -6, 4
    s_add_u32 s87, s87, s3
    s_mul_i32 s87, s87, 128
    s_add_u32 s87, s87, s38
    s_add_u32 m0, s40, 118784
    s_add_u32 s41, s87, 0
    buffer_load_dwordx4 v191, s[20:23], s41 offen lds
    v_mfma_f32_16x16x32_bf16 v[28:31], v[208:211], v[232:235], v[28:31]
    ds_read_b64_tr_b16 v[78:79], v147 offset:4104
    s_add_u32 m0, s40, 120832
    s_add_u32 s41, s87, 20480
    buffer_load_dwordx4 v191, s[20:23], s41 offen lds
    v_mfma_f32_16x16x32_bf16 v[32:35], v[212:215], v[228:231], v[32:35]
    ds_read_b64_tr_b16 v[80:81], v146 offset:2048
    v_mfma_f32_16x16x32_bf16 v[36:39], v[212:215], v[232:235], v[36:39]
    ds_read_b64_tr_b16 v[82:83], v146 offset:6144
    s_add_u32 m0, s40, 122880
    s_add_u32 s41, s87, 40960
    buffer_load_dwordx4 v191, s[20:23], s41 offen lds
    v_mfma_f32_16x16x32_bf16 v[40:43], v[216:219], v[228:231], v[40:43]
    ds_read_b64_tr_b16 v[84:85], v146 offset:2056
    ds_read_b64_tr_b16 v[86:87], v146 offset:6152
    s_add_u32 m0, s40, 124928
    s_add_u32 s41, s87, 61440
    buffer_load_dwordx4 v191, s[20:23], s41 offen lds
    v_mfma_f32_16x16x32_bf16 v[44:47], v[216:219], v[232:235], v[44:47]
    ds_read_b64_tr_b16 v[88:89], v147 offset:2048
    v_mfma_f32_16x16x32_bf16 v[48:51], v[220:223], v[228:231], v[48:51]
    ds_read_b64_tr_b16 v[90:91], v147 offset:6144
    s_add_u32 m0, s40, 126976
    s_add_u32 s41, s87, 81920
    buffer_load_dwordx4 v191, s[20:23], s41 offen lds
    v_mfma_f32_16x16x32_bf16 v[52:55], v[220:223], v[232:235], v[52:55]
    ds_read_b64_tr_b16 v[92:93], v147 offset:2056
    v_mfma_f32_16x16x32_bf16 v[56:59], v[224:227], v[228:231], v[56:59]
    ds_read_b64_tr_b16 v[94:95], v147 offset:6152
    v_mfma_f32_16x16x32_bf16 v[60:63], v[224:227], v[232:235], v[60:63]
    v_add_u32 v146, 0x8000, v146
    v_add_u32 v147, 0x8000, v147
    s_waitcnt vmcnt(26) lgkmcnt(0)
    s_barrier
    v_mfma_f32_16x16x32_bf16 v[0:3], v[64:67], v[96:99], v[0:3]
    ds_read_b128 v[228:231], v145
    ds_read_b128 v[232:235], v145 offset:2048
    s_cmp_ge_u32 s3, 5
    s_cselect_b32 s87, -5, 5
    s_add_u32 s87, s87, s3
    s_mul_i32 s87, s87, 524288
    s_add_u32 s87, s87, s37
    s_add_u32 m0, s39, 0
    s_add_u32 s41, s87, 0
    buffer_load_dwordx4 v190, s[16:19], s41 offen lds
    v_mfma_f32_16x16x32_bf16 v[4:7], v[64:67], v[100:103], v[4:7]
    ds_read_b64_tr_b16 v[196:197], v146
    v_mfma_f32_16x16x32_bf16 v[8:11], v[68:71], v[96:99], v[8:11]
    ds_read_b64_tr_b16 v[198:199], v146 offset:4096
    v_mfma_f32_16x16x32_bf16 v[12:15], v[68:71], v[100:103], v[12:15]
    ds_read_b64_tr_b16 v[200:201], v146 offset:8
    s_add_u32 m0, s39, 1920
    s_add_u32 s41, s87, 0
    buffer_load_dwordx4 v190, s[16:19], s41 offen offset:128 lds
    v_mfma_f32_16x16x32_bf16 v[16:19], v[72:75], v[96:99], v[16:19]
    ds_read_b64_tr_b16 v[202:203], v146 offset:4104
    v_mfma_f32_16x16x32_bf16 v[20:23], v[72:75], v[100:103], v[20:23]
    ds_read_b64_tr_b16 v[204:205], v147
    ds_read_b64_tr_b16 v[206:207], v147 offset:4096
    v_mfma_f32_16x16x32_bf16 v[24:27], v[76:79], v[96:99], v[24:27]
    ds_read_b64_tr_b16 v[208:209], v147 offset:8
    v_mfma_f32_16x16x32_bf16 v[28:31], v[76:79], v[100:103], v[28:31]
    ds_read_b64_tr_b16 v[210:211], v147 offset:4104
    s_add_u32 m0, s39, 4096
    s_add_u32 s41, s87, 32768
    buffer_load_dwordx4 v190, s[16:19], s41 offen lds
    v_mfma_f32_16x16x32_bf16 v[32:35], v[80:83], v[96:99], v[32:35]
    ds_read_b64_tr_b16 v[212:213], v146 offset:2048
    v_mfma_f32_16x16x32_bf16 v[36:39], v[80:83], v[100:103], v[36:39]
    ds_read_b64_tr_b16 v[214:215], v146 offset:6144
    v_mfma_f32_16x16x32_bf16 v[40:43], v[84:87], v[96:99], v[40:43]
    ds_read_b64_tr_b16 v[216:217], v146 offset:2056
    ds_read_b64_tr_b16 v[218:219], v146 offset:6152
    s_add_u32 m0, s39, 6016
    s_add_u32 s41, s87, 32768
    buffer_load_dwordx4 v190, s[16:19], s41 offen offset:128 lds
    v_mfma_f32_16x16x32_bf16 v[44:47], v[84:87], v[100:103], v[44:47]
    ds_read_b64_tr_b16 v[220:221], v147 offset:2048
    v_mfma_f32_16x16x32_bf16 v[48:51], v[88:91], v[96:99], v[48:51]
    ds_read_b64_tr_b16 v[222:223], v147 offset:6144
    v_mfma_f32_16x16x32_bf16 v[52:55], v[88:91], v[100:103], v[52:55]
    ds_read_b64_tr_b16 v[224:225], v147 offset:2056
    v_mfma_f32_16x16x32_bf16 v[56:59], v[92:95], v[96:99], v[56:59]
    ds_read_b64_tr_b16 v[226:227], v147 offset:6152
    v_mfma_f32_16x16x32_bf16 v[60:63], v[92:95], v[100:103], v[60:63]
    v_add_u32 v146, 0x8000, v146
    v_add_u32 v147, 0x8000, v147
    v_add_u32 v144, 0xffff6000, v144
    v_add_u32 v145, 0xffff6000, v145
    s_waitcnt vmcnt(21) lgkmcnt(0)
    s_barrier
    v_mfma_f32_16x16x32_bf16 v[0:3], v[196:199], v[228:231], v[0:3]
    ds_read_b128 v[96:99], v144
    ds_read_b128 v[100:103], v144 offset:2048
    s_cmp_ge_u32 s3, 5
    s_cselect_b32 s87, -5, 5
    s_add_u32 s87, s87, s3
    s_mul_i32 s87, s87, 524288
    s_add_u32 s87, s87, s37
    s_add_u32 m0, s39, 32768
    s_add_u32 s41, s87, 262144
    buffer_load_dwordx4 v190, s[16:19], s41 offen lds
    v_mfma_f32_16x16x32_bf16 v[4:7], v[196:199], v[232:235], v[4:7]
    ds_read_b64_tr_b16 v[64:65], v146
    s_add_u32 m0, s39, 34688
    s_add_u32 s41, s87, 262144
    buffer_load_dwordx4 v190, s[16:19], s41 offen offset:128 lds
    v_mfma_f32_16x16x32_bf16 v[8:11], v[200:203], v[228:231], v[8:11]
    ds_read_b64_tr_b16 v[66:67], v146 offset:4096
    v_mfma_f32_16x16x32_bf16 v[12:15], v[200:203], v[232:235], v[12:15]
    ds_read_b64_tr_b16 v[68:69], v146 offset:8
    s_add_u32 m0, s39, 36864
    s_add_u32 s41, s87, 294912
    buffer_load_dwordx4 v190, s[16:19], s41 offen lds
    v_mfma_f32_16x16x32_bf16 v[16:19], v[204:207], v[228:231], v[16:19]
    ds_read_b64_tr_b16 v[70:71], v146 offset:4104
    s_add_u32 m0, s39, 38784
    s_add_u32 s41, s87, 294912
    buffer_load_dwordx4 v190, s[16:19], s41 offen offset:128 lds
    v_mfma_f32_16x16x32_bf16 v[20:23], v[204:207], v[232:235], v[20:23]
    ds_read_b64_tr_b16 v[72:73], v147
    ds_read_b64_tr_b16 v[74:75], v147 offset:4096
    v_mfma_f32_16x16x32_bf16 v[24:27], v[208:211], v[228:231], v[24:27]
    ds_read_b64_tr_b16 v[76:77], v147 offset:8
    s_cmp_ge_u32 s3, 5
    s_cselect_b32 s87, -5, 5
    s_add_u32 s87, s87, s3
    s_mul_i32 s87, s87, 128
    s_add_u32 s87, s87, s38
    s_add_u32 m0, s40, 139264
    s_add_u32 s41, s87, 0
    buffer_load_dwordx4 v191, s[20:23], s41 offen lds
    v_mfma_f32_16x16x32_bf16 v[28:31], v[208:211], v[232:235], v[28:31]
    ds_read_b64_tr_b16 v[78:79], v147 offset:4104
    s_add_u32 m0, s40, 141312
    s_add_u32 s41, s87, 20480
    buffer_load_dwordx4 v191, s[20:23], s41 offen lds
    v_mfma_f32_16x16x32_bf16 v[32:35], v[212:215], v[228:231], v[32:35]
    ds_read_b64_tr_b16 v[80:81], v146 offset:2048
    v_mfma_f32_16x16x32_bf16 v[36:39], v[212:215], v[232:235], v[36:39]
    ds_read_b64_tr_b16 v[82:83], v146 offset:6144
    s_add_u32 m0, s40, 143360
    s_add_u32 s41, s87, 40960
    buffer_load_dwordx4 v191, s[20:23], s41 offen lds
    v_mfma_f32_16x16x32_bf16 v[40:43], v[216:219], v[228:231], v[40:43]
    ds_read_b64_tr_b16 v[84:85], v146 offset:2056
    ds_read_b64_tr_b16 v[86:87], v146 offset:6152
    s_add_u32 m0, s40, 145408
    s_add_u32 s41, s87, 61440
    buffer_load_dwordx4 v191, s[20:23], s41 offen lds
    v_mfma_f32_16x16x32_bf16 v[44:47], v[216:219], v[232:235], v[44:47]
    ds_read_b64_tr_b16 v[88:89], v147 offset:2048
    v_mfma_f32_16x16x32_bf16 v[48:51], v[220:223], v[228:231], v[48:51]
    ds_read_b64_tr_b16 v[90:91], v147 offset:6144
    s_add_u32 m0, s40, 147456
    s_add_u32 s41, s87, 81920
    buffer_load_dwordx4 v191, s[20:23], s41 offen lds
    v_mfma_f32_16x16x32_bf16 v[52:55], v[220:223], v[232:235], v[52:55]
    ds_read_b64_tr_b16 v[92:93], v147 offset:2056
    v_mfma_f32_16x16x32_bf16 v[56:59], v[224:227], v[228:231], v[56:59]
    ds_read_b64_tr_b16 v[94:95], v147 offset:6152
    v_mfma_f32_16x16x32_bf16 v[60:63], v[224:227], v[232:235], v[60:63]
    v_add_u32 v146, 0x4000, v146
    v_add_u32 v147, 0x4000, v147
    s_waitcnt vmcnt(26) lgkmcnt(0)
    s_barrier
    v_mfma_f32_16x16x32_bf16 v[0:3], v[64:67], v[96:99], v[0:3]
    ds_read_b128 v[228:231], v145
    ds_read_b128 v[232:235], v145 offset:2048
    s_lshl_b32 s42, s33, 3
    s_add_u32 s42, s42, s32
    s_cmp_lg_u32 s42, 4
    s_cbranch_scc1 L_p0
    s_mov_b32 s42, s53
    v_mov_b32 v187, s42
    buffer_load_dword v194, v187, s[80:83], 0 offen sc1
L_p0:
    v_mfma_f32_16x16x32_bf16 v[4:7], v[64:67], v[100:103], v[4:7]
    ds_read_b64_tr_b16 v[196:197], v146
    v_mfma_f32_16x16x32_bf16 v[8:11], v[68:71], v[96:99], v[8:11]
    ds_read_b64_tr_b16 v[198:199], v146 offset:4096
    s_cmp_ge_u32 s3, 4
    s_cselect_b32 s87, -4, 6
    s_add_u32 s87, s87, s3
    s_mul_i32 s87, s87, 524288
    s_add_u32 s87, s87, s37
    s_add_u32 m0, s39, 65536
    s_add_u32 s41, s87, 0
    buffer_load_dwordx4 v190, s[16:19], s41 offen lds
    v_mfma_f32_16x16x32_bf16 v[12:15], v[68:71], v[100:103], v[12:15]
    ds_read_b64_tr_b16 v[200:201], v146 offset:8
    v_mfma_f32_16x16x32_bf16 v[16:19], v[72:75], v[96:99], v[16:19]
    ds_read_b64_tr_b16 v[202:203], v146 offset:4104
    v_mfma_f32_16x16x32_bf16 v[20:23], v[72:75], v[100:103], v[20:23]
    ds_read_b64_tr_b16 v[204:205], v147
    ds_read_b64_tr_b16 v[206:207], v147 offset:4096
    s_add_u32 m0, s39, 67456
    s_add_u32 s41, s87, 0
    buffer_load_dwordx4 v190, s[16:19], s41 offen offset:128 lds
    v_mfma_f32_16x16x32_bf16 v[24:27], v[76:79], v[96:99], v[24:27]
    ds_read_b64_tr_b16 v[208:209], v147 offset:8
    v_mfma_f32_16x16x32_bf16 v[28:31], v[76:79], v[100:103], v[28:31]
    ds_read_b64_tr_b16 v[210:211], v147 offset:4104
    v_mfma_f32_16x16x32_bf16 v[32:35], v[80:83], v[96:99], v[32:35]
    ds_read_b64_tr_b16 v[212:213], v146 offset:2048
    s_add_u32 m0, s39, 69632
    s_add_u32 s41, s87, 32768
    buffer_load_dwordx4 v190, s[16:19], s41 offen lds
    v_mfma_f32_16x16x32_bf16 v[36:39], v[80:83], v[100:103], v[36:39]
    ds_read_b64_tr_b16 v[214:215], v146 offset:6144
    v_mfma_f32_16x16x32_bf16 v[40:43], v[84:87], v[96:99], v[40:43]
    ds_read_b64_tr_b16 v[216:217], v146 offset:2056
    ds_read_b64_tr_b16 v[218:219], v146 offset:6152
    v_mfma_f32_16x16x32_bf16 v[44:47], v[84:87], v[100:103], v[44:47]
    ds_read_b64_tr_b16 v[220:221], v147 offset:2048
    s_add_u32 m0, s39, 71552
    s_add_u32 s41, s87, 32768
    buffer_load_dwordx4 v190, s[16:19], s41 offen offset:128 lds
    v_mfma_f32_16x16x32_bf16 v[48:51], v[88:91], v[96:99], v[48:51]
    ds_read_b64_tr_b16 v[222:223], v147 offset:6144
    v_mfma_f32_16x16x32_bf16 v[52:55], v[88:91], v[100:103], v[52:55]
    ds_read_b64_tr_b16 v[224:225], v147 offset:2056
    v_mfma_f32_16x16x32_bf16 v[56:59], v[92:95], v[96:99], v[56:59]
    ds_read_b64_tr_b16 v[226:227], v147 offset:6152
    v_mfma_f32_16x16x32_bf16 v[60:63], v[92:95], v[100:103], v[60:63]
    v_add_u32 v146, 0xffff0000, v146
    v_add_u32 v147, 0xffff0000, v147
    v_add_u32 v144, 0x5000, v144
    v_add_u32 v145, 0x5000, v145
    s_waitcnt vmcnt(17) lgkmcnt(0)
    s_barrier
    v_mfma_f32_16x16x32_bf16 v[0:3], v[196:199], v[228:231], v[0:3]
    ds_read_b128 v[96:99], v144
    ds_read_b128 v[100:103], v144 offset:2048
    s_cmp_ge_u32 s3, 4
    s_cselect_b32 s87, -4, 6
    s_add_u32 s87, s87, s3
    s_mul_i32 s87, s87, 524288
    s_add_u32 s87, s87, s37
    s_add_u32 m0, s39, 81920
    s_add_u32 s41, s87, 262144
    buffer_load_dwordx4 v190, s[16:19], s41 offen lds
    v_mfma_f32_16x16x32_bf16 v[4:7], v[196:199], v[232:235], v[4:7]
    ds_read_b64_tr_b16 v[64:65], v146
    s_add_u32 m0, s39, 83840
    s_add_u32 s41, s87, 262144
    buffer_load_dwordx4 v190, s[16:19], s41 offen offset:128 lds
    v_mfma_f32_16x16x32_bf16 v[8:11], v[200:203], v[228:231], v[8:11]
    ds_read_b64_tr_b16 v[66:67], v146 offset:4096
    s_add_u32 m0, s39, 86016
    s_add_u32 s41, s87, 294912
    buffer_load_dwordx4 v190, s[16:19], s41 offen lds
    v_mfma_f32_16x16x32_bf16 v[12:15], v[200:203], v[232:235], v[12:15]
    ds_read_b64_tr_b16 v[68:69], v146 offset:8
    v_mfma_f32_16x16x32_bf16 v[16:19], v[204:207], v[228:231], v[16:19]
    ds_read_b64_tr_b16 v[70:71], v146 offset:4104
    s_add_u32 m0, s39, 87936
    s_add_u32 s41, s87, 294912
    buffer_load_dwordx4 v190, s[16:19], s41 offen offset:128 lds
    v_mfma_f32_16x16x32_bf16 v[20:23], v[204:207], v[232:235], v[20:23]
    ds_read_b64_tr_b16 v[72:73], v147
    ds_read_b64_tr_b16 v[74:75], v147 offset:4096
    s_cmp_ge_u32 s3, 4
    s_cselect_b32 s87, -4, 6
    s_add_u32 s87, s87, s3
    s_mul_i32 s87, s87, 128
    s_add_u32 s87, s87, s38
    s_add_u32 m0, s40, 98304
    s_add_u32 s41, s87, 0
    buffer_load_dwordx4 v191, s[20:23], s41 offen lds
    v_mfma_f32_16x16x32_bf16 v[24:27], v[208:211], v[228:231], v[24:27]
    ds_read_b64_tr_b16 v[76:77], v147 offset:8
    v_mfma_f32_16x16x32_bf16 v[28:31], v[208:211], v[232:235], v[28:31]
    ds_read_b64_tr_b16 v[78:79], v147 offset:4104
    s_add_u32 m0, s40, 100352
    s_add_u32 s41, s87, 20480
    buffer_load_dwordx4 v191, s[20:23], s41 offen lds
    v_mfma_f32_16x16x32_bf16 v[32:35], v[212:215], v[228:231], v[32:35]
    ds_read_b64_tr_b16 v[80:81], v146 offset:2048
    s_add_u32 m0, s40, 102400
    s_add_u32 s41, s87, 40960
    buffer_load_dwordx4 v191, s[20:23], s41 offen lds
    v_mfma_f32_16x16x32_bf16 v[36:39], v[212:215], v[232:235], v[36:39]
    ds_read_b64_tr_b16 v[82:83], v146 offset:6144
    s_add_u32 m0, s40, 104448
    s_add_u32 s41, s87, 61440
    buffer_load_dwordx4 v191, s[20:23], s41 offen lds
    v_mfma_f32_16x16x32_bf16 v[40:43], v[216:219], v[228:231], v[40:43]
    ds_read_b64_tr_b16 v[84:85], v146 offset:2056
    ds_read_b64_tr_b16 v[86:87], v146 offset:6152
    v_mfma_f32_16x16x32_bf16 v[44:47], v[216:219], v[232:235], v[44:47]
    ds_read_b64_tr_b16 v[88:89], v147 offset:2048
    s_add_u32 m0, s40, 106496
    s_add_u32 s41, s87, 81920
    buffer_load_dwordx4 v191, s[20:23], s41 offen lds
    v_mfma_f32_16x16x32_bf16 v[48:51], v[220:223], v[228:231], v[48:51]
    ds_read_b64_tr_b16 v[90:91], v147 offset:6144
    s_cmp_lg_u32 s33, 0
    s_cbranch_scc1 L_p2wo
    v_mbcnt_lo_u32_b32 v186, -1, 0
    v_mbcnt_hi_u32_b32 v186, -1, v186
    v_min_u32 v186, 39, v186
    v_lshlrev_b32 v186, 7, v186
    s_lshl_b32 s42, s2, 2
    s_add_u32 s42, s42, s32
    s_sub_u32 s42, s42, 4
    s_mul_i32 s42, s42, 5120
    buffer_load_dword v255, v186, s[28:31], s42 offen
L_p2wo:
    v_mfma_f32_16x16x32_bf16 v[52:55], v[220:223], v[232:235], v[52:55]
    ds_read_b64_tr_b16 v[92:93], v147 offset:2056
    v_mfma_f32_16x16x32_bf16 v[56:59], v[224:227], v[228:231], v[56:59]
    ds_read_b64_tr_b16 v[94:95], v147 offset:6152
    v_mfma_f32_16x16x32_bf16 v[60:63], v[224:227], v[232:235], v[60:63]
    v_add_u32 v146, 0x8000, v146
    v_add_u32 v147, 0x8000, v147
    s_waitcnt vmcnt(26) lgkmcnt(0)
    s_barrier
    v_mfma_f32_16x16x32_bf16 v[0:3], v[64:67], v[96:99], v[0:3]
    ds_read_b128 v[228:231], v145
    ds_read_b128 v[232:235], v145 offset:2048
    s_cmp_ge_u32 s3, 3
    s_cselect_b32 s87, -3, 7
    s_add_u32 s87, s87, s3
    s_mul_i32 s87, s87, 524288
    s_add_u32 s87, s87, s37
    s_add_u32 m0, s39, 16384
    s_add_u32 s41, s87, 0
    buffer_load_dwordx4 v190, s[16:19], s41 offen lds
    v_mfma_f32_16x16x32_bf16 v[4:7], v[64:67], v[100:103], v[4:7]
    ds_read_b64_tr_b16 v[196:197], v146
    v_mfma_f32_16x16x32_bf16 v[8:11], v[68:71], v[96:99], v[8:11]
    ds_read_b64_tr_b16 v[198:199], v146 offset:4096
    v_mfma_f32_16x16x32_bf16 v[12:15], v[68:71], v[100:103], v[12:15]
    ds_read_b64_tr_b16 v[200:201], v146 offset:8
    s_add_u32 m0, s39, 18304
    s_add_u32 s41, s87, 0
    buffer_load_dwordx4 v190, s[16:19], s41 offen offset:128 lds
    v_mfma_f32_16x16x32_bf16 v[16:19], v[72:75], v[96:99], v[16:19]
    ds_read_b64_tr_b16 v[202:203], v146 offset:4104
    v_mfma_f32_16x16x32_bf16 v[20:23], v[72:75], v[100:103], v[20:23]
    ds_read_b64_tr_b16 v[204:205], v147
    ds_read_b64_tr_b16 v[206:207], v147 offset:4096
    v_mfma_f32_16x16x32_bf16 v[24:27], v[76:79], v[96:99], v[24:27]
    ds_read_b64_tr_b16 v[208:209], v147 offset:8
    v_mfma_f32_16x16x32_bf16 v[28:31], v[76:79], v[100:103], v[28:31]
    ds_read_b64_tr_b16 v[210:211], v147 offset:4104
    s_add_u32 m0, s39, 20480
    s_add_u32 s41, s87, 32768
    buffer_load_dwordx4 v190, s[16:19], s41 offen lds
    v_mfma_f32_16x16x32_bf16 v[32:35], v[80:83], v[96:99], v[32:35]
    ds_read_b64_tr_b16 v[212:213], v146 offset:2048
    v_mfma_f32_16x16x32_bf16 v[36:39], v[80:83], v[100:103], v[36:39]
    ds_read_b64_tr_b16 v[214:215], v146 offset:6144
    v_mfma_f32_16x16x32_bf16 v[40:43], v[84:87], v[96:99], v[40:43]
    ds_read_b64_tr_b16 v[216:217], v146 offset:2056
    ds_read_b64_tr_b16 v[218:219], v146 offset:6152
    s_add_u32 m0, s39, 22400
    s_add_u32 s41, s87, 32768
    buffer_load_dwordx4 v190, s[16:19], s41 offen offset:128 lds
    v_mfma_f32_16x16x32_bf16 v[44:47], v[84:87], v[100:103], v[44:47]
    ds_read_b64_tr_b16 v[220:221], v147 offset:2048
    v_mfma_f32_16x16x32_bf16 v[48:51], v[88:91], v[96:99], v[48:51]
    ds_read_b64_tr_b16 v[222:223], v147 offset:6144
    v_mfma_f32_16x16x32_bf16 v[52:55], v[88:91], v[100:103], v[52:55]
    ds_read_b64_tr_b16 v[224:225], v147 offset:2056
    v_mfma_f32_16x16x32_bf16 v[56:59], v[92:95], v[96:99], v[56:59]
    ds_read_b64_tr_b16 v[226:227], v147 offset:6152
    v_mfma_f32_16x16x32_bf16 v[60:63], v[92:95], v[100:103], v[60:63]
    v_add_u32 v146, 0xffff4000, v146
    v_add_u32 v147, 0xffff4000, v147
    v_add_u32 v144, 0x5000, v144
    v_add_u32 v145, 0x5000, v145
    s_waitcnt vmcnt(17) lgkmcnt(0)
    s_barrier
    v_mfma_f32_16x16x32_bf16 v[0:3], v[196:199], v[228:231], v[0:3]
    ds_read_b128 v[96:99], v144
    ds_read_b128 v[100:103], v144 offset:2048
    s_cmp_ge_u32 s3, 3
    s_cselect_b32 s87, -3, 7
    s_add_u32 s87, s87, s3
    s_mul_i32 s87, s87, 524288
    s_add_u32 s87, s87, s37
    s_add_u32 m0, s39, 49152
    s_add_u32 s41, s87, 262144
    buffer_load_dwordx4 v190, s[16:19], s41 offen lds
    v_mfma_f32_16x16x32_bf16 v[4:7], v[196:199], v[232:235], v[4:7]
    ds_read_b64_tr_b16 v[64:65], v146
    s_add_u32 m0, s39, 51072
    s_add_u32 s41, s87, 262144
    buffer_load_dwordx4 v190, s[16:19], s41 offen offset:128 lds
    v_mfma_f32_16x16x32_bf16 v[8:11], v[200:203], v[228:231], v[8:11]
    ds_read_b64_tr_b16 v[66:67], v146 offset:4096
    v_mfma_f32_16x16x32_bf16 v[12:15], v[200:203], v[232:235], v[12:15]
    ds_read_b64_tr_b16 v[68:69], v146 offset:8
    s_add_u32 m0, s39, 53248
    s_add_u32 s41, s87, 294912
    buffer_load_dwordx4 v190, s[16:19], s41 offen lds
    v_mfma_f32_16x16x32_bf16 v[16:19], v[204:207], v[228:231], v[16:19]
    ds_read_b64_tr_b16 v[70:71], v146 offset:4104
    s_add_u32 m0, s39, 55168
    s_add_u32 s41, s87, 294912
    buffer_load_dwordx4 v190, s[16:19], s41 offen offset:128 lds
    v_mfma_f32_16x16x32_bf16 v[20:23], v[204:207], v[232:235], v[20:23]
    ds_read_b64_tr_b16 v[72:73], v147
    ds_read_b64_tr_b16 v[74:75], v147 offset:4096
    v_mfma_f32_16x16x32_bf16 v[24:27], v[208:211], v[228:231], v[24:27]
    ds_read_b64_tr_b16 v[76:77], v147 offset:8
    s_cmp_ge_u32 s3, 3
    s_cselect_b32 s87, -3, 7
    s_add_u32 s87, s87, s3
    s_mul_i32 s87, s87, 128
    s_add_u32 s87, s87, s38
    s_add_u32 m0, s40, 118784
    s_add_u32 s41, s87, 0
    buffer_load_dwordx4 v191, s[20:23], s41 offen lds
    v_mfma_f32_16x16x32_bf16 v[28:31], v[208:211], v[232:235], v[28:31]
    ds_read_b64_tr_b16 v[78:79], v147 offset:4104
    s_add_u32 m0, s40, 120832
    s_add_u32 s41, s87, 20480
    buffer_load_dwordx4 v191, s[20:23], s41 offen lds
    v_mfma_f32_16x16x32_bf16 v[32:35], v[212:215], v[228:231], v[32:35]
    ds_read_b64_tr_b16 v[80:81], v146 offset:2048
    v_mfma_f32_16x16x32_bf16 v[36:39], v[212:215], v[232:235], v[36:39]
    ds_read_b64_tr_b16 v[82:83], v146 offset:6144
    s_add_u32 m0, s40, 122880
    s_add_u32 s41, s87, 40960
    buffer_load_dwordx4 v191, s[20:23], s41 offen lds
    v_mfma_f32_16x16x32_bf16 v[40:43], v[216:219], v[228:231], v[40:43]
    ds_read_b64_tr_b16 v[84:85], v146 offset:2056
    ds_read_b64_tr_b16 v[86:87], v146 offset:6152
    s_add_u32 m0, s40, 124928
    s_add_u32 s41, s87, 61440
    buffer_load_dwordx4 v191, s[20:23], s41 offen lds
    v_mfma_f32_16x16x32_bf16 v[44:47], v[216:219], v[232:235], v[44:47]
    ds_read_b64_tr_b16 v[88:89], v147 offset:2048
    v_mfma_f32_16x16x32_bf16 v[48:51], v[220:223], v[228:231], v[48:51]
    ds_read_b64_tr_b16 v[90:91], v147 offset:6144
    s_add_u32 m0, s40, 126976
    s_add_u32 s41, s87, 81920
    buffer_load_dwordx4 v191, s[20:23], s41 offen lds
    v_mfma_f32_16x16x32_bf16 v[52:55], v[220:223], v[232:235], v[52:55]
    ds_read_b64_tr_b16 v[92:93], v147 offset:2056
    v_mfma_f32_16x16x32_bf16 v[56:59], v[224:227], v[228:231], v[56:59]
    ds_read_b64_tr_b16 v[94:95], v147 offset:6152
    v_mfma_f32_16x16x32_bf16 v[60:63], v[224:227], v[232:235], v[60:63]
    v_add_u32 v146, 0x8000, v146
    v_add_u32 v147, 0x8000, v147
    s_waitcnt vmcnt(26) lgkmcnt(0)
    s_barrier
    v_mfma_f32_16x16x32_bf16 v[0:3], v[64:67], v[96:99], v[0:3]
    ds_read_b128 v[228:231], v145
    ds_read_b128 v[232:235], v145 offset:2048
    s_cmp_ge_u32 s3, 2
    s_cselect_b32 s87, -2, 8
    s_add_u32 s87, s87, s3
    s_mul_i32 s87, s87, 524288
    s_add_u32 s87, s87, s37
    s_add_u32 m0, s39, 0
    s_add_u32 s41, s87, 0
    buffer_load_dwordx4 v190, s[16:19], s41 offen lds
    v_mfma_f32_16x16x32_bf16 v[4:7], v[64:67], v[100:103], v[4:7]
    ds_read_b64_tr_b16 v[196:197], v146
    v_mfma_f32_16x16x32_bf16 v[8:11], v[68:71], v[96:99], v[8:11]
    ds_read_b64_tr_b16 v[198:199], v146 offset:4096
    v_mfma_f32_16x16x32_bf16 v[12:15], v[68:71], v[100:103], v[12:15]
    ds_read_b64_tr_b16 v[200:201], v146 offset:8
    s_add_u32 m0, s39, 1920
    s_add_u32 s41, s87, 0
    buffer_load_dwordx4 v190, s[16:19], s41 offen offset:128 lds
    v_mfma_f32_16x16x32_bf16 v[16:19], v[72:75], v[96:99], v[16:19]
    ds_read_b64_tr_b16 v[202:203], v146 offset:4104
    v_mfma_f32_16x16x32_bf16 v[20:23], v[72:75], v[100:103], v[20:23]
    ds_read_b64_tr_b16 v[204:205], v147
    ds_read_b64_tr_b16 v[206:207], v147 offset:4096
    v_mfma_f32_16x16x32_bf16 v[24:27], v[76:79], v[96:99], v[24:27]
    ds_read_b64_tr_b16 v[208:209], v147 offset:8
    v_mfma_f32_16x16x32_bf16 v[28:31], v[76:79], v[100:103], v[28:31]
    ds_read_b64_tr_b16 v[210:211], v147 offset:4104
    s_add_u32 m0, s39, 4096
    s_add_u32 s41, s87, 32768
    buffer_load_dwordx4 v190, s[16:19], s41 offen lds
    v_mfma_f32_16x16x32_bf16 v[32:35], v[80:83], v[96:99], v[32:35]
    ds_read_b64_tr_b16 v[212:213], v146 offset:2048
    v_mfma_f32_16x16x32_bf16 v[36:39], v[80:83], v[100:103], v[36:39]
    ds_read_b64_tr_b16 v[214:215], v146 offset:6144
    v_mfma_f32_16x16x32_bf16 v[40:43], v[84:87], v[96:99], v[40:43]
    ds_read_b64_tr_b16 v[216:217], v146 offset:2056
    ds_read_b64_tr_b16 v[218:219], v146 offset:6152
    s_add_u32 m0, s39, 6016
    s_add_u32 s41, s87, 32768
    buffer_load_dwordx4 v190, s[16:19], s41 offen offset:128 lds
    v_mfma_f32_16x16x32_bf16 v[44:47], v[84:87], v[100:103], v[44:47]
    ds_read_b64_tr_b16 v[220:221], v147 offset:2048
    v_mfma_f32_16x16x32_bf16 v[48:51], v[88:91], v[96:99], v[48:51]
    ds_read_b64_tr_b16 v[222:223], v147 offset:6144
    v_mfma_f32_16x16x32_bf16 v[52:55], v[88:91], v[100:103], v[52:55]
    ds_read_b64_tr_b16 v[224:225], v147 offset:2056
    v_mfma_f32_16x16x32_bf16 v[56:59], v[92:95], v[96:99], v[56:59]
    ds_read_b64_tr_b16 v[226:227], v147 offset:6152
    v_mfma_f32_16x16x32_bf16 v[60:63], v[92:95], v[100:103], v[60:63]
    v_add_u32 v146, 0x8000, v146
    v_add_u32 v147, 0x8000, v147
    v_add_u32 v144, 0xffff6000, v144
    v_add_u32 v145, 0xffff6000, v145
    s_waitcnt vmcnt(17) lgkmcnt(0)
    s_barrier
    v_mfma_f32_16x16x32_bf16 v[0:3], v[196:199], v[228:231], v[0:3]
    ds_read_b128 v[96:99], v144
    ds_read_b128 v[100:103], v144 offset:2048
    s_cmp_ge_u32 s3, 2
    s_cselect_b32 s87, -2, 8
    s_add_u32 s87, s87, s3
    s_mul_i32 s87, s87, 524288
    s_add_u32 s87, s87, s37
    s_add_u32 m0, s39, 32768
    s_add_u32 s41, s87, 262144
    buffer_load_dwordx4 v190, s[16:19], s41 offen lds
    v_mfma_f32_16x16x32_bf16 v[4:7], v[196:199], v[232:235], v[4:7]
    ds_read_b64_tr_b16 v[64:65], v146
    s_add_u32 m0, s39, 34688
    s_add_u32 s41, s87, 262144
    buffer_load_dwordx4 v190, s[16:19], s41 offen offset:128 lds
    v_mfma_f32_16x16x32_bf16 v[8:11], v[200:203], v[228:231], v[8:11]
    ds_read_b64_tr_b16 v[66:67], v146 offset:4096
    v_mfma_f32_16x16x32_bf16 v[12:15], v[200:203], v[232:235], v[12:15]
    ds_read_b64_tr_b16 v[68:69], v146 offset:8
    s_add_u32 m0, s39, 36864
    s_add_u32 s41, s87, 294912
    buffer_load_dwordx4 v190, s[16:19], s41 offen lds
    v_mfma_f32_16x16x32_bf16 v[16:19], v[204:207], v[228:231], v[16:19]
    ds_read_b64_tr_b16 v[70:71], v146 offset:4104
    s_add_u32 m0, s39, 38784
    s_add_u32 s41, s87, 294912
    buffer_load_dwordx4 v190, s[16:19], s41 offen offset:128 lds
    v_mfma_f32_16x16x32_bf16 v[20:23], v[204:207], v[232:235], v[20:23]
    ds_read_b64_tr_b16 v[72:73], v147
    ds_read_b64_tr_b16 v[74:75], v147 offset:4096
    v_mfma_f32_16x16x32_bf16 v[24:27], v[208:211], v[228:231], v[24:27]
    ds_read_b64_tr_b16 v[76:77], v147 offset:8
    s_cmp_ge_u32 s3, 2
    s_cselect_b32 s87, -2, 8
    s_add_u32 s87, s87, s3
    s_mul_i32 s87, s87, 128
    s_add_u32 s87, s87, s38
    s_add_u32 m0, s40, 139264
    s_add_u32 s41, s87, 0
    buffer_load_dwordx4 v191, s[20:23], s41 offen lds
    v_mfma_f32_16x16x32_bf16 v[28:31], v[208:211], v[232:235], v[28:31]
    ds_read_b64_tr_b16 v[78:79], v147 offset:4104
    s_add_u32 m0, s40, 141312
    s_add_u32 s41, s87, 20480
    buffer_load_dwordx4 v191, s[20:23], s41 offen lds
    v_mfma_f32_16x16x32_bf16 v[32:35], v[212:215], v[228:231], v[32:35]
    ds_read_b64_tr_b16 v[80:81], v146 offset:2048
    v_mfma_f32_16x16x32_bf16 v[36:39], v[212:215], v[232:235], v[36:39]
    ds_read_b64_tr_b16 v[82:83], v146 offset:6144
    s_add_u32 m0, s40, 143360
    s_add_u32 s41, s87, 40960
    buffer_load_dwordx4 v191, s[20:23], s41 offen lds
    v_mfma_f32_16x16x32_bf16 v[40:43], v[216:219], v[228:231], v[40:43]
    ds_read_b64_tr_b16 v[84:85], v146 offset:2056
    ds_read_b64_tr_b16 v[86:87], v146 offset:6152
    s_add_u32 m0, s40, 145408
    s_add_u32 s41, s87, 61440
    buffer_load_dwordx4 v191, s[20:23], s41 offen lds
    v_mfma_f32_16x16x32_bf16 v[44:47], v[216:219], v[232:235], v[44:47]
    ds_read_b64_tr_b16 v[88:89], v147 offset:2048
    v_mfma_f32_16x16x32_bf16 v[48:51], v[220:223], v[228:231], v[48:51]
    ds_read_b64_tr_b16 v[90:91], v147 offset:6144
    s_add_u32 m0, s40, 147456
    s_add_u32 s41, s87, 81920
    buffer_load_dwordx4 v191, s[20:23], s41 offen lds
    v_mfma_f32_16x16x32_bf16 v[52:55], v[220:223], v[232:235], v[52:55]
    ds_read_b64_tr_b16 v[92:93], v147 offset:2056
    v_mfma_f32_16x16x32_bf16 v[56:59], v[224:227], v[228:231], v[56:59]
    ds_read_b64_tr_b16 v[94:95], v147 offset:6152
    v_mfma_f32_16x16x32_bf16 v[60:63], v[224:227], v[232:235], v[60:63]
    v_add_u32 v146, 0x4000, v146
    v_add_u32 v147, 0x4000, v147
    s_waitcnt vmcnt(26) lgkmcnt(0)
    s_barrier
    v_mfma_f32_16x16x32_bf16 v[0:3], v[64:67], v[96:99], v[0:3]
    ds_read_b128 v[228:231], v145
    ds_read_b128 v[232:235], v145 offset:2048
    s_cmp_ge_u32 s3, 1
    s_cselect_b32 s87, -1, 9
    s_add_u32 s87, s87, s3
    s_mul_i32 s87, s87, 524288
    s_add_u32 s87, s87, s37
    s_add_u32 m0, s39, 65536
    s_add_u32 s41, s87, 0
    buffer_load_dwordx4 v190, s[16:19], s41 offen lds
    v_mfma_f32_16x16x32_bf16 v[4:7], v[64:67], v[100:103], v[4:7]
    ds_read_b64_tr_b16 v[196:197], v146
    v_mfma_f32_16x16x32_bf16 v[8:11], v[68:71], v[96:99], v[8:11]
    ds_read_b64_tr_b16 v[198:199], v146 offset:4096
    v_mfma_f32_16x16x32_bf16 v[12:15], v[68:71], v[100:103], v[12:15]
    ds_read_b64_tr_b16 v[200:201], v146 offset:8
    s_add_u32 m0, s39, 67456
    s_add_u32 s41, s87, 0
    buffer_load_dwordx4 v190, s[16:19], s41 offen offset:128 lds
    v_mfma_f32_16x16x32_bf16 v[16:19], v[72:75], v[96:99], v[16:19]
    ds_read_b64_tr_b16 v[202:203], v146 offset:4104
    v_mfma_f32_16x16x32_bf16 v[20:23], v[72:75], v[100:103], v[20:23]
    ds_read_b64_tr_b16 v[204:205], v147
    ds_read_b64_tr_b16 v[206:207], v147 offset:4096
    v_mfma_f32_16x16x32_bf16 v[24:27], v[76:79], v[96:99], v[24:27]
    ds_read_b64_tr_b16 v[208:209], v147 offset:8
    v_mfma_f32_16x16x32_bf16 v[28:31], v[76:79], v[100:103], v[28:31]
    ds_read_b64_tr_b16 v[210:211], v147 offset:4104
    s_add_u32 m0, s39, 69632
    s_add_u32 s41, s87, 32768
    buffer_load_dwordx4 v190, s[16:19], s41 offen lds
    v_mfma_f32_16x16x32_bf16 v[32:35], v[80:83], v[96:99], v[32:35]
    ds_read_b64_tr_b16 v[212:213], v146 offset:2048
    v_mfma_f32_16x16x32_bf16 v[36:39], v[80:83], v[100:103], v[36:39]
    ds_read_b64_tr_b16 v[214:215], v146 offset:6144
    v_mfma_f32_16x16x32_bf16 v[40:43], v[84:87], v[96:99], v[40:43]
    ds_read_b64_tr_b16 v[216:217], v146 offset:2056
    ds_read_b64_tr_b16 v[218:219], v146 offset:6152
    s_add_u32 m0, s39, 71552
    s_add_u32 s41, s87, 32768
    buffer_load_dwordx4 v190, s[16:19], s41 offen offset:128 lds
    v_mfma_f32_16x16x32_bf16 v[44:47], v[84:87], v[100:103], v[44:47]
    ds_read_b64_tr_b16 v[220:221], v147 offset:2048
    v_mfma_f32_16x16x32_bf16 v[48:51], v[88:91], v[96:99], v[48:51]
    ds_read_b64_tr_b16 v[222:223], v147 offset:6144
    v_mfma_f32_16x16x32_bf16 v[52:55], v[88:91], v[100:103], v[52:55]
    ds_read_b64_tr_b16 v[224:225], v147 offset:2056
    v_mfma_f32_16x16x32_bf16 v[56:59], v[92:95], v[96:99], v[56:59]
    ds_read_b64_tr_b16 v[226:227], v147 offset:6152
    v_mfma_f32_16x16x32_bf16 v[60:63], v[92:95], v[100:103], v[60:63]
    v_add_u32 v146, 0xffff0000, v146
    v_add_u32 v147, 0xffff0000, v147
    v_add_u32 v144, 0x5000, v144
    v_add_u32 v145, 0x5000, v145
    s_waitcnt vmcnt(17) lgkmcnt(0)
    s_barrier
    v_mfma_f32_16x16x32_bf16 v[0:3], v[196:199], v[228:231], v[0:3]
    ds_read_b128 v[96:99], v144
    ds_read_b128 v[100:103], v144 offset:2048
    s_cmp_ge_u32 s3, 1
    s_cselect_b32 s87, -1, 9
    s_add_u32 s87, s87, s3
    s_mul_i32 s87, s87, 524288
    s_add_u32 s87, s87, s37
    s_add_u32 m0, s39, 81920
    s_add_u32 s41, s87, 262144
    buffer_load_dwordx4 v190, s[16:19], s41 offen lds
    v_mfma_f32_16x16x32_bf16 v[4:7], v[196:199], v[232:235], v[4:7]
    ds_read_b64_tr_b16 v[64:65], v146
    s_add_u32 m0, s39, 83840
    s_add_u32 s41, s87, 262144
    buffer_load_dwordx4 v190, s[16:19], s41 offen offset:128 lds
    v_mfma_f32_16x16x32_bf16 v[8:11], v[200:203], v[228:231], v[8:11]
    ds_read_b64_tr_b16 v[66:67], v146 offset:4096
    s_add_u32 m0, s39, 86016
    s_add_u32 s41, s87, 294912
    buffer_load_dwordx4 v190, s[16:19], s41 offen lds
    v_mfma_f32_16x16x32_bf16 v[12:15], v[200:203], v[232:235], v[12:15]
    ds_read_b64_tr_b16 v[68:69], v146 offset:8
    v_mfma_f32_16x16x32_bf16 v[16:19], v[204:207], v[228:231], v[16:19]
    ds_read_b64_tr_b16 v[70:71], v146 offset:4104
    s_add_u32 m0, s39, 87936
    s_add_u32 s41, s87, 294912
    buffer_load_dwordx4 v190, s[16:19], s41 offen offset:128 lds
    v_mfma_f32_16x16x32_bf16 v[20:23], v[204:207], v[232:235], v[20:23]
    ds_read_b64_tr_b16 v[72:73], v147
    ds_read_b64_tr_b16 v[74:75], v147 offset:4096
    s_cmp_ge_u32 s3, 1
    s_cselect_b32 s87, -1, 9
    s_add_u32 s87, s87, s3
    s_mul_i32 s87, s87, 128
    s_add_u32 s87, s87, s38
    s_add_u32 m0, s40, 98304
    s_add_u32 s41, s87, 0
    buffer_load_dwordx4 v191, s[20:23], s41 offen lds
    v_mfma_f32_16x16x32_bf16 v[24:27], v[208:211], v[228:231], v[24:27]
    ds_read_b64_tr_b16 v[76:77], v147 offset:8
    v_mfma_f32_16x16x32_bf16 v[28:31], v[208:211], v[232:235], v[28:31]
    ds_read_b64_tr_b16 v[78:79], v147 offset:4104
    s_add_u32 m0, s40, 100352
    s_add_u32 s41, s87, 20480
    buffer_load_dwordx4 v191, s[20:23], s41 offen lds
    v_mfma_f32_16x16x32_bf16 v[32:35], v[212:215], v[228:231], v[32:35]
    ds_read_b64_tr_b16 v[80:81], v146 offset:2048
    s_add_u32 m0, s40, 102400
    s_add_u32 s41, s87, 40960
    buffer_load_dwordx4 v191, s[20:23], s41 offen lds
    v_mfma_f32_16x16x32_bf16 v[36:39], v[212:215], v[232:235], v[36:39]
    ds_read_b64_tr_b16 v[82:83], v146 offset:6144
    s_add_u32 m0, s40, 104448
    s_add_u32 s41, s87, 61440
    buffer_load_dwordx4 v191, s[20:23], s41 offen lds
    v_mfma_f32_16x16x32_bf16 v[40:43], v[216:219], v[228:231], v[40:43]
    ds_read_b64_tr_b16 v[84:85], v146 offset:2056
    ds_read_b64_tr_b16 v[86:87], v146 offset:6152
    v_mfma_f32_16x16x32_bf16 v[44:47], v[216:219], v[232:235], v[44:47]
    ds_read_b64_tr_b16 v[88:89], v147 offset:2048
    s_add_u32 m0, s40, 106496
    s_add_u32 s41, s87, 81920
    buffer_load_dwordx4 v191, s[20:23], s41 offen lds
    v_mfma_f32_16x16x32_bf16 v[48:51], v[220:223], v[228:231], v[48:51]
    ds_read_b64_tr_b16 v[90:91], v147 offset:6144
    s_lshl_b32 s42, s33, 3
    s_add_u32 s42, s42, s32
    s_cmp_lg_u32 s42, 4
    s_cbranch_scc1 L_m0
    v_readfirstlane_b32 s42, v194
    s_nop 0
    s_bfe_u32 s54, s42, 0x80010
    s_lshr_b32 s42, s42, 24
    s_bcnt1_i32_b32 s42, s42
    s_lshl_b32 s42, s42, 8
    s_or_b32 s42, s42, s54
    s_cmp_eq_u32 s42, 0x1ff
    s_cselect_b32 s42, 1, 0
    v_mov_b32 v186, s42
    v_mov_b32 v187, 163836
    ds_write_b32 v187, v186
L_m0:
    v_mfma_f32_16x16x32_bf16 v[52:55], v[220:223], v[232:235], v[52:55]
    ds_read_b64_tr_b16 v[92:93], v147 offset:2056
    v_mfma_f32_16x16x32_bf16 v[56:59], v[224:227], v[228:231], v[56:59]
    ds_read_b64_tr_b16 v[94:95], v147 offset:6152
    v_mfma_f32_16x16x32_bf16 v[60:63], v[224:227], v[232:235], v[60:63]
    v_add_u32 v146, 0x8000, v146
    v_add_u32 v147, 0x8000, v147
    s_waitcnt vmcnt(26) lgkmcnt(0)
    s_barrier
    v_mfma_f32_16x16x32_bf16 v[0:3], v[64:67], v[96:99], v[0:3]
    ds_read_b128 v[228:231], v145
    ds_read_b128 v[232:235], v145 offset:2048
    s_add_u32 s87, s64, 8192
    s_and_b32 s87, s87, 0x1ffff
    s_add_u32 s87, s87, s36
    s_add_u32 m0, s39, 16384
    s_add_u32 s41, s87, 0
    s_waitcnt vmcnt(4)
    buffer_load_dwordx4 v188, s[8:11], s41 offen nt lds
    v_mfma_f32_16x16x32_bf16 v[4:7], v[64:67], v[100:103], v[4:7]
    ds_read_b64_tr_b16 v[196:197], v146
    v_mfma_f32_16x16x32_bf16 v[8:11], v[68:71], v[96:99], v[8:11]
    ds_read_b64_tr_b16 v[198:199], v146 offset:4096
    v_mfma_f32_16x16x32_bf16 v[12:15], v[68:71], v[100:103], v[12:15]
    ds_read_b64_tr_b16 v[200:201], v146 offset:8
    s_add_u32 m0, s39, 18304
    s_add_u32 s41, s87, 0
    s_waitcnt vmcnt(4)
    buffer_load_dwordx4 v188, s[8:11], s41 offen offset:128 nt lds
    v_mfma_f32_16x16x32_bf16 v[16:19], v[72:75], v[96:99], v[16:19]
    ds_read_b64_tr_b16 v[202:203], v146 offset:4104
    v_mfma_f32_16x16x32_bf16 v[20:23], v[72:75], v[100:103], v[20:23]
    ds_read_b64_tr_b16 v[204:205], v147
    ds_read_b64_tr_b16 v[206:207], v147 offset:4096
    v_mfma_f32_16x16x32_bf16 v[24:27], v[76:79], v[96:99], v[24:27]
    ds_read_b64_tr_b16 v[208:209], v147 offset:8
    v_mfma_f32_16x16x32_bf16 v[28:31], v[76:79], v[100:103], v[28:31]
    ds_read_b64_tr_b16 v[210:211], v147 offset:4104
    s_add_u32 m0, s39, 20480
    s_add_u32 s41, s87, 4096
    s_waitcnt vmcnt(4)
    buffer_load_dwordx4 v188, s[8:11], s41 offen nt lds
    v_mfma_f32_16x16x32_bf16 v[32:35], v[80:83], v[96:99], v[32:35]
    ds_read_b64_tr_b16 v[212:213], v146 offset:2048
    v_mfma_f32_16x16x32_bf16 v[36:39], v[80:83], v[100:103], v[36:39]
    ds_read_b64_tr_b16 v[214:215], v146 offset:6144
    v_mfma_f32_16x16x32_bf16 v[40:43], v[84:87], v[96:99], v[40:43]
    ds_read_b64_tr_b16 v[216:217], v146 offset:2056
    ds_read_b64_tr_b16 v[218:219], v146 offset:6152
    s_add_u32 m0, s39, 22400
    s_add_u32 s41, s87, 4096
    s_waitcnt vmcnt(4)
    buffer_load_dwordx4 v188, s[8:11], s41 offen offset:128 nt lds
    v_mfma_f32_16x16x32_bf16 v[44:47], v[84:87], v[100:103], v[44:47]
    ds_read_b64_tr_b16 v[220:221], v147 offset:2048
    v_mfma_f32_16x16x32_bf16 v[48:51], v[88:91], v[96:99], v[48:51]
    ds_read_b64_tr_b16 v[222:223], v147 offset:6144
    v_mfma_f32_16x16x32_bf16 v[52:55], v[88:91], v[100:103], v[52:55]
    ds_read_b64_tr_b16 v[224:225], v147 offset:2056
    v_mfma_f32_16x16x32_bf16 v[56:59], v[92:95], v[96:99], v[56:59]
    ds_read_b64_tr_b16 v[226:227], v147 offset:6152
    v_mfma_f32_16x16x32_bf16 v[60:63], v[92:95], v[100:103], v[60:63]
    v_add_u32 v146, 0xffff4000, v146
    v_add_u32 v147, 0xffff4000, v147
    v_add_u32 v144, 0x5000, v144
    v_add_u32 v145, 0x5000, v145
    s_waitcnt vmcnt(17) lgkmcnt(0)
    s_barrier
    v_mfma_f32_16x16x32_bf16 v[0:3], v[196:199], v[228:231], v[0:3]
    ds_read_b128 v[96:99], v144
    ds_read_b128 v[100:103], v144 offset:2048
    s_add_u32 s87, s64, 16384
    s_and_b32 s87, s87, 0x1ffff
    s_add_u32 s87, s87, s36
    s_add_u32 m0, s39, 49152
    s_add_u32 s41, s87, 0
    s_waitcnt vmcnt(4)
    buffer_load_dwordx4 v188, s[8:11], s41 offen nt lds
    v_mfma_f32_16x16x32_bf16 v[4:7], v[196:199], v[232:235], v[4:7]
    ds_read_b64_tr_b16 v[64:65], v146
    v_mfma_f32_16x16x32_bf16 v[8:11], v[200:203], v[228:231], v[8:11]
    ds_read_b64_tr_b16 v[66:67], v146 offset:4096
    v_mfma_f32_16x16x32_bf16 v[12:15], v[200:203], v[232:235], v[12:15]
    ds_read_b64_tr_b16 v[68:69], v146 offset:8
    s_add_u32 m0, s39, 51072
    s_add_u32 s41, s87, 0
    s_waitcnt vmcnt(4)
    buffer_load_dwordx4 v188, s[8:11], s41 offen offset:128 nt lds
    v_mfma_f32_16x16x32_bf16 v[16:19], v[204:207], v[228:231], v[16:19]
    ds_read_b64_tr_b16 v[70:71], v146 offset:4104
    v_mfma_f32_16x16x32_bf16 v[20:23], v[204:207], v[232:235], v[20:23]
    ds_read_b64_tr_b16 v[72:73], v147
    ds_read_b64_tr_b16 v[74:75], v147 offset:4096
    v_mfma_f32_16x16x32_bf16 v[24:27], v[208:211], v[228:231], v[24:27]
    ds_read_b64_tr_b16 v[76:77], v147 offset:8
    v_mfma_f32_16x16x32_bf16 v[28:31], v[208:211], v[232:235], v[28:31]
    ds_read_b64_tr_b16 v[78:79], v147 offset:4104
    s_add_u32 m0, s39, 53248
    s_add_u32 s41, s87, 4096
    s_waitcnt vmcnt(4)
    buffer_load_dwordx4 v188, s[8:11], s41 offen nt lds
    v_mfma_f32_16x16x32_bf16 v[32:35], v[212:215], v[228:231], v[32:35]
    ds_read_b64_tr_b16 v[80:81], v146 offset:2048
    v_mfma_f32_16x16x32_bf16 v[36:39], v[212:215], v[232:235], v[36:39]
    ds_read_b64_tr_b16 v[82:83], v146 offset:6144
    v_mfma_f32_16x16x32_bf16 v[40:43], v[216:219], v[228:231], v[40:43]
    ds_read_b64_tr_b16 v[84:85], v146 offset:2056
    ds_read_b64_tr_b16 v[86:87], v146 offset:6152
    s_add_u32 m0, s39, 55168
    s_add_u32 s41, s87, 4096
    s_waitcnt vmcnt(4)
    buffer_load_dwordx4 v188, s[8:11], s41 offen offset:128 nt lds
    v_mfma_f32_16x16x32_bf16 v[44:47], v[216:219], v[232:235], v[44:47]
    ds_read_b64_tr_b16 v[88:89], v147 offset:2048
    v_mfma_f32_16x16x32_bf16 v[48:51], v[220:223], v[228:231], v[48:51]
    ds_read_b64_tr_b16 v[90:91], v147 offset:6144
    v_mfma_f32_16x16x32_bf16 v[52:55], v[220:223], v[232:235], v[52:55]
    ds_read_b64_tr_b16 v[92:93], v147 offset:2056
    v_mfma_f32_16x16x32_bf16 v[56:59], v[224:227], v[228:231], v[56:59]
    ds_read_b64_tr_b16 v[94:95], v147 offset:6152
    v_mfma_f32_16x16x32_bf16 v[60:63], v[224:227], v[232:235], v[60:63]
    v_add_u32 v146, 0x8000, v146
    v_add_u32 v147, 0x8000, v147
    s_waitcnt vmcnt(21) lgkmcnt(0)
    s_barrier
    v_mfma_f32_16x16x32_bf16 v[0:3], v[64:67], v[96:99], v[0:3]
    ds_read_b128 v[228:231], v145
    ds_read_b128 v[232:235], v145 offset:2048
    v_mov_b32 v140, 163836
    ds_read_b32 v140, v140
    v_mfma_f32_16x16x32_bf16 v[4:7], v[64:67], v[100:103], v[4:7]
    ds_read_b64_tr_b16 v[196:197], v146
    v_mfma_f32_16x16x32_bf16 v[8:11], v[68:71], v[96:99], v[8:11]
    ds_read_b64_tr_b16 v[198:199], v146 offset:4096
    s_add_u32 s87, s64, 0
    s_and_b32 s87, s87, 0x1ffff
    s_add_u32 s87, s87, s36
    s_add_u32 m0, s39, 0
    s_add_u32 s41, s87, 0
    s_waitcnt vmcnt(4)
    buffer_load_dwordx4 v188, s[8:11], s41 offen nt lds
    v_mfma_f32_16x16x32_bf16 v[12:15], v[68:71], v[100:103], v[12:15]
    ds_read_b64_tr_b16 v[200:201], v146 offset:8
    v_mfma_f32_16x16x32_bf16 v[16:19], v[72:75], v[96:99], v[16:19]
    ds_read_b64_tr_b16 v[202:203], v146 offset:4104
    v_mfma_f32_16x16x32_bf16 v[20:23], v[72:75], v[100:103], v[20:23]
    ds_read_b64_tr_b16 v[204:205], v147
    ds_read_b64_tr_b16 v[206:207], v147 offset:4096
    s_add_u32 m0, s39, 1920
    s_add_u32 s41, s87, 0
    s_waitcnt vmcnt(4)
    buffer_load_dwordx4 v188, s[8:11], s41 offen offset:128 nt lds
    v_mfma_f32_16x16x32_bf16 v[24:27], v[76:79], v[96:99], v[24:27]
    ds_read_b64_tr_b16 v[208:209], v147 offset:8
    v_mfma_f32_16x16x32_bf16 v[28:31], v[76:79], v[100:103], v[28:31]
    ds_read_b64_tr_b16 v[210:211], v147 offset:4104
    v_mfma_f32_16x16x32_bf16 v[32:35], v[80:83], v[96:99], v[32:35]
    ds_read_b64_tr_b16 v[212:213], v146 offset:2048
    s_add_u32 m0, s39, 4096
    s_add_u32 s41, s87, 4096
    s_waitcnt vmcnt(4)
    buffer_load_dwordx4 v188, s[8:11], s41 offen nt lds
    v_mfma_f32_16x16x32_bf16 v[36:39], v[80:83], v[100:103], v[36:39]
    ds_read_b64_tr_b16 v[214:215], v146 offset:6144
    v_mfma_f32_16x16x32_bf16 v[40:43], v[84:87], v[96:99], v[40:43]
    ds_read_b64_tr_b16 v[216:217], v146 offset:2056
    ds_read_b64_tr_b16 v[218:219], v146 offset:6152
    v_mfma_f32_16x16x32_bf16 v[44:47], v[84:87], v[100:103], v[44:47]
    ds_read_b64_tr_b16 v[220:221], v147 offset:2048
    s_add_u32 m0, s39, 6016
    s_add_u32 s41, s87, 4096
    s_waitcnt vmcnt(4)
    buffer_load_dwordx4 v188, s[8:11], s41 offen offset:128 nt lds
    v_mfma_f32_16x16x32_bf16 v[48:51], v[88:91], v[96:99], v[48:51]
    ds_read_b64_tr_b16 v[222:223], v147 offset:6144
    v_mfma_f32_16x16x32_bf16 v[52:55], v[88:91], v[100:103], v[52:55]
    ds_read_b64_tr_b16 v[224:225], v147 offset:2056
    v_mfma_f32_16x16x32_bf16 v[56:59], v[92:95], v[96:99], v[56:59]
    ds_read_b64_tr_b16 v[226:227], v147 offset:6152
    v_mfma_f32_16x16x32_bf16 v[60:63], v[92:95], v[100:103], v[60:63]
    v_add_u32 v146, 0x8000, v146
    v_add_u32 v147, 0x8000, v147
    v_add_u32 v144, 0xffff6000, v144
    v_add_u32 v145, 0xffff6000, v145
    s_waitcnt vmcnt(12) lgkmcnt(0)
    s_barrier
    v_mfma_f32_16x16x32_bf16 v[0:3], v[196:199], v[228:231], v[0:3]
    ds_read_b128 v[96:99], v144
    ds_read_b128 v[100:103], v144 offset:2048
    v_readfirstlane_b32 s42, v140
    s_cmp_eq_u32 s33, 0
    s_cselect_b32 s91, s42, s91
    v_mfma_f32_16x16x32_bf16 v[4:7], v[196:199], v[232:235], v[4:7]
    ds_read_b64_tr_b16 v[64:65], v146
    s_add_u32 s87, s64, 0
    s_and_b32 s87, s87, 0x1ffff
    s_add_u32 s87, s87, s36
    s_add_u32 m0, s39, 32768
    s_add_u32 s41, s87, 0
    s_waitcnt vmcnt(4)
    buffer_load_dwordx4 v189, s[12:15], s41 offen nt lds
    v_mfma_f32_16x16x32_bf16 v[8:11], v[200:203], v[228:231], v[8:11]
    ds_read_b64_tr_b16 v[66:67], v146 offset:4096
    v_mfma_f32_16x16x32_bf16 v[12:15], v[200:203], v[232:235], v[12:15]
    ds_read_b64_tr_b16 v[68:69], v146 offset:8
    s_add_u32 m0, s39, 34688
    s_add_u32 s41, s87, 0
    s_waitcnt vmcnt(4)
    buffer_load_dwordx4 v189, s[12:15], s41 offen offset:128 nt lds
    v_mfma_f32_16x16x32_bf16 v[16:19], v[204:207], v[228:231], v[16:19]
    ds_read_b64_tr_b16 v[70:71], v146 offset:4104
    s_add_u32 m0, s39, 36864
    s_add_u32 s41, s87, 4096
    s_waitcnt vmcnt(4)
    buffer_load_dwordx4 v189, s[12:15], s41 offen nt lds
    v_mfma_f32_16x16x32_bf16 v[20:23], v[204:207], v[232:235], v[20:23]
    ds_read_b64_tr_b16 v[72:73], v147
    ds_read_b64_tr_b16 v[74:75], v147 offset:4096
    v_mfma_f32_16x16x32_bf16 v[24:27], v[208:211], v[228:231], v[24:27]
    ds_read_b64_tr_b16 v[76:77], v147 offset:8
    s_add_u32 m0, s39, 38784
    s_add_u32 s41, s87, 4096
    s_waitcnt vmcnt(4)
    buffer_load_dwordx4 v189, s[12:15], s41 offen offset:128 nt lds
    v_mfma_f32_16x16x32_bf16 v[28:31], v[208:211], v[232:235], v[28:31]
    ds_read_b64_tr_b16 v[78:79], v147 offset:4104
    s_add_u32 s87, s64, 24576
    s_and_b32 s87, s87, 0x1ffff
    s_add_u32 s87, s87, s36
    s_add_u32 m0, s39, 131072
    s_add_u32 s41, s87, 0
    s_waitcnt vmcnt(4)
    buffer_load_dwordx4 v189, s[12:15], s41 offen nt lds
    v_mfma_f32_16x16x32_bf16 v[32:35], v[212:215], v[228:231], v[32:35]
    ds_read_b64_tr_b16 v[80:81], v146 offset:2048
    v_mfma_f32_16x16x32_bf16 v[36:39], v[212:215], v[232:235], v[36:39]
    ds_read_b64_tr_b16 v[82:83], v146 offset:6144
    s_add_u32 m0, s39, 132992
    s_add_u32 s41, s87, 0
    s_waitcnt vmcnt(4)
    buffer_load_dwordx4 v189, s[12:15], s41 offen offset:128 nt lds
    v_mfma_f32_16x16x32_bf16 v[40:43], v[216:219], v[228:231], v[40:43]
    ds_read_b64_tr_b16 v[84:85], v146 offset:2056
    ds_read_b64_tr_b16 v[86:87], v146 offset:6152
    s_add_u32 m0, s39, 135168
    s_add_u32 s41, s87, 4096
    s_waitcnt vmcnt(4)
    buffer_load_dwordx4 v189, s[12:15], s41 offen nt lds
    v_mfma_f32_16x16x32_bf16 v[44:47], v[216:219], v[232:235], v[44:47]
    ds_read_b64_tr_b16 v[88:89], v147 offset:2048
    v_mfma_f32_16x16x32_bf16 v[48:51], v[220:223], v[228:231], v[48:51]
    ds_read_b64_tr_b16 v[90:91], v147 offset:6144
    s_add_u32 m0, s39, 137088
    s_add_u32 s41, s87, 4096
    s_waitcnt vmcnt(4)
    buffer_load_dwordx4 v189, s[12:15], s41 offen offset:128 nt lds
    v_mfma_f32_16x16x32_bf16 v[52:55], v[220:223], v[232:235], v[52:55]
    ds_read_b64_tr_b16 v[92:93], v147 offset:2056
    v_mfma_f32_16x16x32_bf16 v[56:59], v[224:227], v[228:231], v[56:59]
    ds_read_b64_tr_b16 v[94:95], v147 offset:6152
    v_mfma_f32_16x16x32_bf16 v[60:63], v[224:227], v[232:235], v[60:63]
    v_add_u32 v146, 0x4000, v146
    v_add_u32 v147, 0x4000, v147
    s_waitcnt vmcnt(20) lgkmcnt(0)
    s_barrier
    v_mfma_f32_16x16x32_bf16 v[0:3], v[64:67], v[96:99], v[0:3]
    ds_read_b128 v[228:231], v145
    ds_read_b128 v[232:235], v145 offset:2048
    s_add_u32 s87, s64, 8192
    s_and_b32 s87, s87, 0x1ffff
    s_add_u32 s87, s87, s36
    s_add_u32 m0, s39, 65536
    s_add_u32 s41, s87, 0
    s_waitcnt vmcnt(4)
    buffer_load_dwordx4 v189, s[12:15], s41 offen nt lds
    v_mfma_f32_16x16x32_bf16 v[4:7], v[64:67], v[100:103], v[4:7]
    ds_read_b64_tr_b16 v[196:197], v146
    s_add_u32 m0, s39, 67456
    s_add_u32 s41, s87, 0
    s_waitcnt vmcnt(4)
    buffer_load_dwordx4 v189, s[12:15], s41 offen offset:128 nt lds
    v_mfma_f32_16x16x32_bf16 v[8:11], v[68:71], v[96:99], v[8:11]
    ds_read_b64_tr_b16 v[198:199], v146 offset:4096
    v_mfma_f32_16x16x32_bf16 v[12:15], v[68:71], v[100:103], v[12:15]
    ds_read_b64_tr_b16 v[200:201], v146 offset:8
    s_add_u32 m0, s39, 69632
    s_add_u32 s41, s87, 4096
    s_waitcnt vmcnt(4)
    buffer_load_dwordx4 v189, s[12:15], s41 offen nt lds
    v_mfma_f32_16x16x32_bf16 v[16:19], v[72:75], v[96:99], v[16:19]
    ds_read_b64_tr_b16 v[202:203], v146 offset:4104
    v_mfma_f32_16x16x32_bf16 v[20:23], v[72:75], v[100:103], v[20:23]
    ds_read_b64_tr_b16 v[204:205], v147
    ds_read_b64_tr_b16 v[206:207], v147 offset:4096
    s_add_u32 m0, s39, 71552
    s_add_u32 s41, s87, 4096
    s_waitcnt vmcnt(4)
    buffer_load_dwordx4 v189, s[12:15], s41 offen offset:128 nt lds
    v_mfma_f32_16x16x32_bf16 v[24:27], v[76:79], v[96:99], v[24:27]
    ds_read_b64_tr_b16 v[208:209], v147 offset:8
    v_mfma_f32_16x16x32_bf16 v[28:31], v[76:79], v[100:103], v[28:31]
    ds_read_b64_tr_b16 v[210:211], v147 offset:4104
    s_add_u32 s87, s64, 40960
    s_and_b32 s87, s87, 0x1ffff
    s_add_u32 s87, s87, s36
    s_add_u32 m0, s39, 147456
    s_add_u32 s41, s87, 0
    s_waitcnt vmcnt(4)
    buffer_load_dwordx4 v188, s[8:11], s41 offen nt lds
    v_mfma_f32_16x16x32_bf16 v[32:35], v[80:83], v[96:99], v[32:35]
    ds_read_b64_tr_b16 v[212:213], v146 offset:2048
    s_add_u32 m0, s39, 149376
    s_add_u32 s41, s87, 0
    s_waitcnt vmcnt(4)
    buffer_load_dwordx4 v188, s[8:11], s41 offen offset:128 nt lds
    v_mfma_f32_16x16x32_bf16 v[36:39], v[80:83], v[100:103], v[36:39]
    ds_read_b64_tr_b16 v[214:215], v146 offset:6144
    v_mfma_f32_16x16x32_bf16 v[40:43], v[84:87], v[96:99], v[40:43]
    ds_read_b64_tr_b16 v[216:217], v146 offset:2056
    ds_read_b64_tr_b16 v[218:219], v146 offset:6152
    s_add_u32 m0, s39, 151552
    s_add_u32 s41, s87, 4096
    s_waitcnt vmcnt(4)
    buffer_load_dwordx4 v188, s[8:11], s41 offen nt lds
    v_mfma_f32_16x16x32_bf16 v[44:47], v[84:87], v[100:103], v[44:47]
    ds_read_b64_tr_b16 v[220:221], v147 offset:2048
    v_mfma_f32_16x16x32_bf16 v[48:51], v[88:91], v[96:99], v[48:51]
    ds_read_b64_tr_b16 v[222:223], v147 offset:6144
    s_add_u32 m0, s39, 153472
    s_add_u32 s41, s87, 4096
    s_waitcnt vmcnt(4)
    buffer_load_dwordx4 v188, s[8:11], s41 offen offset:128 nt lds
    v_mfma_f32_16x16x32_bf16 v[52:55], v[88:91], v[100:103], v[52:55]
    ds_read_b64_tr_b16 v[224:225], v147 offset:2056
    v_mfma_f32_16x16x32_bf16 v[56:59], v[92:95], v[96:99], v[56:59]
    ds_read_b64_tr_b16 v[226:227], v147 offset:6152
    v_mfma_f32_16x16x32_bf16 v[60:63], v[92:95], v[100:103], v[60:63]
    v_add_u32 v144, s52, v144
    v_add_u32 v145, s52, v145
    v_add_u32 v144, 0xfffe8000, v144
    v_add_u32 v145, 0xfffe8000, v145
    v_xor_b32 v146, 64, v148
    v_xor_b32 v147, 64, v149
    s_waitcnt vmcnt(16) lgkmcnt(0)
    s_barrier
    ds_read_b128 v[152:155], v144
    ds_read_b128 v[156:159], v144 offset:4096
    ds_read_b128 v[160:163], v145
    ds_read_b128 v[164:167], v145 offset:4096
    ds_read_b128 v[168:171], v144 offset:2048
    ds_read_b128 v[172:175], v144 offset:6144
    ds_read_b128 v[176:179], v145 offset:2048
    v_mfma_f32_16x16x32_bf16 v[0:3], v[196:199], v[228:231], v[0:3]
    s_add_u32 s87, s64, 24576
    s_and_b32 s87, s87, 0x1ffff
    s_add_u32 s87, s87, s36
    s_add_u32 m0, s39, 81920
    s_add_u32 s41, s87, 0
    s_waitcnt vmcnt(4)
    buffer_load_dwordx4 v188, s[8:11], s41 offen nt lds
    v_mfma_f32_16x16x32_bf16 v[4:7], v[196:199], v[232:235], v[4:7]
    v_mfma_f32_16x16x32_bf16 v[8:11], v[200:203], v[228:231], v[8:11]
    s_add_u32 m0, s39, 83840
    s_add_u32 s41, s87, 0
    s_waitcnt vmcnt(4)
    buffer_load_dwordx4 v188, s[8:11], s41 offen offset:128 nt lds
    v_mfma_f32_16x16x32_bf16 v[12:15], v[200:203], v[232:235], v[12:15]
    v_mfma_f32_16x16x32_bf16 v[16:19], v[204:207], v[228:231], v[16:19]
    v_mfma_f32_16x16x32_bf16 v[20:23], v[204:207], v[232:235], v[20:23]
    s_add_u32 m0, s39, 86016
    s_add_u32 s41, s87, 4096
    s_waitcnt vmcnt(4)
    buffer_load_dwordx4 v188, s[8:11], s41 offen nt lds
    v_mfma_f32_16x16x32_bf16 v[24:27], v[208:211], v[228:231], v[24:27]
    v_mul_f32 v0, s72, v0
    v_mul_f32 v1, s72, v1
    v_mul_f32 v2, s72, v2
    v_mul_f32 v3, s72, v3
    v_cvt_pk_bf16_f32 v64, v0, v1
    v_cvt_pk_bf16_f32 v65, v2, v3
    v_mfma_f32_16x16x32_bf16 v[28:31], v[208:211], v[232:235], v[28:31]
    v_mul_f32 v8, s72, v8
    v_mul_f32 v9, s72, v9
    v_mul_f32 v10, s72, v10
    v_mul_f32 v11, s72, v11
    v_cvt_pk_bf16_f32 v66, v8, v9
    v_cvt_pk_bf16_f32 v67, v10, v11
    v_mfma_f32_16x16x32_bf16 v[32:35], v[212:215], v[228:231], v[32:35]
    s_add_u32 m0, s39, 87936
    s_add_u32 s41, s87, 4096
    s_waitcnt vmcnt(4)
    buffer_load_dwordx4 v188, s[8:11], s41 offen offset:128 nt lds
    v_mul_f32 v4, s72, v4
    v_mul_f32 v5, s72, v5
    v_mul_f32 v6, s72, v6
    v_mul_f32 v7, s72, v7
    v_cvt_pk_bf16_f32 v68, v4, v5
    v_cvt_pk_bf16_f32 v69, v6, v7
    v_mfma_f32_16x16x32_bf16 v[36:39], v[212:215], v[232:235], v[36:39]
    v_mul_f32 v12, s72, v12
    v_mul_f32 v13, s72, v13
    v_mul_f32 v14, s72, v14
    v_mul_f32 v15, s72, v15
    v_cvt_pk_bf16_f32 v70, v12, v13
    v_cvt_pk_bf16_f32 v71, v14, v15
    v_mfma_f32_16x16x32_bf16 v[40:43], v[216:219], v[228:231], v[40:43]
    s_add_u32 s87, s64, 16384
    s_and_b32 s87, s87, 0x1ffff
    s_add_u32 s87, s87, s36
    s_add_u32 m0, s39, 98304
    s_add_u32 s41, s87, 0
    s_waitcnt vmcnt(4)
    buffer_load_dwordx4 v189, s[12:15], s41 offen nt lds
    v_mul_f32 v16, s72, v16
    v_mul_f32 v17, s72, v17
    v_mul_f32 v18, s72, v18
    v_mul_f32 v19, s72, v19
    v_mfma_f32_16x16x32_bf16 v[44:47], v[216:219], v[232:235], v[44:47]
    v_cvt_pk_bf16_f32 v72, v16, v17
    v_cvt_pk_bf16_f32 v73, v18, v19
    v_mul_f32 v24, s72, v24
    v_mul_f32 v25, s72, v25
    v_mfma_f32_16x16x32_bf16 v[48:51], v[220:223], v[228:231], v[48:51]
    v_mul_f32 v26, s72, v26
    v_mul_f32 v27, s72, v27
    v_cvt_pk_bf16_f32 v74, v24, v25
    v_cvt_pk_bf16_f32 v75, v26, v27
    v_mfma_f32_16x16x32_bf16 v[52:55], v[220:223], v[232:235], v[52:55]
    s_add_u32 m0, s39, 100224
    s_add_u32 s41, s87, 0
    s_waitcnt vmcnt(4)
    buffer_load_dwordx4 v189, s[12:15], s41 offen offset:128 nt lds
    v_mul_f32 v20, s72, v20
    v_mul_f32 v21, s72, v21
    v_mul_f32 v22, s72, v22
    v_mul_f32 v23, s72, v23
    v_mfma_f32_16x16x32_bf16 v[56:59], v[224:227], v[228:231], v[56:59]
    v_cvt_pk_bf16_f32 v76, v20, v21
    v_cvt_pk_bf16_f32 v77, v22, v23
    v_mul_f32 v28, s72, v28
    v_mul_f32 v29, s72, v29
    v_mfma_f32_16x16x32_bf16 v[60:63], v[224:227], v[232:235], v[60:63]
    v_mul_f32 v30, s72, v30
    v_mul_f32 v31, s72, v31
    v_cvt_pk_bf16_f32 v78, v28, v29
    v_cvt_pk_bf16_f32 v79, v30, v31
    s_waitcnt lgkmcnt(6)
    v_mfma_f32_16x16x32_bf16 v[104:107], v[152:155], v[64:67], 0
    s_add_u32 m0, s39, 102400
    s_add_u32 s41, s87, 4096
    s_waitcnt vmcnt(4)
    buffer_load_dwordx4 v189, s[12:15], s41 offen nt lds
    v_mul_f32 v32, s72, v32
    v_mul_f32 v33, s72, v33
    v_mul_f32 v34, s72, v34
    v_mul_f32 v35, s72, v35
    v_mfma_f32_16x16x32_bf16 v[108:111], v[152:155], v[68:71], 0
    ds_read_b128 v[180:183], v145 offset:6144
    v_cvt_pk_bf16_f32 v80, v32, v33
    v_cvt_pk_bf16_f32 v81, v34, v35
    v_mul_f32 v40, s72, v40
    v_mul_f32 v41, s72, v41
    s_waitcnt lgkmcnt(6)
    v_mfma_f32_16x16x32_bf16 v[112:115], v[156:159], v[64:67], 0
    s_add_u32 m0, s39, 104320
    s_add_u32 s41, s87, 4096
    s_waitcnt vmcnt(4)
    buffer_load_dwordx4 v189, s[12:15], s41 offen offset:128 nt lds
    v_mul_f32 v42, s72, v42
    v_mul_f32 v43, s72, v43
    v_cvt_pk_bf16_f32 v82, v40, v41
    v_cvt_pk_bf16_f32 v83, v42, v43
    v_mfma_f32_16x16x32_bf16 v[116:119], v[156:159], v[68:71], 0
    v_add_u32 v144, 0x4000, v144
    v_add_u32 v145, 0x4000, v145
    ds_read_b128 v[152:155], v144
    v_mul_f32 v36, s72, v36
    v_mul_f32 v37, s72, v37
    v_mul_f32 v38, s72, v38
    v_mul_f32 v39, s72, v39
    s_waitcnt lgkmcnt(6)
    v_mfma_f32_16x16x32_bf16 v[104:107], v[160:163], v[72:75], v[104:107]
    v_cvt_pk_bf16_f32 v84, v36, v37
    v_cvt_pk_bf16_f32 v85, v38, v39
    v_mul_f32 v44, s72, v44
    v_mul_f32 v45, s72, v45
    v_mfma_f32_16x16x32_bf16 v[108:111], v[160:163], v[76:79], v[108:111]
    ds_read_b128 v[156:159], v144 offset:4096
    s_add_u32 s87, s64, 32768
    s_and_b32 s87, s87, 0x1ffff
    s_add_u32 s87, s87, s36
    s_add_u32 m0, s39, 114688
    s_add_u32 s41, s87, 0
    s_waitcnt vmcnt(4)
    buffer_load_dwordx4 v188, s[8:11], s41 offen nt lds
    v_mul_f32 v46, s72, v46
    v_mul_f32 v47, s72, v47
    v_cvt_pk_bf16_f32 v86, v44, v45
    v_cvt_pk_bf16_f32 v87, v46, v47
    s_waitcnt lgkmcnt(6)
    v_mfma_f32_16x16x32_bf16 v[112:115], v[164:167], v[72:75], v[112:115]
    v_mul_f32 v48, s72, v48
    v_mul_f32 v49, s72, v49
    v_mul_f32 v50, s72, v50
    v_mul_f32 v51, s72, v51
    v_cvt_pk_bf16_f32 v88, v48, v49
    v_mfma_f32_16x16x32_bf16 v[116:119], v[164:167], v[76:79], v[116:119]
    ds_read_b128 v[160:163], v145
    v_cvt_pk_bf16_f32 v89, v50, v51
    v_mul_f32 v56, s72, v56
    v_mul_f32 v57, s72, v57
    v_mul_f32 v58, s72, v58
    v_mul_f32 v59, s72, v59
    s_waitcnt lgkmcnt(6)
    v_mfma_f32_16x16x32_bf16 v[104:107], v[168:171], v[80:83], v[104:107]
    s_add_u32 m0, s39, 116608
    s_add_u32 s41, s87, 0
    s_waitcnt vmcnt(4)
    buffer_load_dwordx4 v188, s[8:11], s41 offen offset:128 nt lds
    v_cvt_pk_bf16_f32 v90, v56, v57
    v_cvt_pk_bf16_f32 v91, v58, v59
    v_mul_f32 v52, s72, v52
    v_mul_f32 v53, s72, v53
    v_mul_f32 v54, s72, v54
    v_mfma_f32_16x16x32_bf16 v[108:111], v[168:171], v[84:87], v[108:111]
    ds_read_b128 v[164:167], v145 offset:4096
    v_mul_f32 v55, s72, v55
    v_cvt_pk_bf16_f32 v92, v52, v53
    v_cvt_pk_bf16_f32 v93, v54, v55
    v_mul_f32 v60, s72, v60
    v_mul_f32 v61, s72, v61
    s_waitcnt lgkmcnt(6)
    v_mfma_f32_16x16x32_bf16 v[112:115], v[172:175], v[80:83], v[112:115]
    s_add_u32 m0, s39, 118784
    s_add_u32 s41, s87, 4096
    s_waitcnt vmcnt(4)
    buffer_load_dwordx4 v188, s[8:11], s41 offen nt lds
    v_mul_f32 v62, s72, v62
    v_mul_f32 v63, s72, v63
    v_cvt_pk_bf16_f32 v94, v60, v61
    v_cvt_pk_bf16_f32 v95, v62, v63
    v_mfma_f32_16x16x32_bf16 v[116:119], v[172:175], v[84:87], v[116:119]
    ds_read_b128 v[168:171], v144 offset:2048
    s_waitcnt lgkmcnt(6)
    v_mfma_f32_16x16x32_bf16 v[104:107], v[176:179], v[88:91], v[104:107]
    v_mfma_f32_16x16x32_bf16 v[108:111], v[176:179], v[92:95], v[108:111]
    ds_read_b128 v[172:175], v144 offset:6144
    s_add_u32 m0, s39, 120704
    s_add_u32 s41, s87, 4096
    s_waitcnt vmcnt(4)
    buffer_load_dwordx4 v188, s[8:11], s41 offen offset:128 nt lds
    s_waitcnt lgkmcnt(6)
    v_mfma_f32_16x16x32_bf16 v[112:115], v[180:183], v[88:91], v[112:115]
    v_mfma_f32_16x16x32_bf16 v[116:119], v[180:183], v[92:95], v[116:119]
    ds_read_b128 v[176:179], v145 offset:2048
    v_max3_f32 v138, v104, v105, v106
    s_nop 4
    v_max3_f32 v138, v138, v107, v112
    v_max3_f32 v138, v138, v113, v114
    v_max_f32 v138, v138, v115
    v_max3_f32 v139, v108, v109, v110
    v_max3_f32 v139, v139, v111, v116
    v_max3_f32 v139, v139, v117, v118
    v_max_f32 v139, v139, v119
    v_mov_b32 v140, v138
    v_mov_b32 v141, v139
    s_nop 0
    v_permlane32_swap_b32 v138, v140
    v_permlane32_swap_b32 v139, v141
    v_max_f32 v138, v138, v140
    v_max_f32 v139, v139, v141
    v_mov_b32 v140, v138
    v_mov_b32 v141, v139
    s_nop 0
    v_permlane16_swap_b32 v138, v140
    v_permlane16_swap_b32 v139, v141
    v_max_f32 v138, v138, v140
    v_max_f32 v139, v139, v141
    v_sub_f32 v96, 0, v138
    v_sub_f32 v97, 0, v138
    v_sub_f32 v98, 0, v138
    v_sub_f32 v99, 0, v138
    v_sub_f32 v104, v104, v138
    v_sub_f32 v105, v105, v138
    v_sub_f32 v106, v106, v138
    v_sub_f32 v107, v107, v138
    v_sub_f32 v112, v112, v138
    v_sub_f32 v113, v113, v138
    v_sub_f32 v114, v114, v138
    v_sub_f32 v115, v115, v138
    v_sub_f32 v100, 0, v139
    v_sub_f32 v101, 0, v139
    v_sub_f32 v102, 0, v139
    v_sub_f32 v103, 0, v139
    v_sub_f32 v108, v108, v139
    v_sub_f32 v109, v109, v139
    v_sub_f32 v110, v110, v139
    v_sub_f32 v111, v111, v139
    v_sub_f32 v116, v116, v139
    v_sub_f32 v117, v117, v139
    v_sub_f32 v118, v118, v139
    v_sub_f32 v119, v119, v139
    v_exp_f32 v140, v104
    v_exp_f32 v141, v105
    v_exp_f32 v142, v106
    v_add_f32 v138, v140, v141
    v_cvt_pk_bf16_f32 v120, v140, v141
    v_exp_f32 v143, v107
    v_exp_f32 v140, v108
    v_add_f32 v138, v138, v142
    v_cvt_pk_bf16_f32 v121, v142, v143
    v_add_f32 v138, v138, v143
    v_exp_f32 v141, v109
    v_exp_f32 v142, v110
    v_add_f32 v139, v140, v141
    v_cvt_pk_bf16_f32 v124, v140, v141
    v_exp_f32 v143, v111
    v_exp_f32 v140, v112
    v_add_f32 v139, v139, v142
    v_cvt_pk_bf16_f32 v125, v142, v143
    v_add_f32 v139, v139, v143
    v_exp_f32 v141, v113
    v_exp_f32 v142, v114
    v_add_f32 v138, v138, v140
    v_cvt_pk_bf16_f32 v122, v140, v141
    v_add_f32 v138, v138, v141
    v_exp_f32 v143, v115
    v_exp_f32 v140, v116
    v_add_f32 v138, v138, v142
    v_cvt_pk_bf16_f32 v123, v142, v143
    v_add_f32 v138, v138, v143
    v_exp_f32 v141, v117
    v_exp_f32 v142, v118
    v_add_f32 v139, v139, v140
    v_cvt_pk_bf16_f32 v126, v140, v141
    v_add_f32 v139, v139, v141
    v_exp_f32 v143, v119
    v_add_f32 v139, v139, v142
    v_cvt_pk_bf16_f32 v127, v142, v143
    v_add_f32 v139, v139, v143
    s_setprio 0
    s_waitcnt vmcnt(24)
    s_barrier
    s_waitcnt lgkmcnt(6)
    v_mfma_f32_16x16x32_bf16 v[104:107], v[152:155], v[64:67], v[96:99]
    s_add_u32 s87, s64, 32768
    s_and_b32 s87, s87, 0x1ffff
    s_add_u32 s87, s87, s36
    s_add_u32 m0, s39, 0
    s_add_u32 s41, s87, 0
    s_waitcnt vmcnt(4)
    buffer_load_dwordx4 v189, s[12:15], s41 offen nt lds
    v_mfma_f32_16x16x32_bf16 v[108:111], v[152:155], v[68:71], v[100:103]
    ds_read_b128 v[180:183], v145 offset:6144
    s_waitcnt lgkmcnt(6)
    v_mfma_f32_16x16x32_bf16 v[112:115], v[156:159], v[64:67], v[96:99]
    v_mfma_f32_16x16x32_bf16 v[116:119], v[156:159], v[68:71], v[100:103]
    ds_read_b64_tr_b16 v[152:153], v146
    ds_read_b64_tr_b16 v[154:155], v146 offset:4096
    v_mov_b32 v136, v138
    s_waitcnt lgkmcnt(7)
    v_mfma_f32_16x16x32_bf16 v[104:107], v[160:163], v[72:75], v[104:107]
    v_mfma_f32_16x16x32_bf16 v[108:111], v[160:163], v[76:79], v[108:111]
    ds_read_b64_tr_b16 v[156:157], v147
    ds_read_b64_tr_b16 v[158:159], v147 offset:4096
    v_mov_b32 v137, v139
    s_waitcnt lgkmcnt(8)
    v_mfma_f32_16x16x32_bf16 v[112:115], v[164:167], v[72:75], v[112:115]
    v_mfma_f32_16x16x32_bf16 v[116:119], v[164:167], v[76:79], v[116:119]
    ds_read_b64_tr_b16 v[160:161], v148
    ds_read_b64_tr_b16 v[162:163], v148 offset:4096
    s_waitcnt lgkmcnt(9)
    v_mfma_f32_16x16x32_bf16 v[104:107], v[168:171], v[80:83], v[104:107]
    s_add_u32 m0, s39, 1920
    s_add_u32 s41, s87, 0
    s_waitcnt vmcnt(4)
    buffer_load_dwordx4 v189, s[12:15], s41 offen offset:128 nt lds
    v_mfma_f32_16x16x32_bf16 v[108:111], v[168:171], v[84:87], v[108:111]
    ds_read_b64_tr_b16 v[164:165], v149
    ds_read_b64_tr_b16 v[166:167], v149 offset:4096
    s_waitcnt lgkmcnt(10)
    v_mfma_f32_16x16x32_bf16 v[112:115], v[172:175], v[80:83], v[112:115]
    v_mfma_f32_16x16x32_bf16 v[116:119], v[172:175], v[84:87], v[116:119]
    ds_read_b64_tr_b16 v[168:169], v146 offset:2048
    ds_read_b64_tr_b16 v[170:171], v146 offset:6144
    s_waitcnt lgkmcnt(11)
    v_mfma_f32_16x16x32_bf16 v[104:107], v[176:179], v[88:91], v[104:107]
    v_mfma_f32_16x16x32_bf16 v[108:111], v[176:179], v[92:95], v[108:111]
    ds_read_b64_tr_b16 v[172:173], v147 offset:2048
    ds_read_b64_tr_b16 v[174:175], v147 offset:6144
    s_waitcnt lgkmcnt(12)
    v_mfma_f32_16x16x32_bf16 v[112:115], v[180:183], v[88:91], v[112:115]
    v_mfma_f32_16x16x32_bf16 v[116:119], v[180:183], v[92:95], v[116:119]
    ds_read_b64_tr_b16 v[176:177], v148 offset:2048
    ds_read_b64_tr_b16 v[178:179], v148 offset:6144
    s_setprio 1
    s_waitcnt lgkmcnt(12)
    v_mfma_f32_16x16x32_bf16 v[0:3], v[152:155], v[120:123], 0
    v_mfma_f32_16x16x32_bf16 v[4:7], v[152:155], v[124:127], 0
    ds_read_b64_tr_b16 v[180:181], v149 offset:2048
    ds_read_b64_tr_b16 v[182:183], v149 offset:6144
    s_add_u32 m0, s39, 4096
    s_add_u32 s41, s87, 4096
    s_waitcnt vmcnt(4)
    buffer_load_dwordx4 v189, s[12:15], s41 offen nt lds
    s_waitcnt lgkmcnt(12)
    v_mfma_f32_16x16x32_bf16 v[8:11], v[156:159], v[120:123], 0
    v_exp_f32 v140, v104
    v_exp_f32 v141, v105
    v_exp_f32 v142, v106
    v_mfma_f32_16x16x32_bf16 v[12:15], v[156:159], v[124:127], 0
    v_add_u32 v144, 0x8000, v144
    v_add_u32 v145, 0x8000, v145
    ds_read_b128 v[152:155], v144
    v_add_f32 v138, v140, v141
    v_cvt_pk_bf16_f32 v128, v140, v141
    v_exp_f32 v143, v107
    s_waitcnt lgkmcnt(11)
    v_mfma_f32_16x16x32_bf16 v[16:19], v[160:163], v[120:123], 0
    v_exp_f32 v140, v108
    v_add_f32 v138, v138, v142
    v_cvt_pk_bf16_f32 v129, v142, v143
    v_add_f32 v138, v138, v143
    v_mfma_f32_16x16x32_bf16 v[20:23], v[160:163], v[124:127], 0
    ds_read_b128 v[156:159], v144 offset:4096
    v_exp_f32 v141, v109
    v_exp_f32 v142, v110
    v_add_f32 v139, v140, v141
    v_cvt_pk_bf16_f32 v132, v140, v141
    s_waitcnt lgkmcnt(10)
    v_mfma_f32_16x16x32_bf16 v[24:27], v[164:167], v[120:123], 0
    v_exp_f32 v143, v111
    v_exp_f32 v140, v112
    v_mfma_f32_16x16x32_bf16 v[28:31], v[164:167], v[124:127], 0
    ds_read_b128 v[160:163], v145
    v_add_f32 v139, v139, v142
    v_cvt_pk_bf16_f32 v133, v142, v143
    v_add_f32 v139, v139, v143
    v_exp_f32 v141, v113
    s_waitcnt lgkmcnt(9)
    v_mfma_f32_16x16x32_bf16 v[32:35], v[168:171], v[120:123], 0
    s_add_u32 m0, s39, 6016
    s_add_u32 s41, s87, 4096
    s_waitcnt vmcnt(4)
    buffer_load_dwordx4 v189, s[12:15], s41 offen offset:128 nt lds
    v_exp_f32 v142, v114
    v_add_f32 v138, v138, v140
    v_cvt_pk_bf16_f32 v130, v140, v141
    v_add_f32 v138, v138, v141
    v_mfma_f32_16x16x32_bf16 v[36:39], v[168:171], v[124:127], 0
    ds_read_b128 v[164:167], v145 offset:4096
    v_exp_f32 v143, v115
    v_exp_f32 v140, v116
    v_add_f32 v138, v138, v142
    v_cvt_pk_bf16_f32 v131, v142, v143
    v_add_f32 v138, v138, v143
    s_waitcnt lgkmcnt(8)
    v_mfma_f32_16x16x32_bf16 v[40:43], v[172:175], v[120:123], 0
    v_exp_f32 v141, v117
    v_exp_f32 v142, v118
    v_mfma_f32_16x16x32_bf16 v[44:47], v[172:175], v[124:127], 0
    ds_read_b128 v[168:171], v144 offset:2048
    v_add_f32 v139, v139, v140
    v_cvt_pk_bf16_f32 v134, v140, v141
    v_add_f32 v139, v139, v141
    v_exp_f32 v143, v119
    s_waitcnt lgkmcnt(7)
    v_mfma_f32_16x16x32_bf16 v[48:51], v[176:179], v[120:123], 0
    v_add_f32 v139, v139, v142
    v_cvt_pk_bf16_f32 v135, v142, v143
    v_add_f32 v139, v139, v143
    v_max_f32 v185, v138, v139
    v_cmp_nge_f32 vcc, 0x46800000, v185
    v_mfma_f32_16x16x32_bf16 v[52:55], v[176:179], v[124:127], 0
    ds_read_b128 v[172:175], v144 offset:6144
    s_waitcnt lgkmcnt(6)
    v_mfma_f32_16x16x32_bf16 v[56:59], v[180:183], v[120:123], 0
    v_mfma_f32_16x16x32_bf16 v[60:63], v[180:183], v[124:127], 0
    ds_read_b128 v[176:179], v145 offset:2048
    s_cbranch_vccnz L_stub0
L_back0:
    s_setprio 0
    s_waitcnt vmcnt(12)
    s_barrier
    s_waitcnt lgkmcnt(6)
    v_mfma_f32_16x16x32_bf16 v[104:107], v[152:155], v[64:67], v[96:99]
    v_mfma_f32_16x16x32_bf16 v[108:111], v[152:155], v[68:71], v[100:103]
    ds_read_b128 v[180:183], v145 offset:6144
    s_waitcnt lgkmcnt(6)
    v_mfma_f32_16x16x32_bf16 v[112:115], v[156:159], v[64:67], v[96:99]
    v_mfma_f32_16x16x32_bf16 v[116:119], v[156:159], v[68:71], v[100:103]
    v_add_u32 v146, 0x8000, v146
    v_add_u32 v147, 0x8000, v147
    v_add_u32 v148, 0x8000, v148
    v_add_u32 v149, 0x8000, v149
    ds_read_b64_tr_b16 v[152:153], v146
    ds_read_b64_tr_b16 v[154:155], v146 offset:4096
    v_add_f32 v136, v136, v138
    s_waitcnt lgkmcnt(7)
    v_mfma_f32_16x16x32_bf16 v[104:107], v[160:163], v[72:75], v[104:107]
    v_mfma_f32_16x16x32_bf16 v[108:111], v[160:163], v[76:79], v[108:111]
    ds_read_b64_tr_b16 v[156:157], v147
    ds_read_b64_tr_b16 v[158:159], v147 offset:4096
    v_add_f32 v137, v137, v139
    s_waitcnt lgkmcnt(8)
    v_mfma_f32_16x16x32_bf16 v[112:115], v[164:167], v[72:75], v[112:115]
    v_mfma_f32_16x16x32_bf16 v[116:119], v[164:167], v[76:79], v[116:119]
    ds_read_b64_tr_b16 v[160:161], v148
    ds_read_b64_tr_b16 v[162:163], v148 offset:4096
    s_waitcnt lgkmcnt(9)
    v_mfma_f32_16x16x32_bf16 v[104:107], v[168:171], v[80:83], v[104:107]
    v_mfma_f32_16x16x32_bf16 v[108:111], v[168:171], v[84:87], v[108:111]
    ds_read_b64_tr_b16 v[164:165], v149
    ds_read_b64_tr_b16 v[166:167], v149 offset:4096
    s_waitcnt lgkmcnt(10)
    v_mfma_f32_16x16x32_bf16 v[112:115], v[172:175], v[80:83], v[112:115]
    v_mfma_f32_16x16x32_bf16 v[116:119], v[172:175], v[84:87], v[116:119]
    ds_read_b64_tr_b16 v[168:169], v146 offset:2048
    ds_read_b64_tr_b16 v[170:171], v146 offset:6144
    s_waitcnt lgkmcnt(11)
    v_mfma_f32_16x16x32_bf16 v[104:107], v[176:179], v[88:91], v[104:107]
    v_mfma_f32_16x16x32_bf16 v[108:111], v[176:179], v[92:95], v[108:111]
    ds_read_b64_tr_b16 v[172:173], v147 offset:2048
    ds_read_b64_tr_b16 v[174:175], v147 offset:6144
    s_waitcnt lgkmcnt(12)
    v_mfma_f32_16x16x32_bf16 v[112:115], v[180:183], v[88:91], v[112:115]
    v_mfma_f32_16x16x32_bf16 v[116:119], v[180:183], v[92:95], v[116:119]
    ds_read_b64_tr_b16 v[176:177], v148 offset:2048
    ds_read_b64_tr_b16 v[178:179], v148 offset:6144
    s_setprio 1
    s_waitcnt lgkmcnt(12)
    v_mfma_f32_16x16x32_bf16 v[0:3], v[152:155], v[128:131], v[0:3]
    v_mfma_f32_16x16x32_bf16 v[4:7], v[152:155], v[132:135], v[4:7]
    ds_read_b64_tr_b16 v[180:181], v149 offset:2048
    ds_read_b64_tr_b16 v[182:183], v149 offset:6144
    s_waitcnt lgkmcnt(12)
    v_mfma_f32_16x16x32_bf16 v[8:11], v[156:159], v[128:131], v[8:11]
    v_exp_f32 v140, v104
    v_exp_f32 v141, v105
    v_exp_f32 v142, v106
    v_mfma_f32_16x16x32_bf16 v[12:15], v[156:159], v[132:135], v[12:15]
    v_add_u32 v144, 0x8000, v144
    v_add_u32 v145, 0x8000, v145
    ds_read_b128 v[152:155], v144
    v_add_f32 v138, v140, v141
    v_cvt_pk_bf16_f32 v120, v140, v141
    v_exp_f32 v143, v107
    s_waitcnt lgkmcnt(11)
    v_mfma_f32_16x16x32_bf16 v[16:19], v[160:163], v[128:131], v[16:19]
    v_exp_f32 v140, v108
    v_add_f32 v138, v138, v142
    v_cvt_pk_bf16_f32 v121, v142, v143
    v_add_f32 v138, v138, v143
    v_mfma_f32_16x16x32_bf16 v[20:23], v[160:163], v[132:135], v[20:23]
    ds_read_b128 v[156:159], v144 offset:4096
    v_exp_f32 v141, v109
    v_exp_f32 v142, v110
    v_add_f32 v139, v140, v141
    v_cvt_pk_bf16_f32 v124, v140, v141
    s_waitcnt lgkmcnt(10)
    v_mfma_f32_16x16x32_bf16 v[24:27], v[164:167], v[128:131], v[24:27]
    v_exp_f32 v143, v111
    v_exp_f32 v140, v112
    v_mfma_f32_16x16x32_bf16 v[28:31], v[164:167], v[132:135], v[28:31]
    ds_read_b128 v[160:163], v145
    v_add_f32 v139, v139, v142
    v_cvt_pk_bf16_f32 v125, v142, v143
    v_add_f32 v139, v139, v143
    v_exp_f32 v141, v113
    s_waitcnt lgkmcnt(9)
    v_mfma_f32_16x16x32_bf16 v[32:35], v[168:171], v[128:131], v[32:35]
    v_exp_f32 v142, v114
    v_add_f32 v138, v138, v140
    v_cvt_pk_bf16_f32 v122, v140, v141
    v_add_f32 v138, v138, v141
    v_mfma_f32_16x16x32_bf16 v[36:39], v[168:171], v[132:135], v[36:39]
    ds_read_b128 v[164:167], v145 offset:4096
    v_exp_f32 v143, v115
    v_exp_f32 v140, v116
    v_add_f32 v138, v138, v142
    v_cvt_pk_bf16_f32 v123, v142, v143
    v_add_f32 v138, v138, v143
    s_waitcnt lgkmcnt(8)
    v_mfma_f32_16x16x32_bf16 v[40:43], v[172:175], v[128:131], v[40:43]
    v_exp_f32 v141, v117
    v_exp_f32 v142, v118
    v_mfma_f32_16x16x32_bf16 v[44:47], v[172:175], v[132:135], v[44:47]
    ds_read_b128 v[168:171], v144 offset:2048
    v_add_f32 v139, v139, v140
    v_cvt_pk_bf16_f32 v126, v140, v141
    v_add_f32 v139, v139, v141
    v_exp_f32 v143, v119
    s_waitcnt lgkmcnt(7)
    v_mfma_f32_16x16x32_bf16 v[48:51], v[176:179], v[128:131], v[48:51]
    v_add_f32 v139, v139, v142
    v_cvt_pk_bf16_f32 v127, v142, v143
    v_add_f32 v139, v139, v143
    v_max_f32 v185, v138, v139
    v_cmp_nge_f32 vcc, 0x46800000, v185
    v_mfma_f32_16x16x32_bf16 v[52:55], v[176:179], v[132:135], v[52:55]
    ds_read_b128 v[172:175], v144 offset:6144
    s_waitcnt lgkmcnt(6)
    v_mfma_f32_16x16x32_bf16 v[56:59], v[180:183], v[128:131], v[56:59]
    v_mfma_f32_16x16x32_bf16 v[60:63], v[180:183], v[132:135], v[60:63]
    ds_read_b128 v[176:179], v145 offset:2048
    s_cbranch_vccnz L_stub1
L_back1:
    s_setprio 0
    s_waitcnt vmcnt(4)
    s_barrier
    s_waitcnt lgkmcnt(6)
    v_mfma_f32_16x16x32_bf16 v[104:107], v[152:155], v[64:67], v[96:99]
    s_add_u32 s87, s64, 49152
    s_and_b32 s87, s87, 0x1ffff
    s_add_u32 s87, s87, s36
    s_add_u32 m0, s39, 16384
    s_add_u32 s41, s87, 0
    s_waitcnt vmcnt(4)
    buffer_load_dwordx4 v188, s[8:11], s41 offen nt lds
    v_mfma_f32_16x16x32_bf16 v[108:111], v[152:155], v[68:71], v[100:103]
    ds_read_b128 v[180:183], v145 offset:6144
    s_waitcnt lgkmcnt(6)
    v_mfma_f32_16x16x32_bf16 v[112:115], v[156:159], v[64:67], v[96:99]
    v_mfma_f32_16x16x32_bf16 v[116:119], v[156:159], v[68:71], v[100:103]
    v_add_u32 v146, 0x8000, v146
    v_add_u32 v147, 0x8000, v147
    v_add_u32 v148, 0x8000, v148
    v_add_u32 v149, 0x8000, v149
    ds_read_b64_tr_b16 v[152:153], v146
    ds_read_b64_tr_b16 v[154:155], v146 offset:4096
    v_add_f32 v136, v136, v138
    s_waitcnt lgkmcnt(7)
    v_mfma_f32_16x16x32_bf16 v[104:107], v[160:163], v[72:75], v[104:107]
    v_mfma_f32_16x16x32_bf16 v[108:111], v[160:163], v[76:79], v[108:111]
    ds_read_b64_tr_b16 v[156:157], v147
    ds_read_b64_tr_b16 v[158:159], v147 offset:4096
    v_add_f32 v137, v137, v139
    s_waitcnt lgkmcnt(8)
    v_mfma_f32_16x16x32_bf16 v[112:115], v[164:167], v[72:75], v[112:115]
    v_mfma_f32_16x16x32_bf16 v[116:119], v[164:167], v[76:79], v[116:119]
    ds_read_b64_tr_b16 v[160:161], v148
    ds_read_b64_tr_b16 v[162:163], v148 offset:4096
    s_waitcnt lgkmcnt(9)
    v_mfma_f32_16x16x32_bf16 v[104:107], v[168:171], v[80:83], v[104:107]
    s_add_u32 m0, s39, 18304
    s_add_u32 s41, s87, 0
    s_waitcnt vmcnt(4)
    buffer_load_dwordx4 v188, s[8:11], s41 offen offset:128 nt lds
    v_mfma_f32_16x16x32_bf16 v[108:111], v[168:171], v[84:87], v[108:111]
    ds_read_b64_tr_b16 v[164:165], v149
    ds_read_b64_tr_b16 v[166:167], v149 offset:4096
    s_waitcnt lgkmcnt(10)
    v_mfma_f32_16x16x32_bf16 v[112:115], v[172:175], v[80:83], v[112:115]
    v_mfma_f32_16x16x32_bf16 v[116:119], v[172:175], v[84:87], v[116:119]
    ds_read_b64_tr_b16 v[168:169], v146 offset:2048
    ds_read_b64_tr_b16 v[170:171], v146 offset:6144
    s_waitcnt lgkmcnt(11)
    v_mfma_f32_16x16x32_bf16 v[104:107], v[176:179], v[88:91], v[104:107]
    v_mfma_f32_16x16x32_bf16 v[108:111], v[176:179], v[92:95], v[108:111]
    ds_read_b64_tr_b16 v[172:173], v147 offset:2048
    ds_read_b64_tr_b16 v[174:175], v147 offset:6144
    s_waitcnt lgkmcnt(12)
    v_mfma_f32_16x16x32_bf16 v[112:115], v[180:183], v[88:91], v[112:115]
    v_mfma_f32_16x16x32_bf16 v[116:119], v[180:183], v[92:95], v[116:119]
    ds_read_b64_tr_b16 v[176:177], v148 offset:2048
    ds_read_b64_tr_b16 v[178:179], v148 offset:6144
    s_setprio 1
    s_waitcnt lgkmcnt(12)
    v_mfma_f32_16x16x32_bf16 v[0:3], v[152:155], v[120:123], v[0:3]
    v_mfma_f32_16x16x32_bf16 v[4:7], v[152:155], v[124:127], v[4:7]
    ds_read_b64_tr_b16 v[180:181], v149 offset:2048
    ds_read_b64_tr_b16 v[182:183], v149 offset:6144
    s_add_u32 m0, s39, 20480
    s_add_u32 s41, s87, 4096
    s_waitcnt vmcnt(4)
    buffer_load_dwordx4 v188, s[8:11], s41 offen nt lds
    s_waitcnt lgkmcnt(12)
    v_mfma_f32_16x16x32_bf16 v[8:11], v[156:159], v[120:123], v[8:11]
    v_exp_f32 v140, v104
    v_exp_f32 v141, v105
    v_exp_f32 v142, v106
    v_mfma_f32_16x16x32_bf16 v[12:15], v[156:159], v[124:127], v[12:15]
    v_add_u32 v144, 0x8000, v144
    v_add_u32 v145, 0x8000, v145
    ds_read_b128 v[152:155], v144
    v_add_f32 v138, v140, v141
    v_cvt_pk_bf16_f32 v128, v140, v141
    v_exp_f32 v143, v107
    s_waitcnt lgkmcnt(11)
    v_mfma_f32_16x16x32_bf16 v[16:19], v[160:163], v[120:123], v[16:19]
    v_exp_f32 v140, v108
    v_add_f32 v138, v138, v142
    v_cvt_pk_bf16_f32 v129, v142, v143
    v_add_f32 v138, v138, v143
    v_mfma_f32_16x16x32_bf16 v[20:23], v[160:163], v[124:127], v[20:23]
    ds_read_b128 v[156:159], v144 offset:4096
    v_exp_f32 v141, v109
    v_exp_f32 v142, v110
    v_add_f32 v139, v140, v141
    v_cvt_pk_bf16_f32 v132, v140, v141
    s_waitcnt lgkmcnt(10)
    v_mfma_f32_16x16x32_bf16 v[24:27], v[164:167], v[120:123], v[24:27]
    v_exp_f32 v143, v111
    v_exp_f32 v140, v112
    v_mfma_f32_16x16x32_bf16 v[28:31], v[164:167], v[124:127], v[28:31]
    ds_read_b128 v[160:163], v145
    v_add_f32 v139, v139, v142
    v_cvt_pk_bf16_f32 v133, v142, v143
    v_add_f32 v139, v139, v143
    v_exp_f32 v141, v113
    s_waitcnt lgkmcnt(9)
    v_mfma_f32_16x16x32_bf16 v[32:35], v[168:171], v[120:123], v[32:35]
    s_add_u32 m0, s39, 22400
    s_add_u32 s41, s87, 4096
    s_waitcnt vmcnt(4)
    buffer_load_dwordx4 v188, s[8:11], s41 offen offset:128 nt lds
    v_exp_f32 v142, v114
    v_add_f32 v138, v138, v140
    v_cvt_pk_bf16_f32 v130, v140, v141
    v_add_f32 v138, v138, v141
    v_mfma_f32_16x16x32_bf16 v[36:39], v[168:171], v[124:127], v[36:39]
    ds_read_b128 v[164:167], v145 offset:4096
    v_exp_f32 v143, v115
    v_exp_f32 v140, v116
    v_add_f32 v138, v138, v142
    v_cvt_pk_bf16_f32 v131, v142, v143
    v_add_f32 v138, v138, v143
    s_waitcnt lgkmcnt(8)
    v_mfma_f32_16x16x32_bf16 v[40:43], v[172:175], v[120:123], v[40:43]
    v_exp_f32 v141, v117
    v_exp_f32 v142, v118
    v_mfma_f32_16x16x32_bf16 v[44:47], v[172:175], v[124:127], v[44:47]
    ds_read_b128 v[168:171], v144 offset:2048
    v_add_f32 v139, v139, v140
    v_cvt_pk_bf16_f32 v134, v140, v141
    v_add_f32 v139, v139, v141
    v_exp_f32 v143, v119
    s_waitcnt lgkmcnt(7)
    v_mfma_f32_16x16x32_bf16 v[48:51], v[176:179], v[120:123], v[48:51]
    v_add_f32 v139, v139, v142
    v_cvt_pk_bf16_f32 v135, v142, v143
    v_add_f32 v139, v139, v143
    v_max_f32 v185, v138, v139
    v_cmp_nge_f32 vcc, 0x46800000, v185
    v_mfma_f32_16x16x32_bf16 v[52:55], v[176:179], v[124:127], v[52:55]
    ds_read_b128 v[172:175], v144 offset:6144
    s_waitcnt lgkmcnt(6)
    v_mfma_f32_16x16x32_bf16 v[56:59], v[180:183], v[120:123], v[56:59]
    v_mfma_f32_16x16x32_bf16 v[60:63], v[180:183], v[124:127], v[60:63]
    ds_read_b128 v[176:179], v145 offset:2048
    s_cbranch_vccnz L_stub2
L_back2:
    s_setprio 0
    s_waitcnt vmcnt(8)
    s_barrier
    s_waitcnt lgkmcnt(6)
    v_mfma_f32_16x16x32_bf16 v[104:107], v[152:155], v[64:67], v[96:99]
    s_add_u32 s87, s64, 40960
    s_and_b32 s87, s87, 0x1ffff
    s_add_u32 s87, s87, s36
    s_add_u32 m0, s39, 32768
    s_add_u32 s41, s87, 0
    s_waitcnt vmcnt(4)
    buffer_load_dwordx4 v189, s[12:15], s41 offen nt lds
    v_mfma_f32_16x16x32_bf16 v[108:111], v[152:155], v[68:71], v[100:103]
    ds_read_b128 v[180:183], v145 offset:6144
    s_waitcnt lgkmcnt(6)
    v_mfma_f32_16x16x32_bf16 v[112:115], v[156:159], v[64:67], v[96:99]
    v_mfma_f32_16x16x32_bf16 v[116:119], v[156:159], v[68:71], v[100:103]
    v_add_u32 v146, 0x8000, v146
    v_add_u32 v147, 0x8000, v147
    v_add_u32 v148, 0x8000, v148
    v_add_u32 v149, 0x8000, v149
    ds_read_b64_tr_b16 v[152:153], v146
    ds_read_b64_tr_b16 v[154:155], v146 offset:4096
    v_add_f32 v136, v136, v138
    s_waitcnt lgkmcnt(7)
    v_mfma_f32_16x16x32_bf16 v[104:107], v[160:163], v[72:75], v[104:107]
    s_add_u32 m0, s39, 34688
    s_add_u32 s41, s87, 0
    s_waitcnt vmcnt(4)
    buffer_load_dwordx4 v189, s[12:15], s41 offen offset:128 nt lds
    v_mfma_f32_16x16x32_bf16 v[108:111], v[160:163], v[76:79], v[108:111]
    ds_read_b64_tr_b16 v[156:157], v147
    ds_read_b64_tr_b16 v[158:159], v147 offset:4096
    v_add_f32 v137, v137, v139
    s_waitcnt lgkmcnt(8)
    v_mfma_f32_16x16x32_bf16 v[112:115], v[164:167], v[72:75], v[112:115]
    v_mfma_f32_16x16x32_bf16 v[116:119], v[164:167], v[76:79], v[116:119]
    ds_read_b64_tr_b16 v[160:161], v148
    ds_read_b64_tr_b16 v[162:163], v148 offset:4096
    s_waitcnt lgkmcnt(9)
    v_mfma_f32_16x16x32_bf16 v[104:107], v[168:171], v[80:83], v[104:107]
    s_add_u32 m0, s39, 36864
    s_add_u32 s41, s87, 4096
    s_waitcnt vmcnt(4)
    buffer_load_dwordx4 v189, s[12:15], s41 offen nt lds
    v_mfma_f32_16x16x32_bf16 v[108:111], v[168:171], v[84:87], v[108:111]
    ds_read_b64_tr_b16 v[164:165], v149
    ds_read_b64_tr_b16 v[166:167], v149 offset:4096
    s_waitcnt lgkmcnt(10)
    v_mfma_f32_16x16x32_bf16 v[112:115], v[172:175], v[80:83], v[112:115]
    v_mfma_f32_16x16x32_bf16 v[116:119], v[172:175], v[84:87], v[116:119]
    ds_read_b64_tr_b16 v[168:169], v146 offset:2048
    ds_read_b64_tr_b16 v[170:171], v146 offset:6144
    s_waitcnt lgkmcnt(11)
    v_mfma_f32_16x16x32_bf16 v[104:107], v[176:179], v[88:91], v[104:107]
    s_add_u32 m0, s39, 38784
    s_add_u32 s41, s87, 4096
    s_waitcnt vmcnt(4)
    buffer_load_dwordx4 v189, s[12:15], s41 offen offset:128 nt lds
    v_mfma_f32_16x16x32_bf16 v[108:111], v[176:179], v[92:95], v[108:111]
    ds_read_b64_tr_b16 v[172:173], v147 offset:2048
    ds_read_b64_tr_b16 v[174:175], v147 offset:6144
    s_waitcnt lgkmcnt(12)
    v_mfma_f32_16x16x32_bf16 v[112:115], v[180:183], v[88:91], v[112:115]
    v_mfma_f32_16x16x32_bf16 v[116:119], v[180:183], v[92:95], v[116:119]
    ds_read_b64_tr_b16 v[176:177], v148 offset:2048
    ds_read_b64_tr_b16 v[178:179], v148 offset:6144
    s_setprio 1
    s_waitcnt lgkmcnt(12)
    v_mfma_f32_16x16x32_bf16 v[0:3], v[152:155], v[128:131], v[0:3]
    v_mfma_f32_16x16x32_bf16 v[4:7], v[152:155], v[132:135], v[4:7]
    ds_read_b64_tr_b16 v[180:181], v149 offset:2048
    ds_read_b64_tr_b16 v[182:183], v149 offset:6144
    s_add_u32 s87, s64, 57344
    s_and_b32 s87, s87, 0x1ffff
    s_add_u32 s87, s87, s36
    s_add_u32 m0, s39, 49152
    s_add_u32 s41, s87, 0
    s_waitcnt vmcnt(4)
    buffer_load_dwordx4 v188, s[8:11], s41 offen nt lds
    s_waitcnt lgkmcnt(12)
    v_mfma_f32_16x16x32_bf16 v[8:11], v[156:159], v[128:131], v[8:11]
    v_exp_f32 v140, v104
    v_exp_f32 v141, v105
    v_exp_f32 v142, v106
    v_mfma_f32_16x16x32_bf16 v[12:15], v[156:159], v[132:135], v[12:15]
    v_add_u32 v144, 0x8000, v144
    v_add_u32 v145, 0x8000, v145
    ds_read_b128 v[152:155], v144
    v_add_f32 v138, v140, v141
    v_cvt_pk_bf16_f32 v120, v140, v141
    v_exp_f32 v143, v107
    s_waitcnt lgkmcnt(11)
    v_mfma_f32_16x16x32_bf16 v[16:19], v[160:163], v[128:131], v[16:19]
    s_add_u32 m0, s39, 51072
    s_add_u32 s41, s87, 0
    s_waitcnt vmcnt(4)
    buffer_load_dwordx4 v188, s[8:11], s41 offen offset:128 nt lds
    v_exp_f32 v140, v108
    v_add_f32 v138, v138, v142
    v_cvt_pk_bf16_f32 v121, v142, v143
    v_add_f32 v138, v138, v143
    v_mfma_f32_16x16x32_bf16 v[20:23], v[160:163], v[132:135], v[20:23]
    ds_read_b128 v[156:159], v144 offset:4096
    v_exp_f32 v141, v109
    v_exp_f32 v142, v110
    v_add_f32 v139, v140, v141
    v_cvt_pk_bf16_f32 v124, v140, v141
    s_waitcnt lgkmcnt(10)
    v_mfma_f32_16x16x32_bf16 v[24:27], v[164:167], v[128:131], v[24:27]
    v_exp_f32 v143, v111
    v_exp_f32 v140, v112
    v_mfma_f32_16x16x32_bf16 v[28:31], v[164:167], v[132:135], v[28:31]
    ds_read_b128 v[160:163], v145
    v_add_f32 v139, v139, v142
    v_cvt_pk_bf16_f32 v125, v142, v143
    v_add_f32 v139, v139, v143
    v_exp_f32 v141, v113
    s_waitcnt lgkmcnt(9)
    v_mfma_f32_16x16x32_bf16 v[32:35], v[168:171], v[128:131], v[32:35]
    s_add_u32 m0, s39, 53248
    s_add_u32 s41, s87, 4096
    s_waitcnt vmcnt(4)
    buffer_load_dwordx4 v188, s[8:11], s41 offen nt lds
    v_exp_f32 v142, v114
    v_add_f32 v138, v138, v140
    v_cvt_pk_bf16_f32 v122, v140, v141
    v_add_f32 v138, v138, v141
    v_mfma_f32_16x16x32_bf16 v[36:39], v[168:171], v[132:135], v[36:39]
    ds_read_b128 v[164:167], v145 offset:4096
    v_exp_f32 v143, v115
    v_exp_f32 v140, v116
    v_add_f32 v138, v138, v142
    v_cvt_pk_bf16_f32 v123, v142, v143
    v_add_f32 v138, v138, v143
    s_waitcnt lgkmcnt(8)
    v_mfma_f32_16x16x32_bf16 v[40:43], v[172:175], v[128:131], v[40:43]
    v_exp_f32 v141, v117
    v_exp_f32 v142, v118
    v_mfma_f32_16x16x32_bf16 v[44:47], v[172:175], v[132:135], v[44:47]
    ds_read_b128 v[168:171], v144 offset:2048
    v_add_f32 v139, v139, v140
    v_cvt_pk_bf16_f32 v126, v140, v141
    v_add_f32 v139, v139, v141
    v_exp_f32 v143, v119
    s_waitcnt lgkmcnt(7)
    v_mfma_f32_16x16x32_bf16 v[48:51], v[176:179], v[128:131], v[48:51]
    s_add_u32 m0, s39, 55168
    s_add_u32 s41, s87, 4096
    s_waitcnt vmcnt(4)
    buffer_load_dwordx4 v188, s[8:11], s41 offen offset:128 nt lds
    v_add_f32 v139, v139, v142
    v_cvt_pk_bf16_f32 v127, v142, v143
    v_add_f32 v139, v139, v143
    v_max_f32 v185, v138, v139
    v_cmp_nge_f32 vcc, 0x46800000, v185
    v_mfma_f32_16x16x32_bf16 v[52:55], v[176:179], v[132:135], v[52:55]
    ds_read_b128 v[172:175], v144 offset:6144
    s_waitcnt lgkmcnt(6)
    v_mfma_f32_16x16x32_bf16 v[56:59], v[180:183], v[128:131], v[56:59]
    v_mfma_f32_16x16x32_bf16 v[60:63], v[180:183], v[132:135], v[60:63]
    ds_read_b128 v[176:179], v145 offset:2048
    s_cbranch_vccnz L_stub3
L_back3:
    s_setprio 0
    s_waitcnt vmcnt(8)
    s_barrier
    s_waitcnt lgkmcnt(6)
    v_mfma_f32_16x16x32_bf16 v[104:107], v[152:155], v[64:67], v[96:99]
    s_add_u32 s87, s64, 49152
    s_and_b32 s87, s87, 0x1ffff
    s_add_u32 s87, s87, s36
    s_add_u32 m0, s39, 65536
    s_add_u32 s41, s87, 0
    s_waitcnt vmcnt(4)
    buffer_load_dwordx4 v189, s[12:15], s41 offen nt lds
    v_mfma_f32_16x16x32_bf16 v[108:111], v[152:155], v[68:71], v[100:103]
    ds_read_b128 v[180:183], v145 offset:6144
    s_waitcnt lgkmcnt(6)
    v_mfma_f32_16x16x32_bf16 v[112:115], v[156:159], v[64:67], v[96:99]
    v_mfma_f32_16x16x32_bf16 v[116:119], v[156:159], v[68:71], v[100:103]
    v_add_u32 v146, 0xfffe0000, v146
    v_add_u32 v147, 0xfffe0000, v147
    v_add_u32 v148, 0xfffe0000, v148
    v_add_u32 v149, 0xfffe0000, v149
    ds_read_b64_tr_b16 v[152:153], v146
    ds_read_b64_tr_b16 v[154:155], v146 offset:4096
    v_add_f32 v136, v136, v138
    s_waitcnt lgkmcnt(7)
    v_mfma_f32_16x16x32_bf16 v[104:107], v[160:163], v[72:75], v[104:107]
    s_add_u32 m0, s39, 67456
    s_add_u32 s41, s87, 0
    s_waitcnt vmcnt(4)
    buffer_load_dwordx4 v189, s[12:15], s41 offen offset:128 nt lds
    v_mfma_f32_16x16x32_bf16 v[108:111], v[160:163], v[76:79], v[108:111]
    ds_read_b64_tr_b16 v[156:157], v147
    ds_read_b64_tr_b16 v[158:159], v147 offset:4096
    v_add_f32 v137, v137, v139
    s_waitcnt lgkmcnt(8)
    v_mfma_f32_16x16x32_bf16 v[112:115], v[164:167], v[72:75], v[112:115]
    v_mfma_f32_16x16x32_bf16 v[116:119], v[164:167], v[76:79], v[116:119]
    ds_read_b64_tr_b16 v[160:161], v148
    ds_read_b64_tr_b16 v[162:163], v148 offset:4096
    s_waitcnt lgkmcnt(9)
    v_mfma_f32_16x16x32_bf16 v[104:107], v[168:171], v[80:83], v[104:107]
    s_add_u32 m0, s39, 69632
    s_add_u32 s41, s87, 4096
    s_waitcnt vmcnt(4)
    buffer_load_dwordx4 v189, s[12:15], s41 offen nt lds
    v_mfma_f32_16x16x32_bf16 v[108:111], v[168:171], v[84:87], v[108:111]
    ds_read_b64_tr_b16 v[164:165], v149
    ds_read_b64_tr_b16 v[166:167], v149 offset:4096
    s_waitcnt lgkmcnt(10)
    v_mfma_f32_16x16x32_bf16 v[112:115], v[172:175], v[80:83], v[112:115]
    v_mfma_f32_16x16x32_bf16 v[116:119], v[172:175], v[84:87], v[116:119]
    ds_read_b64_tr_b16 v[168:169], v146 offset:2048
    ds_read_b64_tr_b16 v[170:171], v146 offset:6144
    s_waitcnt lgkmcnt(11)
    v_mfma_f32_16x16x32_bf16 v[104:107], v[176:179], v[88:91], v[104:107]
    s_add_u32 m0, s39, 71552
    s_add_u32 s41, s87, 4096
    s_waitcnt vmcnt(4)
    buffer_load_dwordx4 v189, s[12:15], s41 offen offset:128 nt lds
    v_mfma_f32_16x16x32_bf16 v[108:111], v[176:179], v[92:95], v[108:111]
    ds_read_b64_tr_b16 v[172:173], v147 offset:2048
    ds_read_b64_tr_b16 v[174:175], v147 offset:6144
    s_waitcnt lgkmcnt(12)
    v_mfma_f32_16x16x32_bf16 v[112:115], v[180:183], v[88:91], v[112:115]
    v_mfma_f32_16x16x32_bf16 v[116:119], v[180:183], v[92:95], v[116:119]
    ds_read_b64_tr_b16 v[176:177], v148 offset:2048
    ds_read_b64_tr_b16 v[178:179], v148 offset:6144
    s_setprio 1
    s_waitcnt lgkmcnt(12)
    v_mfma_f32_16x16x32_bf16 v[0:3], v[152:155], v[120:123], v[0:3]
    v_mfma_f32_16x16x32_bf16 v[4:7], v[152:155], v[124:127], v[4:7]
    ds_read_b64_tr_b16 v[180:181], v149 offset:2048
    ds_read_b64_tr_b16 v[182:183], v149 offset:6144
    s_add_u32 s87, s64, 65536
    s_and_b32 s87, s87, 0x1ffff
    s_add_u32 s87, s87, s36
    s_add_u32 m0, s39, 81920
    s_add_u32 s41, s87, 0
    s_waitcnt vmcnt(4)
    buffer_load_dwordx4 v188, s[8:11], s41 offen nt lds
    s_waitcnt lgkmcnt(12)
    v_mfma_f32_16x16x32_bf16 v[8:11], v[156:159], v[120:123], v[8:11]
    v_exp_f32 v140, v104
    v_exp_f32 v141, v105
    v_exp_f32 v142, v106
    v_mfma_f32_16x16x32_bf16 v[12:15], v[156:159], v[124:127], v[12:15]
    v_add_u32 v144, 0xfffe0000, v144
    v_add_u32 v145, 0xfffe0000, v145
    ds_read_b128 v[152:155], v144
    v_add_f32 v138, v140, v141
    v_cvt_pk_bf16_f32 v128, v140, v141
    v_exp_f32 v143, v107
    s_waitcnt lgkmcnt(11)
    v_mfma_f32_16x16x32_bf16 v[16:19], v[160:163], v[120:123], v[16:19]
    s_add_u32 m0, s39, 83840
    s_add_u32 s41, s87, 0
    s_waitcnt vmcnt(4)
    buffer_load_dwordx4 v188, s[8:11], s41 offen offset:128 nt lds
    v_exp_f32 v140, v108
    v_add_f32 v138, v138, v142
    v_cvt_pk_bf16_f32 v129, v142, v143
    v_add_f32 v138, v138, v143
    v_mfma_f32_16x16x32_bf16 v[20:23], v[160:163], v[124:127], v[20:23]
    ds_read_b128 v[156:159], v144 offset:4096
    v_exp_f32 v141, v109
    v_exp_f32 v142, v110
    v_add_f32 v139, v140, v141
    v_cvt_pk_bf16_f32 v132, v140, v141
    s_waitcnt lgkmcnt(10)
    v_mfma_f32_16x16x32_bf16 v[24:27], v[164:167], v[120:123], v[24:27]
    v_exp_f32 v143, v111
    v_exp_f32 v140, v112
    v_mfma_f32_16x16x32_bf16 v[28:31], v[164:167], v[124:127], v[28:31]
    ds_read_b128 v[160:163], v145
    v_add_f32 v139, v139, v142
    v_cvt_pk_bf16_f32 v133, v142, v143
    v_add_f32 v139, v139, v143
    v_exp_f32 v141, v113
    s_waitcnt lgkmcnt(9)
    v_mfma_f32_16x16x32_bf16 v[32:35], v[168:171], v[120:123], v[32:35]
    s_add_u32 m0, s39, 86016
    s_add_u32 s41, s87, 4096
    s_waitcnt vmcnt(4)
    buffer_load_dwordx4 v188, s[8:11], s41 offen nt lds
    v_exp_f32 v142, v114
    v_add_f32 v138, v138, v140
    v_cvt_pk_bf16_f32 v130, v140, v141
    v_add_f32 v138, v138, v141
    v_mfma_f32_16x16x32_bf16 v[36:39], v[168:171], v[124:127], v[36:39]
    ds_read_b128 v[164:167], v145 offset:4096
    v_exp_f32 v143, v115
    v_exp_f32 v140, v116
    v_add_f32 v138, v138, v142
    v_cvt_pk_bf16_f32 v131, v142, v143
    v_add_f32 v138, v138, v143
    s_waitcnt lgkmcnt(8)
    v_mfma_f32_16x16x32_bf16 v[40:43], v[172:175], v[120:123], v[40:43]
    v_exp_f32 v141, v117
    v_exp_f32 v142, v118
    v_mfma_f32_16x16x32_bf16 v[44:47], v[172:175], v[124:127], v[44:47]
    ds_read_b128 v[168:171], v144 offset:2048
    v_add_f32 v139, v139, v140
    v_cvt_pk_bf16_f32 v134, v140, v141
    v_add_f32 v139, v139, v141
    v_exp_f32 v143, v119
    s_waitcnt lgkmcnt(7)
    v_mfma_f32_16x16x32_bf16 v[48:51], v[176:179], v[120:123], v[48:51]
    s_add_u32 m0, s39, 87936
    s_add_u32 s41, s87, 4096
    s_waitcnt vmcnt(4)
    buffer_load_dwordx4 v188, s[8:11], s41 offen offset:128 nt lds
    v_add_f32 v139, v139, v142
    v_cvt_pk_bf16_f32 v135, v142, v143
    v_add_f32 v139, v139, v143
    v_max_f32 v185, v138, v139
    v_cmp_nge_f32 vcc, 0x46800000, v185
    v_mfma_f32_16x16x32_bf16 v[52:55], v[176:179], v[124:127], v[52:55]
    ds_read_b128 v[172:175], v144 offset:6144
    s_waitcnt lgkmcnt(6)
    v_mfma_f32_16x16x32_bf16 v[56:59], v[180:183], v[120:123], v[56:59]
    v_mfma_f32_16x16x32_bf16 v[60:63], v[180:183], v[124:127], v[60:63]
    ds_read_b128 v[176:179], v145 offset:2048
    s_cbranch_vccnz L_stub4
L_back4:
    s_setprio 0
    s_waitcnt vmcnt(8)
    s_barrier
    s_waitcnt lgkmcnt(6)
    v_mfma_f32_16x16x32_bf16 v[104:107], v[152:155], v[64:67], v[96:99]
    s_add_u32 s87, s64, 57344
    s_and_b32 s87, s87, 0x1ffff
    s_add_u32 s87, s87, s36
    s_add_u32 m0, s39, 98304
    s_add_u32 s41, s87, 0
    s_waitcnt vmcnt(4)
    buffer_load_dwordx4 v189, s[12:15], s41 offen nt lds
    v_mfma_f32_16x16x32_bf16 v[108:111], v[152:155], v[68:71], v[100:103]
    ds_read_b128 v[180:183], v145 offset:6144
    s_waitcnt lgkmcnt(6)
    v_mfma_f32_16x16x32_bf16 v[112:115], v[156:159], v[64:67], v[96:99]
    v_mfma_f32_16x16x32_bf16 v[116:119], v[156:159], v[68:71], v[100:103]
    v_add_u32 v146, 0x8000, v146
    v_add_u32 v147, 0x8000, v147
    v_add_u32 v148, 0x8000, v148
    v_add_u32 v149, 0x8000, v149
    ds_read_b64_tr_b16 v[152:153], v146
    ds_read_b64_tr_b16 v[154:155], v146 offset:4096
    v_add_f32 v136, v136, v138
    s_waitcnt lgkmcnt(7)
    v_mfma_f32_16x16x32_bf16 v[104:107], v[160:163], v[72:75], v[104:107]
    s_add_u32 m0, s39, 100224
    s_add_u32 s41, s87, 0
    s_waitcnt vmcnt(4)
    buffer_load_dwordx4 v189, s[12:15], s41 offen offset:128 nt lds
    v_mfma_f32_16x16x32_bf16 v[108:111], v[160:163], v[76:79], v[108:111]
    ds_read_b64_tr_b16 v[156:157], v147
    ds_read_b64_tr_b16 v[158:159], v147 offset:4096
    v_add_f32 v137, v137, v139
    s_waitcnt lgkmcnt(8)
    v_mfma_f32_16x16x32_bf16 v[112:115], v[164:167], v[72:75], v[112:115]
    v_mfma_f32_16x16x32_bf16 v[116:119], v[164:167], v[76:79], v[116:119]
    ds_read_b64_tr_b16 v[160:161], v148
    ds_read_b64_tr_b16 v[162:163], v148 offset:4096
    s_waitcnt lgkmcnt(9)
    v_mfma_f32_16x16x32_bf16 v[104:107], v[168:171], v[80:83], v[104:107]
    s_add_u32 m0, s39, 102400
    s_add_u32 s41, s87, 4096
    s_waitcnt vmcnt(4)
    buffer_load_dwordx4 v189, s[12:15], s41 offen nt lds
    v_mfma_f32_16x16x32_bf16 v[108:111], v[168:171], v[84:87], v[108:111]
    ds_read_b64_tr_b16 v[164:165], v149
    ds_read_b64_tr_b16 v[166:167], v149 offset:4096
    s_waitcnt lgkmcnt(10)
    v_mfma_f32_16x16x32_bf16 v[112:115], v[172:175], v[80:83], v[112:115]
    v_mfma_f32_16x16x32_bf16 v[116:119], v[172:175], v[84:87], v[116:119]
    ds_read_b64_tr_b16 v[168:169], v146 offset:2048
    ds_read_b64_tr_b16 v[170:171], v146 offset:6144
    s_waitcnt lgkmcnt(11)
    v_mfma_f32_16x16x32_bf16 v[104:107], v[176:179], v[88:91], v[104:107]
    s_add_u32 m0, s39, 104320
    s_add_u32 s41, s87, 4096
    s_waitcnt vmcnt(4)
    buffer_load_dwordx4 v189, s[12:15], s41 offen offset:128 nt lds
    v_mfma_f32_16x16x32_bf16 v[108:111], v[176:179], v[92:95], v[108:111]
    ds_read_b64_tr_b16 v[172:173], v147 offset:2048
    ds_read_b64_tr_b16 v[174:175], v147 offset:6144
    s_waitcnt lgkmcnt(12)
    v_mfma_f32_16x16x32_bf16 v[112:115], v[180:183], v[88:91], v[112:115]
    v_mfma_f32_16x16x32_bf16 v[116:119], v[180:183], v[92:95], v[116:119]
    ds_read_b64_tr_b16 v[176:177], v148 offset:2048
    ds_read_b64_tr_b16 v[178:179], v148 offset:6144
    s_setprio 1
    s_waitcnt lgkmcnt(12)
    v_mfma_f32_16x16x32_bf16 v[0:3], v[152:155], v[128:131], v[0:3]
    v_mfma_f32_16x16x32_bf16 v[4:7], v[152:155], v[132:135], v[4:7]
    ds_read_b64_tr_b16 v[180:181], v149 offset:2048
    ds_read_b64_tr_b16 v[182:183], v149 offset:6144
    s_add_u32 s87, s64, 73728
    s_and_b32 s87, s87, 0x1ffff
    s_add_u32 s87, s87, s36
    s_add_u32 m0, s39, 114688
    s_add_u32 s41, s87, 0
    s_waitcnt vmcnt(4)
    buffer_load_dwordx4 v188, s[8:11], s41 offen nt lds
    s_waitcnt lgkmcnt(12)
    v_mfma_f32_16x16x32_bf16 v[8:11], v[156:159], v[128:131], v[8:11]
    v_exp_f32 v140, v104
    v_exp_f32 v141, v105
    v_exp_f32 v142, v106
    v_mfma_f32_16x16x32_bf16 v[12:15], v[156:159], v[132:135], v[12:15]
    v_add_u32 v144, 0x8000, v144
    v_add_u32 v145, 0x8000, v145
    ds_read_b128 v[152:155], v144
    v_add_f32 v138, v140, v141
    v_cvt_pk_bf16_f32 v120, v140, v141
    v_exp_f32 v143, v107
    s_waitcnt lgkmcnt(11)
    v_mfma_f32_16x16x32_bf16 v[16:19], v[160:163], v[128:131], v[16:19]
    s_add_u32 m0, s39, 116608
    s_add_u32 s41, s87, 0
    s_waitcnt vmcnt(4)
    buffer_load_dwordx4 v188, s[8:11], s41 offen offset:128 nt lds
    v_exp_f32 v140, v108
    v_add_f32 v138, v138, v142
    v_cvt_pk_bf16_f32 v121, v142, v143
    v_add_f32 v138, v138, v143
    v_mfma_f32_16x16x32_bf16 v[20:23], v[160:163], v[132:135], v[20:23]
    ds_read_b128 v[156:159], v144 offset:4096
    v_exp_f32 v141, v109
    v_exp_f32 v142, v110
    v_add_f32 v139, v140, v141
    v_cvt_pk_bf16_f32 v124, v140, v141
    s_waitcnt lgkmcnt(10)
    v_mfma_f32_16x16x32_bf16 v[24:27], v[164:167], v[128:131], v[24:27]
    v_exp_f32 v143, v111
    v_exp_f32 v140, v112
    v_mfma_f32_16x16x32_bf16 v[28:31], v[164:167], v[132:135], v[28:31]
    ds_read_b128 v[160:163], v145
    v_add_f32 v139, v139, v142
    v_cvt_pk_bf16_f32 v125, v142, v143
    v_add_f32 v139, v139, v143
    v_exp_f32 v141, v113
    s_waitcnt lgkmcnt(9)
    v_mfma_f32_16x16x32_bf16 v[32:35], v[168:171], v[128:131], v[32:35]
    s_add_u32 m0, s39, 118784
    s_add_u32 s41, s87, 4096
    s_waitcnt vmcnt(4)
    buffer_load_dwordx4 v188, s[8:11], s41 offen nt lds
    v_exp_f32 v142, v114
    v_add_f32 v138, v138, v140
    v_cvt_pk_bf16_f32 v122, v140, v141
    v_add_f32 v138, v138, v141
    v_mfma_f32_16x16x32_bf16 v[36:39], v[168:171], v[132:135], v[36:39]
    ds_read_b128 v[164:167], v145 offset:4096
    v_exp_f32 v143, v115
    v_exp_f32 v140, v116
    v_add_f32 v138, v138, v142
    v_cvt_pk_bf16_f32 v123, v142, v143
    v_add_f32 v138, v138, v143
    s_waitcnt lgkmcnt(8)
    v_mfma_f32_16x16x32_bf16 v[40:43], v[172:175], v[128:131], v[40:43]
    v_exp_f32 v141, v117
    v_exp_f32 v142, v118
    v_mfma_f32_16x16x32_bf16 v[44:47], v[172:175], v[132:135], v[44:47]
    ds_read_b128 v[168:171], v144 offset:2048
    v_add_f32 v139, v139, v140
    v_cvt_pk_bf16_f32 v126, v140, v141
    v_add_f32 v139, v139, v141
    v_exp_f32 v143, v119
    s_waitcnt lgkmcnt(7)
    v_mfma_f32_16x16x32_bf16 v[48:51], v[176:179], v[128:131], v[48:51]
    s_add_u32 m0, s39, 120704
    s_add_u32 s41, s87, 4096
    s_waitcnt vmcnt(4)
    buffer_load_dwordx4 v188, s[8:11], s41 offen offset:128 nt lds
    v_add_f32 v139, v139, v142
    v_cvt_pk_bf16_f32 v127, v142, v143
    v_add_f32 v139, v139, v143
    v_max_f32 v185, v138, v139
    v_cmp_nge_f32 vcc, 0x46800000, v185
    v_mfma_f32_16x16x32_bf16 v[52:55], v[176:179], v[132:135], v[52:55]
    ds_read_b128 v[172:175], v144 offset:6144
    s_waitcnt lgkmcnt(6)
    v_mfma_f32_16x16x32_bf16 v[56:59], v[180:183], v[128:131], v[56:59]
    v_mfma_f32_16x16x32_bf16 v[60:63], v[180:183], v[132:135], v[60:63]
    ds_read_b128 v[176:179], v145 offset:2048
    s_cbranch_vccnz L_stub5
L_back5:
    s_setprio 0
    s_waitcnt vmcnt(8)
    s_barrier
    s_waitcnt lgkmcnt(6)
    v_mfma_f32_16x16x32_bf16 v[104:107], v[152:155], v[64:67], v[96:99]
    s_add_u32 s87, s64, 65536
    s_and_b32 s87, s87, 0x1ffff
    s_add_u32 s87, s87, s36
    s_add_u32 m0, s39, 131072
    s_add_u32 s41, s87, 0
    s_waitcnt vmcnt(4)
    buffer_load_dwordx4 v189, s[12:15], s41 offen nt lds
    v_mfma_f32_16x16x32_bf16 v[108:111], v[152:155], v[68:71], v[100:103]
    ds_read_b128 v[180:183], v145 offset:6144
    s_waitcnt lgkmcnt(6)
    v_mfma_f32_16x16x32_bf16 v[112:115], v[156:159], v[64:67], v[96:99]
    v_mfma_f32_16x16x32_bf16 v[116:119], v[156:159], v[68:71], v[100:103]
    v_add_u32 v146, 0x8000, v146
    v_add_u32 v147, 0x8000, v147
    v_add_u32 v148, 0x8000, v148
    v_add_u32 v149, 0x8000, v149
    ds_read_b64_tr_b16 v[152:153], v146
    ds_read_b64_tr_b16 v[154:155], v146 offset:4096
    v_add_f32 v136, v136, v138
    s_waitcnt lgkmcnt(7)
    v_mfma_f32_16x16x32_bf16 v[104:107], v[160:163], v[72:75], v[104:107]
    s_add_u32 m0, s39, 132992
    s_add_u32 s41, s87, 0
    s_waitcnt vmcnt(4)
    buffer_load_dwordx4 v189, s[12:15], s41 offen offset:128 nt lds
    v_mfma_f32_16x16x32_bf16 v[108:111], v[160:163], v[76:79], v[108:111]
    ds_read_b64_tr_b16 v[156:157], v147
    ds_read_b64_tr_b16 v[158:159], v147 offset:4096
    v_add_f32 v137, v137, v139
    s_waitcnt lgkmcnt(8)
    v_mfma_f32_16x16x32_bf16 v[112:115], v[164:167], v[72:75], v[112:115]
    v_mfma_f32_16x16x32_bf16 v[116:119], v[164:167], v[76:79], v[116:119]
    ds_read_b64_tr_b16 v[160:161], v148
    ds_read_b64_tr_b16 v[162:163], v148 offset:4096
    s_waitcnt lgkmcnt(9)
    v_mfma_f32_16x16x32_bf16 v[104:107], v[168:171], v[80:83], v[104:107]
    s_add_u32 m0, s39, 135168
    s_add_u32 s41, s87, 4096
    s_waitcnt vmcnt(4)
    buffer_load_dwordx4 v189, s[12:15], s41 offen nt lds
    v_mfma_f32_16x16x32_bf16 v[108:111], v[168:171], v[84:87], v[108:111]
    ds_read_b64_tr_b16 v[164:165], v149
    ds_read_b64_tr_b16 v[166:167], v149 offset:4096
    s_waitcnt lgkmcnt(10)
    v_mfma_f32_16x16x32_bf16 v[112:115], v[172:175], v[80:83], v[112:115]
    v_mfma_f32_16x16x32_bf16 v[116:119], v[172:175], v[84:87], v[116:119]
    ds_read_b64_tr_b16 v[168:169], v146 offset:2048
    ds_read_b64_tr_b16 v[170:171], v146 offset:6144
    s_waitcnt lgkmcnt(11)
    v_mfma_f32_16x16x32_bf16 v[104:107], v[176:179], v[88:91], v[104:107]
    s_add_u32 m0, s39, 137088
    s_add_u32 s41, s87, 4096
    s_waitcnt vmcnt(4)
    buffer_load_dwordx4 v189, s[12:15], s41 offen offset:128 nt lds
    v_mfma_f32_16x16x32_bf16 v[108:111], v[176:179], v[92:95], v[108:111]
    ds_read_b64_tr_b16 v[172:173], v147 offset:2048
    ds_read_b64_tr_b16 v[174:175], v147 offset:6144
    s_waitcnt lgkmcnt(12)
    v_mfma_f32_16x16x32_bf16 v[112:115], v[180:183], v[88:91], v[112:115]
    v_mfma_f32_16x16x32_bf16 v[116:119], v[180:183], v[92:95], v[116:119]
    ds_read_b64_tr_b16 v[176:177], v148 offset:2048
    ds_read_b64_tr_b16 v[178:179], v148 offset:6144
    s_setprio 1
    s_waitcnt lgkmcnt(12)
    v_mfma_f32_16x16x32_bf16 v[0:3], v[152:155], v[120:123], v[0:3]
    v_mfma_f32_16x16x32_bf16 v[4:7], v[152:155], v[124:127], v[4:7]
    ds_read_b64_tr_b16 v[180:181], v149 offset:2048
    ds_read_b64_tr_b16 v[182:183], v149 offset:6144
    s_add_u32 s87, s64, 81920
    s_and_b32 s87, s87, 0x1ffff
    s_add_u32 s87, s87, s36
    s_add_u32 m0, s39, 147456
    s_add_u32 s41, s87, 0
    s_waitcnt vmcnt(4)
    buffer_load_dwordx4 v188, s[8:11], s41 offen nt lds
    s_waitcnt lgkmcnt(12)
    v_mfma_f32_16x16x32_bf16 v[8:11], v[156:159], v[120:123], v[8:11]
    v_exp_f32 v140, v104
    v_exp_f32 v141, v105
    v_exp_f32 v142, v106
    v_mfma_f32_16x16x32_bf16 v[12:15], v[156:159], v[124:127], v[12:15]
    v_add_u32 v144, 0x8000, v144
    v_add_u32 v145, 0x8000, v145
    ds_read_b128 v[152:155], v144
    v_add_f32 v138, v140, v141
    v_cvt_pk_bf16_f32 v128, v140, v141
    v_exp_f32 v143, v107
    s_waitcnt lgkmcnt(11)
    v_mfma_f32_16x16x32_bf16 v[16:19], v[160:163], v[120:123], v[16:19]
    s_add_u32 m0, s39, 149376
    s_add_u32 s41, s87, 0
    s_waitcnt vmcnt(4)
    buffer_load_dwordx4 v188, s[8:11], s41 offen offset:128 nt lds
    v_exp_f32 v140, v108
    v_add_f32 v138, v138, v142
    v_cvt_pk_bf16_f32 v129, v142, v143
    v_add_f32 v138, v138, v143
    v_mfma_f32_16x16x32_bf16 v[20:23], v[160:163], v[124:127], v[20:23]
    ds_read_b128 v[156:159], v144 offset:4096
    v_exp_f32 v141, v109
    v_exp_f32 v142, v110
    v_add_f32 v139, v140, v141
    v_cvt_pk_bf16_f32 v132, v140, v141
    s_waitcnt lgkmcnt(10)
    v_mfma_f32_16x16x32_bf16 v[24:27], v[164:167], v[120:123], v[24:27]
    v_exp_f32 v143, v111
    v_exp_f32 v140, v112
    v_mfma_f32_16x16x32_bf16 v[28:31], v[164:167], v[124:127], v[28:31]
    ds_read_b128 v[160:163], v145
    v_add_f32 v139, v139, v142
    v_cvt_pk_bf16_f32 v133, v142, v143
    v_add_f32 v139, v139, v143
    v_exp_f32 v141, v113
    s_waitcnt lgkmcnt(9)
    v_mfma_f32_16x16x32_bf16 v[32:35], v[168:171], v[120:123], v[32:35]
    s_add_u32 m0, s39, 151552
    s_add_u32 s41, s87, 4096
    s_waitcnt vmcnt(4)
    buffer_load_dwordx4 v188, s[8:11], s41 offen nt lds
    v_exp_f32 v142, v114
    v_add_f32 v138, v138, v140
    v_cvt_pk_bf16_f32 v130, v140, v141
    v_add_f32 v138, v138, v141
    v_mfma_f32_16x16x32_bf16 v[36:39], v[168:171], v[124:127], v[36:39]
    ds_read_b128 v[164:167], v145 offset:4096
    v_exp_f32 v143, v115
    v_exp_f32 v140, v116
    v_add_f32 v138, v138, v142
    v_cvt_pk_bf16_f32 v131, v142, v143
    v_add_f32 v138, v138, v143
    s_waitcnt lgkmcnt(8)
    v_mfma_f32_16x16x32_bf16 v[40:43], v[172:175], v[120:123], v[40:43]
    v_exp_f32 v141, v117
    v_exp_f32 v142, v118
    v_mfma_f32_16x16x32_bf16 v[44:47], v[172:175], v[124:127], v[44:47]
    ds_read_b128 v[168:171], v144 offset:2048
    v_add_f32 v139, v139, v140
    v_cvt_pk_bf16_f32 v134, v140, v141
    v_add_f32 v139, v139, v141
    v_exp_f32 v143, v119
    s_waitcnt lgkmcnt(7)
    v_mfma_f32_16x16x32_bf16 v[48:51], v[176:179], v[120:123], v[48:51]
    s_add_u32 m0, s39, 153472
    s_add_u32 s41, s87, 4096
    s_waitcnt vmcnt(4)
    buffer_load_dwordx4 v188, s[8:11], s41 offen offset:128 nt lds
    v_add_f32 v139, v139, v142
    v_cvt_pk_bf16_f32 v135, v142, v143
    v_add_f32 v139, v139, v143
    v_max_f32 v185, v138, v139
    v_cmp_nge_f32 vcc, 0x46800000, v185
    v_mfma_f32_16x16x32_bf16 v[52:55], v[176:179], v[124:127], v[52:55]
    ds_read_b128 v[172:175], v144 offset:6144
    s_waitcnt lgkmcnt(6)
    v_mfma_f32_16x16x32_bf16 v[56:59], v[180:183], v[120:123], v[56:59]
    v_mfma_f32_16x16x32_bf16 v[60:63], v[180:183], v[124:127], v[60:63]
    ds_read_b128 v[176:179], v145 offset:2048
    s_cbranch_vccnz L_stub6
L_back6:
    s_setprio 0
    s_waitcnt vmcnt(8)
    s_barrier
    s_waitcnt lgkmcnt(6)
    v_mfma_f32_16x16x32_bf16 v[104:107], v[152:155], v[64:67], v[96:99]
    s_add_u32 s87, s64, 73728
    s_and_b32 s87, s87, 0x1ffff
    s_add_u32 s87, s87, s36
    s_add_u32 m0, s39, 0
    s_add_u32 s41, s87, 0
    s_waitcnt vmcnt(4)
    buffer_load_dwordx4 v189, s[12:15], s41 offen nt lds
    v_mfma_f32_16x16x32_bf16 v[108:111], v[152:155], v[68:71], v[100:103]
    ds_read_b128 v[180:183], v145 offset:6144
    s_waitcnt lgkmcnt(6)
    v_mfma_f32_16x16x32_bf16 v[112:115], v[156:159], v[64:67], v[96:99]
    v_mfma_f32_16x16x32_bf16 v[116:119], v[156:159], v[68:71], v[100:103]
    v_add_u32 v146, 0x8000, v146
    v_add_u32 v147, 0x8000, v147
    v_add_u32 v148, 0x8000, v148
    v_add_u32 v149, 0x8000, v149
    ds_read_b64_tr_b16 v[152:153], v146
    ds_read_b64_tr_b16 v[154:155], v146 offset:4096
    v_add_f32 v136, v136, v138
    s_waitcnt lgkmcnt(7)
    v_mfma_f32_16x16x32_bf16 v[104:107], v[160:163], v[72:75], v[104:107]
    s_add_u32 m0, s39, 1920
    s_add_u32 s41, s87, 0
    s_waitcnt vmcnt(4)
    buffer_load_dwordx4 v189, s[12:15], s41 offen offset:128 nt lds
    v_mfma_f32_16x16x32_bf16 v[108:111], v[160:163], v[76:79], v[108:111]
    ds_read_b64_tr_b16 v[156:157], v147
    ds_read_b64_tr_b16 v[158:159], v147 offset:4096
    v_add_f32 v137, v137, v139
    s_waitcnt lgkmcnt(8)
    v_mfma_f32_16x16x32_bf16 v[112:115], v[164:167], v[72:75], v[112:115]
    v_mfma_f32_16x16x32_bf16 v[116:119], v[164:167], v[76:79], v[116:119]
    ds_read_b64_tr_b16 v[160:161], v148
    ds_read_b64_tr_b16 v[162:163], v148 offset:4096
    s_waitcnt lgkmcnt(9)
    v_mfma_f32_16x16x32_bf16 v[104:107], v[168:171], v[80:83], v[104:107]
    s_add_u32 m0, s39, 4096
    s_add_u32 s41, s87, 4096
    s_waitcnt vmcnt(4)
    buffer_load_dwordx4 v189, s[12:15], s41 offen nt lds
    v_mfma_f32_16x16x32_bf16 v[108:111], v[168:171], v[84:87], v[108:111]
    ds_read_b64_tr_b16 v[164:165], v149
    ds_read_b64_tr_b16 v[166:167], v149 offset:4096
    s_waitcnt lgkmcnt(10)
    v_mfma_f32_16x16x32_bf16 v[112:115], v[172:175], v[80:83], v[112:115]
    v_mfma_f32_16x16x32_bf16 v[116:119], v[172:175], v[84:87], v[116:119]
    ds_read_b64_tr_b16 v[168:169], v146 offset:2048
    ds_read_b64_tr_b16 v[170:171], v146 offset:6144
    s_waitcnt lgkmcnt(11)
    v_mfma_f32_16x16x32_bf16 v[104:107], v[176:179], v[88:91], v[104:107]
    s_add_u32 m0, s39, 6016
    s_add_u32 s41, s87, 4096
    s_waitcnt vmcnt(4)
    buffer_load_dwordx4 v189, s[12:15], s41 offen offset:128 nt lds
    v_mfma_f32_16x16x32_bf16 v[108:111], v[176:179], v[92:95], v[108:111]
    ds_read_b64_tr_b16 v[172:173], v147 offset:2048
    ds_read_b64_tr_b16 v[174:175], v147 offset:6144
    s_waitcnt lgkmcnt(12)
    v_mfma_f32_16x16x32_bf16 v[112:115], v[180:183], v[88:91], v[112:115]
    v_mfma_f32_16x16x32_bf16 v[116:119], v[180:183], v[92:95], v[116:119]
    ds_read_b64_tr_b16 v[176:177], v148 offset:2048
    ds_read_b64_tr_b16 v[178:179], v148 offset:6144
    s_setprio 1
    s_waitcnt lgkmcnt(12)
    v_mfma_f32_16x16x32_bf16 v[0:3], v[152:155], v[128:131], v[0:3]
    v_mfma_f32_16x16x32_bf16 v[4:7], v[152:155], v[132:135], v[4:7]
    ds_read_b64_tr_b16 v[180:181], v149 offset:2048
    ds_read_b64_tr_b16 v[182:183], v149 offset:6144
    s_add_u32 s87, s64, 90112
    s_and_b32 s87, s87, 0x1ffff
    s_add_u32 s87, s87, s36
    s_add_u32 m0, s39, 16384
    s_add_u32 s41, s87, 0
    s_waitcnt vmcnt(4)
    buffer_load_dwordx4 v188, s[8:11], s41 offen nt lds
    s_waitcnt lgkmcnt(12)
    v_mfma_f32_16x16x32_bf16 v[8:11], v[156:159], v[128:131], v[8:11]
    v_exp_f32 v140, v104
    v_exp_f32 v141, v105
    v_exp_f32 v142, v106
    v_mfma_f32_16x16x32_bf16 v[12:15], v[156:159], v[132:135], v[12:15]
    v_add_u32 v144, 0x8000, v144
    v_add_u32 v145, 0x8000, v145
    ds_read_b128 v[152:155], v144
    v_add_f32 v138, v140, v141
    v_cvt_pk_bf16_f32 v120, v140, v141
    v_exp_f32 v143, v107
    s_waitcnt lgkmcnt(11)
    v_mfma_f32_16x16x32_bf16 v[16:19], v[160:163], v[128:131], v[16:19]
    s_add_u32 m0, s39, 18304
    s_add_u32 s41, s87, 0
    s_waitcnt vmcnt(4)
    buffer_load_dwordx4 v188, s[8:11], s41 offen offset:128 nt lds
    v_exp_f32 v140, v108
    v_add_f32 v138, v138, v142
    v_cvt_pk_bf16_f32 v121, v142, v143
    v_add_f32 v138, v138, v143
    v_mfma_f32_16x16x32_bf16 v[20:23], v[160:163], v[132:135], v[20:23]
    ds_read_b128 v[156:159], v144 offset:4096
    v_exp_f32 v141, v109
    v_exp_f32 v142, v110
    v_add_f32 v139, v140, v141
    v_cvt_pk_bf16_f32 v124, v140, v141
    s_waitcnt lgkmcnt(10)
    v_mfma_f32_16x16x32_bf16 v[24:27], v[164:167], v[128:131], v[24:27]
    v_exp_f32 v143, v111
    v_exp_f32 v140, v112
    v_mfma_f32_16x16x32_bf16 v[28:31], v[164:167], v[132:135], v[28:31]
    ds_read_b128 v[160:163], v145
    v_add_f32 v139, v139, v142
    v_cvt_pk_bf16_f32 v125, v142, v143
    v_add_f32 v139, v139, v143
    v_exp_f32 v141, v113
    s_waitcnt lgkmcnt(9)
    v_mfma_f32_16x16x32_bf16 v[32:35], v[168:171], v[128:131], v[32:35]
    s_add_u32 m0, s39, 20480
    s_add_u32 s41, s87, 4096
    s_waitcnt vmcnt(4)
    buffer_load_dwordx4 v188, s[8:11], s41 offen nt lds
    v_exp_f32 v142, v114
    v_add_f32 v138, v138, v140
    v_cvt_pk_bf16_f32 v122, v140, v141
    v_add_f32 v138, v138, v141
    v_mfma_f32_16x16x32_bf16 v[36:39], v[168:171], v[132:135], v[36:39]
    ds_read_b128 v[164:167], v145 offset:4096
    v_exp_f32 v143, v115
    v_exp_f32 v140, v116
    v_add_f32 v138, v138, v142
    v_cvt_pk_bf16_f32 v123, v142, v143
    v_add_f32 v138, v138, v143
    s_waitcnt lgkmcnt(8)
    v_mfma_f32_16x16x32_bf16 v[40:43], v[172:175], v[128:131], v[40:43]
    v_exp_f32 v141, v117
    v_exp_f32 v142, v118
    v_mfma_f32_16x16x32_bf16 v[44:47], v[172:175], v[132:135], v[44:47]
    ds_read_b128 v[168:171], v144 offset:2048
    v_add_f32 v139, v139, v140
    v_cvt_pk_bf16_f32 v126, v140, v141
    v_add_f32 v139, v139, v141
    v_exp_f32 v143, v119
    s_waitcnt lgkmcnt(7)
    v_mfma_f32_16x16x32_bf16 v[48:51], v[176:179], v[128:131], v[48:51]
    s_add_u32 m0, s39, 22400
    s_add_u32 s41, s87, 4096
    s_waitcnt vmcnt(4)
    buffer_load_dwordx4 v188, s[8:11], s41 offen offset:128 nt lds
    v_add_f32 v139, v139, v142
    v_cvt_pk_bf16_f32 v127, v142, v143
    v_add_f32 v139, v139, v143
    v_max_f32 v185, v138, v139
    v_cmp_nge_f32 vcc, 0x46800000, v185
    v_mfma_f32_16x16x32_bf16 v[52:55], v[176:179], v[132:135], v[52:55]
    ds_read_b128 v[172:175], v144 offset:6144
    s_waitcnt lgkmcnt(6)
    v_mfma_f32_16x16x32_bf16 v[56:59], v[180:183], v[128:131], v[56:59]
    v_mfma_f32_16x16x32_bf16 v[60:63], v[180:183], v[132:135], v[60:63]
    ds_read_b128 v[176:179], v145 offset:2048
    s_cbranch_vccnz L_stub7
L_back7:
    s_setprio 0
    s_waitcnt vmcnt(8)
    s_barrier
    s_waitcnt lgkmcnt(6)
    v_mfma_f32_16x16x32_bf16 v[104:107], v[152:155], v[64:67], v[96:99]
    s_lshl_b32 s42, s33, 3
    s_add_u32 s42, s42, s32
    s_cmp_lg_u32 s42, 12
    s_cbranch_scc1 L_p1
    v_mov_b32 v187, s53
    buffer_load_dword v194, v187, s[80:83], 0 offen sc1
L_p1:
    v_mfma_f32_16x16x32_bf16 v[108:111], v[152:155], v[68:71], v[100:103]
    ds_read_b128 v[180:183], v145 offset:6144
    s_waitcnt lgkmcnt(6)
    v_mfma_f32_16x16x32_bf16 v[112:115], v[156:159], v[64:67], v[96:99]
    v_mfma_f32_16x16x32_bf16 v[116:119], v[156:159], v[68:71], v[100:103]
    v_add_u32 v146, 0x8000, v146
    v_add_u32 v147, 0x8000, v147
    v_add_u32 v148, 0x8000, v148
    v_add_u32 v149, 0x8000, v149
    ds_read_b64_tr_b16 v[152:153], v146
    ds_read_b64_tr_b16 v[154:155], v146 offset:4096
    s_add_u32 s87, s64, 81920
    s_and_b32 s87, s87, 0x1ffff
    s_add_u32 s87, s87, s36
    s_add_u32 m0, s39, 32768
    s_add_u32 s41, s87, 0
    s_waitcnt vmcnt(4)
    buffer_load_dwordx4 v189, s[12:15], s41 offen nt lds
    v_add_f32 v136, v136, v138
    s_waitcnt lgkmcnt(7)
    v_mfma_f32_16x16x32_bf16 v[104:107], v[160:163], v[72:75], v[104:107]
    v_mfma_f32_16x16x32_bf16 v[108:111], v[160:163], v[76:79], v[108:111]
    ds_read_b64_tr_b16 v[156:157], v147
    ds_read_b64_tr_b16 v[158:159], v147 offset:4096
    v_add_f32 v137, v137, v139
    s_waitcnt lgkmcnt(8)
    v_mfma_f32_16x16x32_bf16 v[112:115], v[164:167], v[72:75], v[112:115]
    s_add_u32 m0, s39, 34688
    s_add_u32 s41, s87, 0
    s_waitcnt vmcnt(4)
    buffer_load_dwordx4 v189, s[12:15], s41 offen offset:128 nt lds
    v_mfma_f32_16x16x32_bf16 v[116:119], v[164:167], v[76:79], v[116:119]
    ds_read_b64_tr_b16 v[160:161], v148
    ds_read_b64_tr_b16 v[162:163], v148 offset:4096
    s_waitcnt lgkmcnt(9)
    v_mfma_f32_16x16x32_bf16 v[104:107], v[168:171], v[80:83], v[104:107]
    v_mfma_f32_16x16x32_bf16 v[108:111], v[168:171], v[84:87], v[108:111]
    ds_read_b64_tr_b16 v[164:165], v149
    ds_read_b64_tr_b16 v[166:167], v149 offset:4096
    s_add_u32 m0, s39, 36864
    s_add_u32 s41, s87, 4096
    s_waitcnt vmcnt(4)
    buffer_load_dwordx4 v189, s[12:15], s41 offen nt lds
    s_waitcnt lgkmcnt(10)
    v_mfma_f32_16x16x32_bf16 v[112:115], v[172:175], v[80:83], v[112:115]
    v_mfma_f32_16x16x32_bf16 v[116:119], v[172:175], v[84:87], v[116:119]
    ds_read_b64_tr_b16 v[168:169], v146 offset:2048
    ds_read_b64_tr_b16 v[170:171], v146 offset:6144
    s_waitcnt lgkmcnt(11)
    v_mfma_f32_16x16x32_bf16 v[104:107], v[176:179], v[88:91], v[104:107]
    s_add_u32 m0, s39, 38784
    s_add_u32 s41, s87, 4096
    s_waitcnt vmcnt(4)
    buffer_load_dwordx4 v189, s[12:15], s41 offen offset:128 nt lds
    v_mfma_f32_16x16x32_bf16 v[108:111], v[176:179], v[92:95], v[108:111]
    ds_read_b64_tr_b16 v[172:173], v147 offset:2048
    ds_read_b64_tr_b16 v[174:175], v147 offset:6144
    s_waitcnt lgkmcnt(12)
    v_mfma_f32_16x16x32_bf16 v[112:115], v[180:183], v[88:91], v[112:115]
    v_mfma_f32_16x16x32_bf16 v[116:119], v[180:183], v[92:95], v[116:119]
    ds_read_b64_tr_b16 v[176:177], v148 offset:2048
    ds_read_b64_tr_b16 v[178:179], v148 offset:6144
    s_setprio 1
    s_waitcnt lgkmcnt(12)
    v_mfma_f32_16x16x32_bf16 v[0:3], v[152:155], v[120:123], v[0:3]
    v_mfma_f32_16x16x32_bf16 v[4:7], v[152:155], v[124:127], v[4:7]
    ds_read_b64_tr_b16 v[180:181], v149 offset:2048
    ds_read_b64_tr_b16 v[182:183], v149 offset:6144
    s_add_u32 s87, s64, 98304
    s_and_b32 s87, s87, 0x1ffff
    s_add_u32 s87, s87, s36
    s_add_u32 m0, s39, 49152
    s_add_u32 s41, s87, 0
    s_waitcnt vmcnt(4)
    buffer_load_dwordx4 v188, s[8:11], s41 offen nt lds
    s_waitcnt lgkmcnt(12)
    v_mfma_f32_16x16x32_bf16 v[8:11], v[156:159], v[120:123], v[8:11]
    v_exp_f32 v140, v104
    v_exp_f32 v141, v105
    v_exp_f32 v142, v106
    v_mfma_f32_16x16x32_bf16 v[12:15], v[156:159], v[124:127], v[12:15]
    v_add_u32 v144, 0x8000, v144
    v_add_u32 v145, 0x8000, v145
    ds_read_b128 v[152:155], v144
    v_add_f32 v138, v140, v141
    v_cvt_pk_bf16_f32 v128, v140, v141
    v_exp_f32 v143, v107
    s_waitcnt lgkmcnt(11)
    v_mfma_f32_16x16x32_bf16 v[16:19], v[160:163], v[120:123], v[16:19]
    s_add_u32 m0, s39, 51072
    s_add_u32 s41, s87, 0
    s_waitcnt vmcnt(4)
    buffer_load_dwordx4 v188, s[8:11], s41 offen offset:128 nt lds
    v_exp_f32 v140, v108
    v_add_f32 v138, v138, v142
    v_cvt_pk_bf16_f32 v129, v142, v143
    v_add_f32 v138, v138, v143
    v_mfma_f32_16x16x32_bf16 v[20:23], v[160:163], v[124:127], v[20:23]
    ds_read_b128 v[156:159], v144 offset:4096
    v_exp_f32 v141, v109
    v_exp_f32 v142, v110
    v_add_f32 v139, v140, v141
    v_cvt_pk_bf16_f32 v132, v140, v141
    s_waitcnt lgkmcnt(10)
    v_mfma_f32_16x16x32_bf16 v[24:27], v[164:167], v[120:123], v[24:27]
    v_exp_f32 v143, v111
    v_exp_f32 v140, v112
    v_mfma_f32_16x16x32_bf16 v[28:31], v[164:167], v[124:127], v[28:31]
    ds_read_b128 v[160:163], v145
    v_add_f32 v139, v139, v142
    v_cvt_pk_bf16_f32 v133, v142, v143
    v_add_f32 v139, v139, v143
    v_exp_f32 v141, v113
    s_waitcnt lgkmcnt(9)
    v_mfma_f32_16x16x32_bf16 v[32:35], v[168:171], v[120:123], v[32:35]
    s_add_u32 m0, s39, 53248
    s_add_u32 s41, s87, 4096
    s_waitcnt vmcnt(4)
    buffer_load_dwordx4 v188, s[8:11], s41 offen nt lds
    v_exp_f32 v142, v114
    v_add_f32 v138, v138, v140
    v_cvt_pk_bf16_f32 v130, v140, v141
    v_add_f32 v138, v138, v141
    v_mfma_f32_16x16x32_bf16 v[36:39], v[168:171], v[124:127], v[36:39]
    ds_read_b128 v[164:167], v145 offset:4096
    v_exp_f32 v143, v115
    v_exp_f32 v140, v116
    v_add_f32 v138, v138, v142
    v_cvt_pk_bf16_f32 v131, v142, v143
    v_add_f32 v138, v138, v143
    s_waitcnt lgkmcnt(8)
    v_mfma_f32_16x16x32_bf16 v[40:43], v[172:175], v[120:123], v[40:43]
    v_exp_f32 v141, v117
    v_exp_f32 v142, v118
    v_mfma_f32_16x16x32_bf16 v[44:47], v[172:175], v[124:127], v[44:47]
    ds_read_b128 v[168:171], v144 offset:2048
    v_add_f32 v139, v139, v140
    v_cvt_pk_bf16_f32 v134, v140, v141
    v_add_f32 v139, v139, v141
    v_exp_f32 v143, v119
    s_waitcnt lgkmcnt(7)
    v_mfma_f32_16x16x32_bf16 v[48:51], v[176:179], v[120:123], v[48:51]
    s_add_u32 m0, s39, 55168
    s_add_u32 s41, s87, 4096
    s_waitcnt vmcnt(4)
    buffer_load_dwordx4 v188, s[8:11], s41 offen offset:128 nt lds
    v_add_f32 v139, v139, v142
    v_cvt_pk_bf16_f32 v135, v142, v143
    v_add_f32 v139, v139, v143
    v_max_f32 v185, v138, v139
    v_cmp_nge_f32 vcc, 0x46800000, v185
    v_mfma_f32_16x16x32_bf16 v[52:55], v[176:179], v[124:127], v[52:55]
    ds_read_b128 v[172:175], v144 offset:6144
    s_waitcnt lgkmcnt(6)
    v_mfma_f32_16x16x32_bf16 v[56:59], v[180:183], v[120:123], v[56:59]
    v_mfma_f32_16x16x32_bf16 v[60:63], v[180:183], v[124:127], v[60:63]
    ds_read_b128 v[176:179], v145 offset:2048
    s_cbranch_vccnz L_stub8
L_back8:
    s_setprio 0
    s_waitcnt vmcnt(8)
    s_barrier
    s_waitcnt lgkmcnt(6)
    v_mfma_f32_16x16x32_bf16 v[104:107], v[152:155], v[64:67], v[96:99]
    s_add_u32 s87, s64, 90112
    s_and_b32 s87, s87, 0x1ffff
    s_add_u32 s87, s87, s36
    s_add_u32 m0, s39, 65536
    s_add_u32 s41, s87, 0
    s_waitcnt vmcnt(4)
    buffer_load_dwordx4 v189, s[12:15], s41 offen nt lds
    v_mfma_f32_16x16x32_bf16 v[108:111], v[152:155], v[68:71], v[100:103]
    ds_read_b128 v[180:183], v145 offset:6144
    s_waitcnt lgkmcnt(6)
    v_mfma_f32_16x16x32_bf16 v[112:115], v[156:159], v[64:67], v[96:99]
    v_mfma_f32_16x16x32_bf16 v[116:119], v[156:159], v[68:71], v[100:103]
    v_add_u32 v146, 0xfffe0000, v146
    v_add_u32 v147, 0xfffe0000, v147
    v_add_u32 v148, 0xfffe0000, v148
    v_add_u32 v149, 0xfffe0000, v149
    ds_read_b64_tr_b16 v[152:153], v146
    ds_read_b64_tr_b16 v[154:155], v146 offset:4096
    v_add_f32 v136, v136, v138
    s_waitcnt lgkmcnt(7)
    v_mfma_f32_16x16x32_bf16 v[104:107], v[160:163], v[72:75], v[104:107]
    s_add_u32 m0, s39, 67456
    s_add_u32 s41, s87, 0
    s_waitcnt vmcnt(4)
    buffer_load_dwordx4 v189, s[12:15], s41 offen offset:128 nt lds
    v_mfma_f32_16x16x32_bf16 v[108:111], v[160:163], v[76:79], v[108:111]
    ds_read_b64_tr_b16 v[156:157], v147
    ds_read_b64_tr_b16 v[158:159], v147 offset:4096
    v_add_f32 v137, v137, v139
    s_waitcnt lgkmcnt(8)
    v_mfma_f32_16x16x32_bf16 v[112:115], v[164:167], v[72:75], v[112:115]
    v_mfma_f32_16x16x32_bf16 v[116:119], v[164:167], v[76:79], v[116:119]
    ds_read_b64_tr_b16 v[160:161], v148
    ds_read_b64_tr_b16 v[162:163], v148 offset:4096
    s_waitcnt lgkmcnt(9)
    v_mfma_f32_16x16x32_bf16 v[104:107], v[168:171], v[80:83], v[104:107]
    s_add_u32 m0, s39, 69632
    s_add_u32 s41, s87, 4096
    s_waitcnt vmcnt(4)
    buffer_load_dwordx4 v189, s[12:15], s41 offen nt lds
    v_mfma_f32_16x16x32_bf16 v[108:111], v[168:171], v[84:87], v[108:111]
    ds_read_b64_tr_b16 v[164:165], v149
    ds_read_b64_tr_b16 v[166:167], v149 offset:4096
    s_waitcnt lgkmcnt(10)
    v_mfma_f32_16x16x32_bf16 v[112:115], v[172:175], v[80:83], v[112:115]
    v_mfma_f32_16x16x32_bf16 v[116:119], v[172:175], v[84:87], v[116:119]
    ds_read_b64_tr_b16 v[168:169], v146 offset:2048
    ds_read_b64_tr_b16 v[170:171], v146 offset:6144
    s_waitcnt lgkmcnt(11)
    v_mfma_f32_16x16x32_bf16 v[104:107], v[176:179], v[88:91], v[104:107]
    s_add_u32 m0, s39, 71552
    s_add_u32 s41, s87, 4096
    s_waitcnt vmcnt(4)
    buffer_load_dwordx4 v189, s[12:15], s41 offen offset:128 nt lds
    v_mfma_f32_16x16x32_bf16 v[108:111], v[176:179], v[92:95], v[108:111]
    ds_read_b64_tr_b16 v[172:173], v147 offset:2048
    ds_read_b64_tr_b16 v[174:175], v147 offset:6144
    s_waitcnt lgkmcnt(12)
    v_mfma_f32_16x16x32_bf16 v[112:115], v[180:183], v[88:91], v[112:115]
    v_mfma_f32_16x16x32_bf16 v[116:119], v[180:183], v[92:95], v[116:119]
    ds_read_b64_tr_b16 v[176:177], v148 offset:2048
    ds_read_b64_tr_b16 v[178:179], v148 offset:6144
    s_setprio 1
    s_waitcnt lgkmcnt(12)
    v_mfma_f32_16x16x32_bf16 v[0:3], v[152:155], v[128:131], v[0:3]
    v_mfma_f32_16x16x32_bf16 v[4:7], v[152:155], v[132:135], v[4:7]
    ds_read_b64_tr_b16 v[180:181], v149 offset:2048
    ds_read_b64_tr_b16 v[182:183], v149 offset:6144
    s_add_u32 s87, s64, 106496
    s_and_b32 s87, s87, 0x1ffff
    s_add_u32 s87, s87, s36
    s_add_u32 m0, s39, 81920
    s_add_u32 s41, s87, 0
    s_waitcnt vmcnt(4)
    buffer_load_dwordx4 v188, s[8:11], s41 offen nt lds
    s_waitcnt lgkmcnt(12)
    v_mfma_f32_16x16x32_bf16 v[8:11], v[156:159], v[128:131], v[8:11]
    v_exp_f32 v140, v104
    v_exp_f32 v141, v105
    v_exp_f32 v142, v106
    v_mfma_f32_16x16x32_bf16 v[12:15], v[156:159], v[132:135], v[12:15]
    v_add_u32 v144, 0xfffe0000, v144
    v_add_u32 v145, 0xfffe0000, v145
    ds_read_b128 v[152:155], v144
    v_add_f32 v138, v140, v141
    v_cvt_pk_bf16_f32 v120, v140, v141
    v_exp_f32 v143, v107
    s_waitcnt lgkmcnt(11)
    v_mfma_f32_16x16x32_bf16 v[16:19], v[160:163], v[128:131], v[16:19]
    s_add_u32 m0, s39, 83840
    s_add_u32 s41, s87, 0
    s_waitcnt vmcnt(4)
    buffer_load_dwordx4 v188, s[8:11], s41 offen offset:128 nt lds
    v_exp_f32 v140, v108
    v_add_f32 v138, v138, v142
    v_cvt_pk_bf16_f32 v121, v142, v143
    v_add_f32 v138, v138, v143
    v_mfma_f32_16x16x32_bf16 v[20:23], v[160:163], v[132:135], v[20:23]
    ds_read_b128 v[156:159], v144 offset:4096
    v_exp_f32 v141, v109
    v_exp_f32 v142, v110
    v_add_f32 v139, v140, v141
    v_cvt_pk_bf16_f32 v124, v140, v141
    s_waitcnt lgkmcnt(10)
    v_mfma_f32_16x16x32_bf16 v[24:27], v[164:167], v[128:131], v[24:27]
    v_exp_f32 v143, v111
    v_exp_f32 v140, v112
    v_mfma_f32_16x16x32_bf16 v[28:31], v[164:167], v[132:135], v[28:31]
    ds_read_b128 v[160:163], v145
    v_add_f32 v139, v139, v142
    v_cvt_pk_bf16_f32 v125, v142, v143
    v_add_f32 v139, v139, v143
    v_exp_f32 v141, v113
    s_waitcnt lgkmcnt(9)
    v_mfma_f32_16x16x32_bf16 v[32:35], v[168:171], v[128:131], v[32:35]
    s_add_u32 m0, s39, 86016
    s_add_u32 s41, s87, 4096
    s_waitcnt vmcnt(4)
    buffer_load_dwordx4 v188, s[8:11], s41 offen nt lds
    v_exp_f32 v142, v114
    v_add_f32 v138, v138, v140
    v_cvt_pk_bf16_f32 v122, v140, v141
    v_add_f32 v138, v138, v141
    v_mfma_f32_16x16x32_bf16 v[36:39], v[168:171], v[132:135], v[36:39]
    ds_read_b128 v[164:167], v145 offset:4096
    v_exp_f32 v143, v115
    v_exp_f32 v140, v116
    v_add_f32 v138, v138, v142
    v_cvt_pk_bf16_f32 v123, v142, v143
    v_add_f32 v138, v138, v143
    s_waitcnt lgkmcnt(8)
    v_mfma_f32_16x16x32_bf16 v[40:43], v[172:175], v[128:131], v[40:43]
    v_exp_f32 v141, v117
    v_exp_f32 v142, v118
    v_mfma_f32_16x16x32_bf16 v[44:47], v[172:175], v[132:135], v[44:47]
    ds_read_b128 v[168:171], v144 offset:2048
    v_add_f32 v139, v139, v140
    v_cvt_pk_bf16_f32 v126, v140, v141
    v_add_f32 v139, v139, v141
    v_exp_f32 v143, v119
    s_waitcnt lgkmcnt(7)
    v_mfma_f32_16x16x32_bf16 v[48:51], v[176:179], v[128:131], v[48:51]
    s_add_u32 m0, s39, 87936
    s_add_u32 s41, s87, 4096
    s_waitcnt vmcnt(4)
    buffer_load_dwordx4 v188, s[8:11], s41 offen offset:128 nt lds
    v_add_f32 v139, v139, v142
    v_cvt_pk_bf16_f32 v127, v142, v143
    v_add_f32 v139, v139, v143
    v_max_f32 v185, v138, v139
    v_cmp_nge_f32 vcc, 0x46800000, v185
    v_mfma_f32_16x16x32_bf16 v[52:55], v[176:179], v[132:135], v[52:55]
    ds_read_b128 v[172:175], v144 offset:6144
    s_waitcnt lgkmcnt(6)
    v_mfma_f32_16x16x32_bf16 v[56:59], v[180:183], v[128:131], v[56:59]
    v_mfma_f32_16x16x32_bf16 v[60:63], v[180:183], v[132:135], v[60:63]
    ds_read_b128 v[176:179], v145 offset:2048
    s_cbranch_vccnz L_stub9
L_back9:
    s_setprio 0
    s_waitcnt vmcnt(8)
    s_barrier
    s_waitcnt lgkmcnt(6)
    v_mfma_f32_16x16x32_bf16 v[104:107], v[152:155], v[64:67], v[96:99]
    s_add_u32 s87, s64, 98304
    s_and_b32 s87, s87, 0x1ffff
    s_add_u32 s87, s87, s36
    s_add_u32 m0, s39, 98304
    s_add_u32 s41, s87, 0
    s_waitcnt vmcnt(4)
    buffer_load_dwordx4 v189, s[12:15], s41 offen nt lds
    v_mfma_f32_16x16x32_bf16 v[108:111], v[152:155], v[68:71], v[100:103]
    ds_read_b128 v[180:183], v145 offset:6144
    s_waitcnt lgkmcnt(6)
    v_mfma_f32_16x16x32_bf16 v[112:115], v[156:159], v[64:67], v[96:99]
    v_mfma_f32_16x16x32_bf16 v[116:119], v[156:159], v[68:71], v[100:103]
    v_add_u32 v146, 0x8000, v146
    v_add_u32 v147, 0x8000, v147
    v_add_u32 v148, 0x8000, v148
    v_add_u32 v149, 0x8000, v149
    ds_read_b64_tr_b16 v[152:153], v146
    ds_read_b64_tr_b16 v[154:155], v146 offset:4096
    v_add_f32 v136, v136, v138
    s_waitcnt lgkmcnt(7)
    v_mfma_f32_16x16x32_bf16 v[104:107], v[160:163], v[72:75], v[104:107]
    s_add_u32 m0, s39, 100224
    s_add_u32 s41, s87, 0
    s_waitcnt vmcnt(4)
    buffer_load_dwordx4 v189, s[12:15], s41 offen offset:128 nt lds
    v_mfma_f32_16x16x32_bf16 v[108:111], v[160:163], v[76:79], v[108:111]
    ds_read_b64_tr_b16 v[156:157], v147
    ds_read_b64_tr_b16 v[158:159], v147 offset:4096
    v_add_f32 v137, v137, v139
    s_waitcnt lgkmcnt(8)
    v_mfma_f32_16x16x32_bf16 v[112:115], v[164:167], v[72:75], v[112:115]
    v_mfma_f32_16x16x32_bf16 v[116:119], v[164:167], v[76:79], v[116:119]
    ds_read_b64_tr_b16 v[160:161], v148
    ds_read_b64_tr_b16 v[162:163], v148 offset:4096
    s_waitcnt lgkmcnt(9)
    v_mfma_f32_16x16x32_bf16 v[104:107], v[168:171], v[80:83], v[104:107]
    s_add_u32 m0, s39, 102400
    s_add_u32 s41, s87, 4096
    s_waitcnt vmcnt(4)
    buffer_load_dwordx4 v189, s[12:15], s41 offen nt lds
    v_mfma_f32_16x16x32_bf16 v[108:111], v[168:171], v[84:87], v[108:111]
    ds_read_b64_tr_b16 v[164:165], v149
    ds_read_b64_tr_b16 v[166:167], v149 offset:4096
    s_waitcnt lgkmcnt(10)
    v_mfma_f32_16x16x32_bf16 v[112:115], v[172:175], v[80:83], v[112:115]
    v_mfma_f32_16x16x32_bf16 v[116:119], v[172:175], v[84:87], v[116:119]
    ds_read_b64_tr_b16 v[168:169], v146 offset:2048
    ds_read_b64_tr_b16 v[170:171], v146 offset:6144
    s_waitcnt lgkmcnt(11)
    v_mfma_f32_16x16x32_bf16 v[104:107], v[176:179], v[88:91], v[104:107]
    s_add_u32 m0, s39, 104320
    s_add_u32 s41, s87, 4096
    s_waitcnt vmcnt(4)
    buffer_load_dwordx4 v189, s[12:15], s41 offen offset:128 nt lds
    v_mfma_f32_16x16x32_bf16 v[108:111], v[176:179], v[92:95], v[108:111]
    ds_read_b64_tr_b16 v[172:173], v147 offset:2048
    ds_read_b64_tr_b16 v[174:175], v147 offset:6144
    s_waitcnt lgkmcnt(12)
    v_mfma_f32_16x16x32_bf16 v[112:115], v[180:183], v[88:91], v[112:115]
    v_mfma_f32_16x16x32_bf16 v[116:119], v[180:183], v[92:95], v[116:119]
    ds_read_b64_tr_b16 v[176:177], v148 offset:2048
    ds_read_b64_tr_b16 v[178:179], v148 offset:6144
    s_setprio 1
    s_waitcnt lgkmcnt(12)
    v_mfma_f32_16x16x32_bf16 v[0:3], v[152:155], v[120:123], v[0:3]
    v_mfma_f32_16x16x32_bf16 v[4:7], v[152:155], v[124:127], v[4:7]
    ds_read_b64_tr_b16 v[180:181], v149 offset:2048
    ds_read_b64_tr_b16 v[182:183], v149 offset:6144
    s_add_u32 s87, s64, 114688
    s_and_b32 s87, s87, 0x1ffff
    s_add_u32 s87, s87, s36
    s_add_u32 m0, s39, 114688
    s_add_u32 s41, s87, 0
    s_waitcnt vmcnt(4)
    buffer_load_dwordx4 v188, s[8:11], s41 offen nt lds
    s_waitcnt lgkmcnt(12)
    v_mfma_f32_16x16x32_bf16 v[8:11], v[156:159], v[120:123], v[8:11]
    v_exp_f32 v140, v104
    v_exp_f32 v141, v105
    v_exp_f32 v142, v106
    v_mfma_f32_16x16x32_bf16 v[12:15], v[156:159], v[124:127], v[12:15]
    v_add_u32 v144, 0x8000, v144
    v_add_u32 v145, 0x8000, v145
    ds_read_b128 v[152:155], v144
    v_add_f32 v138, v140, v141
    v_cvt_pk_bf16_f32 v128, v140, v141
    v_exp_f32 v143, v107
    s_waitcnt lgkmcnt(11)
    v_mfma_f32_16x16x32_bf16 v[16:19], v[160:163], v[120:123], v[16:19]
    s_add_u32 m0, s39, 116608
    s_add_u32 s41, s87, 0
    s_waitcnt vmcnt(4)
    buffer_load_dwordx4 v188, s[8:11], s41 offen offset:128 nt lds
    v_exp_f32 v140, v108
    v_add_f32 v138, v138, v142
    v_cvt_pk_bf16_f32 v129, v142, v143
    v_add_f32 v138, v138, v143
    v_mfma_f32_16x16x32_bf16 v[20:23], v[160:163], v[124:127], v[20:23]
    ds_read_b128 v[156:159], v144 offset:4096
    v_exp_f32 v141, v109
    v_exp_f32 v142, v110
    v_add_f32 v139, v140, v141
    v_cvt_pk_bf16_f32 v132, v140, v141
    s_waitcnt lgkmcnt(10)
    v_mfma_f32_16x16x32_bf16 v[24:27], v[164:167], v[120:123], v[24:27]
    v_exp_f32 v143, v111
    v_exp_f32 v140, v112
    v_mfma_f32_16x16x32_bf16 v[28:31], v[164:167], v[124:127], v[28:31]
    ds_read_b128 v[160:163], v145
    v_add_f32 v139, v139, v142
    v_cvt_pk_bf16_f32 v133, v142, v143
    v_add_f32 v139, v139, v143
    v_exp_f32 v141, v113
    s_waitcnt lgkmcnt(9)
    v_mfma_f32_16x16x32_bf16 v[32:35], v[168:171], v[120:123], v[32:35]
    s_add_u32 m0, s39, 118784
    s_add_u32 s41, s87, 4096
    s_waitcnt vmcnt(4)
    buffer_load_dwordx4 v188, s[8:11], s41 offen nt lds
    v_exp_f32 v142, v114
    v_add_f32 v138, v138, v140
    v_cvt_pk_bf16_f32 v130, v140, v141
    v_add_f32 v138, v138, v141
    v_mfma_f32_16x16x32_bf16 v[36:39], v[168:171], v[124:127], v[36:39]
    ds_read_b128 v[164:167], v145 offset:4096
    v_exp_f32 v143, v115
    v_exp_f32 v140, v116
    v_add_f32 v138, v138, v142
    v_cvt_pk_bf16_f32 v131, v142, v143
    v_add_f32 v138, v138, v143
    s_waitcnt lgkmcnt(8)
    v_mfma_f32_16x16x32_bf16 v[40:43], v[172:175], v[120:123], v[40:43]
    v_exp_f32 v141, v117
    v_exp_f32 v142, v118
    v_mfma_f32_16x16x32_bf16 v[44:47], v[172:175], v[124:127], v[44:47]
    ds_read_b128 v[168:171], v144 offset:2048
    v_add_f32 v139, v139, v140
    v_cvt_pk_bf16_f32 v134, v140, v141
    v_add_f32 v139, v139, v141
    v_exp_f32 v143, v119
    s_waitcnt lgkmcnt(7)
    v_mfma_f32_16x16x32_bf16 v[48:51], v[176:179], v[120:123], v[48:51]
    s_add_u32 m0, s39, 120704
    s_add_u32 s41, s87, 4096
    s_waitcnt vmcnt(4)
    buffer_load_dwordx4 v188, s[8:11], s41 offen offset:128 nt lds
    v_add_f32 v139, v139, v142
    v_cvt_pk_bf16_f32 v135, v142, v143
    v_add_f32 v139, v139, v143
    v_max_f32 v185, v138, v139
    v_cmp_nge_f32 vcc, 0x46800000, v185
    v_mfma_f32_16x16x32_bf16 v[52:55], v[176:179], v[124:127], v[52:55]
    ds_read_b128 v[172:175], v144 offset:6144
    s_waitcnt lgkmcnt(6)
    v_mfma_f32_16x16x32_bf16 v[56:59], v[180:183], v[120:123], v[56:59]
    v_mfma_f32_16x16x32_bf16 v[60:63], v[180:183], v[124:127], v[60:63]
    ds_read_b128 v[176:179], v145 offset:2048
    s_cbranch_vccnz L_stub10
L_back10:
    s_setprio 0
    s_waitcnt vmcnt(8)
    s_barrier
    s_waitcnt lgkmcnt(6)
    v_mfma_f32_16x16x32_bf16 v[104:107], v[152:155], v[64:67], v[96:99]
    s_add_u32 s87, s64, 106496
    s_and_b32 s87, s87, 0x1ffff
    s_add_u32 s87, s87, s36
    s_add_u32 m0, s39, 131072
    s_add_u32 s41, s87, 0
    s_waitcnt vmcnt(4)
    buffer_load_dwordx4 v189, s[12:15], s41 offen nt lds
    v_mfma_f32_16x16x32_bf16 v[108:111], v[152:155], v[68:71], v[100:103]
    ds_read_b128 v[180:183], v145 offset:6144
    s_waitcnt lgkmcnt(6)
    v_mfma_f32_16x16x32_bf16 v[112:115], v[156:159], v[64:67], v[96:99]
    v_mfma_f32_16x16x32_bf16 v[116:119], v[156:159], v[68:71], v[100:103]
    v_add_u32 v146, 0x8000, v146
    v_add_u32 v147, 0x8000, v147
    v_add_u32 v148, 0x8000, v148
    v_add_u32 v149, 0x8000, v149
    ds_read_b64_tr_b16 v[152:153], v146
    ds_read_b64_tr_b16 v[154:155], v146 offset:4096
    v_add_f32 v136, v136, v138
    s_waitcnt lgkmcnt(7)
    v_mfma_f32_16x16x32_bf16 v[104:107], v[160:163], v[72:75], v[104:107]
    s_add_u32 m0, s39, 132992
    s_add_u32 s41, s87, 0
    s_waitcnt vmcnt(4)
    buffer_load_dwordx4 v189, s[12:15], s41 offen offset:128 nt lds
    v_mfma_f32_16x16x32_bf16 v[108:111], v[160:163], v[76:79], v[108:111]
    ds_read_b64_tr_b16 v[156:157], v147
    ds_read_b64_tr_b16 v[158:159], v147 offset:4096
    v_add_f32 v137, v137, v139
    s_waitcnt lgkmcnt(8)
    v_mfma_f32_16x16x32_bf16 v[112:115], v[164:167], v[72:75], v[112:115]
    v_mfma_f32_16x16x32_bf16 v[116:119], v[164:167], v[76:79], v[116:119]
    ds_read_b64_tr_b16 v[160:161], v148
    ds_read_b64_tr_b16 v[162:163], v148 offset:4096
    s_waitcnt lgkmcnt(9)
    v_mfma_f32_16x16x32_bf16 v[104:107], v[168:171], v[80:83], v[104:107]
    s_add_u32 m0, s39, 135168
    s_add_u32 s41, s87, 4096
    s_waitcnt vmcnt(4)
    buffer_load_dwordx4 v189, s[12:15], s41 offen nt lds
    v_mfma_f32_16x16x32_bf16 v[108:111], v[168:171], v[84:87], v[108:111]
    ds_read_b64_tr_b16 v[164:165], v149
    ds_read_b64_tr_b16 v[166:167], v149 offset:4096
    s_waitcnt lgkmcnt(10)
    v_mfma_f32_16x16x32_bf16 v[112:115], v[172:175], v[80:83], v[112:115]
    v_mfma_f32_16x16x32_bf16 v[116:119], v[172:175], v[84:87], v[116:119]
    ds_read_b64_tr_b16 v[168:169], v146 offset:2048
    ds_read_b64_tr_b16 v[170:171], v146 offset:6144
    s_waitcnt lgkmcnt(11)
    v_mfma_f32_16x16x32_bf16 v[104:107], v[176:179], v[88:91], v[104:107]
    s_add_u32 m0, s39, 137088
    s_add_u32 s41, s87, 4096
    s_waitcnt vmcnt(4)
    buffer_load_dwordx4 v189, s[12:15], s41 offen offset:128 nt lds
    v_mfma_f32_16x16x32_bf16 v[108:111], v[176:179], v[92:95], v[108:111]
    ds_read_b64_tr_b16 v[172:173], v147 offset:2048
    ds_read_b64_tr_b16 v[174:175], v147 offset:6144
    s_waitcnt lgkmcnt(12)
    v_mfma_f32_16x16x32_bf16 v[112:115], v[180:183], v[88:91], v[112:115]
    v_mfma_f32_16x16x32_bf16 v[116:119], v[180:183], v[92:95], v[116:119]
    ds_read_b64_tr_b16 v[176:177], v148 offset:2048
    ds_read_b64_tr_b16 v[178:179], v148 offset:6144
    s_setprio 1
    s_waitcnt lgkmcnt(12)
    v_mfma_f32_16x16x32_bf16 v[0:3], v[152:155], v[128:131], v[0:3]
    v_mfma_f32_16x16x32_bf16 v[4:7], v[152:155], v[132:135], v[4:7]
    ds_read_b64_tr_b16 v[180:181], v149 offset:2048
    ds_read_b64_tr_b16 v[182:183], v149 offset:6144
    s_add_u32 s87, s64, 122880
    s_and_b32 s87, s87, 0x1ffff
    s_add_u32 s87, s87, s36
    s_add_u32 m0, s39, 147456
    s_add_u32 s41, s87, 0
    s_waitcnt vmcnt(4)
    buffer_load_dwordx4 v188, s[8:11], s41 offen nt lds
    s_waitcnt lgkmcnt(12)
    v_mfma_f32_16x16x32_bf16 v[8:11], v[156:159], v[128:131], v[8:11]
    v_exp_f32 v140, v104
    v_exp_f32 v141, v105
    v_exp_f32 v142, v106
    v_mfma_f32_16x16x32_bf16 v[12:15], v[156:159], v[132:135], v[12:15]
    v_add_u32 v144, 0x8000, v144
    v_add_u32 v145, 0x8000, v145
    ds_read_b128 v[152:155], v144
    v_add_f32 v138, v140, v141
    v_cvt_pk_bf16_f32 v120, v140, v141
    v_exp_f32 v143, v107
    s_waitcnt lgkmcnt(11)
    v_mfma_f32_16x16x32_bf16 v[16:19], v[160:163], v[128:131], v[16:19]
    s_add_u32 m0, s39, 149376
    s_add_u32 s41, s87, 0
    s_waitcnt vmcnt(4)
    buffer_load_dwordx4 v188, s[8:11], s41 offen offset:128 nt lds
    v_exp_f32 v140, v108
    v_add_f32 v138, v138, v142
    v_cvt_pk_bf16_f32 v121, v142, v143
    v_add_f32 v138, v138, v143
    v_mfma_f32_16x16x32_bf16 v[20:23], v[160:163], v[132:135], v[20:23]
    ds_read_b128 v[156:159], v144 offset:4096
    v_exp_f32 v141, v109
    v_exp_f32 v142, v110
    v_add_f32 v139, v140, v141
    v_cvt_pk_bf16_f32 v124, v140, v141
    s_waitcnt lgkmcnt(10)
    v_mfma_f32_16x16x32_bf16 v[24:27], v[164:167], v[128:131], v[24:27]
    v_exp_f32 v143, v111
    v_exp_f32 v140, v112
    v_mfma_f32_16x16x32_bf16 v[28:31], v[164:167], v[132:135], v[28:31]
    ds_read_b128 v[160:163], v145
    v_add_f32 v139, v139, v142
    v_cvt_pk_bf16_f32 v125, v142, v143
    v_add_f32 v139, v139, v143
    v_exp_f32 v141, v113
    s_waitcnt lgkmcnt(9)
    v_mfma_f32_16x16x32_bf16 v[32:35], v[168:171], v[128:131], v[32:35]
    s_add_u32 m0, s39, 151552
    s_add_u32 s41, s87, 4096
    s_waitcnt vmcnt(4)
    buffer_load_dwordx4 v188, s[8:11], s41 offen nt lds
    v_exp_f32 v142, v114
    v_add_f32 v138, v138, v140
    v_cvt_pk_bf16_f32 v122, v140, v141
    v_add_f32 v138, v138, v141
    v_mfma_f32_16x16x32_bf16 v[36:39], v[168:171], v[132:135], v[36:39]
    ds_read_b128 v[164:167], v145 offset:4096
    v_exp_f32 v143, v115
    v_exp_f32 v140, v116
    v_add_f32 v138, v138, v142
    v_cvt_pk_bf16_f32 v123, v142, v143
    v_add_f32 v138, v138, v143
    s_waitcnt lgkmcnt(8)
    v_mfma_f32_16x16x32_bf16 v[40:43], v[172:175], v[128:131], v[40:43]
    v_exp_f32 v141, v117
    v_exp_f32 v142, v118
    v_mfma_f32_16x16x32_bf16 v[44:47], v[172:175], v[132:135], v[44:47]
    ds_read_b128 v[168:171], v144 offset:2048
    v_add_f32 v139, v139, v140
    v_cvt_pk_bf16_f32 v126, v140, v141
    v_add_f32 v139, v139, v141
    v_exp_f32 v143, v119
    s_waitcnt lgkmcnt(7)
    v_mfma_f32_16x16x32_bf16 v[48:51], v[176:179], v[128:131], v[48:51]
    s_add_u32 m0, s39, 153472
    s_add_u32 s41, s87, 4096
    s_waitcnt vmcnt(4)
    buffer_load_dwordx4 v188, s[8:11], s41 offen offset:128 nt lds
    v_add_f32 v139, v139, v142
    v_cvt_pk_bf16_f32 v127, v142, v143
    v_add_f32 v139, v139, v143
    v_max_f32 v185, v138, v139
    v_cmp_nge_f32 vcc, 0x46800000, v185
    v_mfma_f32_16x16x32_bf16 v[52:55], v[176:179], v[132:135], v[52:55]
    ds_read_b128 v[172:175], v144 offset:6144
    s_waitcnt lgkmcnt(6)
    v_mfma_f32_16x16x32_bf16 v[56:59], v[180:183], v[128:131], v[56:59]
    v_mfma_f32_16x16x32_bf16 v[60:63], v[180:183], v[132:135], v[60:63]
    ds_read_b128 v[176:179], v145 offset:2048
    s_cbranch_vccnz L_stub11
L_back11:
    s_setprio 0
    s_waitcnt vmcnt(8)
    s_barrier
    s_waitcnt lgkmcnt(6)
    v_mfma_f32_16x16x32_bf16 v[104:107], v[152:155], v[64:67], v[96:99]
    s_add_u32 s87, s64, 114688
    s_and_b32 s87, s87, 0x1ffff
    s_add_u32 s87, s87, s36
    s_add_u32 m0, s39, 0
    s_add_u32 s41, s87, 0
    s_waitcnt vmcnt(4)
    buffer_load_dwordx4 v189, s[12:15], s41 offen nt lds
    v_mfma_f32_16x16x32_bf16 v[108:111], v[152:155], v[68:71], v[100:103]
    ds_read_b128 v[180:183], v145 offset:6144
    s_waitcnt lgkmcnt(6)
    v_mfma_f32_16x16x32_bf16 v[112:115], v[156:159], v[64:67], v[96:99]
    v_mfma_f32_16x16x32_bf16 v[116:119], v[156:159], v[68:71], v[100:103]
    v_add_u32 v146, 0x8000, v146
    v_add_u32 v147, 0x8000, v147
    v_add_u32 v148, 0x8000, v148
    v_add_u32 v149, 0x8000, v149
    ds_read_b64_tr_b16 v[152:153], v146
    ds_read_b64_tr_b16 v[154:155], v146 offset:4096
    v_add_f32 v136, v136, v138
    s_waitcnt lgkmcnt(7)
    v_mfma_f32_16x16x32_bf16 v[104:107], v[160:163], v[72:75], v[104:107]
    v_mfma_f32_16x16x32_bf16 v[108:111], v[160:163], v[76:79], v[108:111]
    ds_read_b64_tr_b16 v[156:157], v147
    ds_read_b64_tr_b16 v[158:159], v147 offset:4096
    s_add_u32 m0, s39, 1920
    s_add_u32 s41, s87, 0
    s_waitcnt vmcnt(4)
    buffer_load_dwordx4 v189, s[12:15], s41 offen offset:128 nt lds
    v_add_f32 v137, v137, v139
    s_waitcnt lgkmcnt(8)
    v_mfma_f32_16x16x32_bf16 v[112:115], v[164:167], v[72:75], v[112:115]
    v_mfma_f32_16x16x32_bf16 v[116:119], v[164:167], v[76:79], v[116:119]
    ds_read_b64_tr_b16 v[160:161], v148
    ds_read_b64_tr_b16 v[162:163], v148 offset:4096
    s_waitcnt lgkmcnt(9)
    v_mfma_f32_16x16x32_bf16 v[104:107], v[168:171], v[80:83], v[104:107]
    v_mfma_f32_16x16x32_bf16 v[108:111], v[168:171], v[84:87], v[108:111]
    ds_read_b64_tr_b16 v[164:165], v149
    ds_read_b64_tr_b16 v[166:167], v149 offset:4096
    s_waitcnt lgkmcnt(10)
    v_mfma_f32_16x16x32_bf16 v[112:115], v[172:175], v[80:83], v[112:115]
    s_add_u32 m0, s39, 4096
    s_add_u32 s41, s87, 4096
    s_waitcnt vmcnt(4)
    buffer_load_dwordx4 v189, s[12:15], s41 offen nt lds
    v_mfma_f32_16x16x32_bf16 v[116:119], v[172:175], v[84:87], v[116:119]
    ds_read_b64_tr_b16 v[168:169], v146 offset:2048
    ds_read_b64_tr_b16 v[170:171], v146 offset:6144
    s_waitcnt lgkmcnt(11)
    v_mfma_f32_16x16x32_bf16 v[104:107], v[176:179], v[88:91], v[104:107]
    v_mfma_f32_16x16x32_bf16 v[108:111], v[176:179], v[92:95], v[108:111]
    ds_read_b64_tr_b16 v[172:173], v147 offset:2048
    ds_read_b64_tr_b16 v[174:175], v147 offset:6144
    s_waitcnt lgkmcnt(12)
    v_mfma_f32_16x16x32_bf16 v[112:115], v[180:183], v[88:91], v[112:115]
    v_mfma_f32_16x16x32_bf16 v[116:119], v[180:183], v[92:95], v[116:119]
    ds_read_b64_tr_b16 v[176:177], v148 offset:2048
    ds_read_b64_tr_b16 v[178:179], v148 offset:6144
    s_setprio 1
    s_waitcnt lgkmcnt(12)
    v_mfma_f32_16x16x32_bf16 v[0:3], v[152:155], v[120:123], v[0:3]
    v_mfma_f32_16x16x32_bf16 v[4:7], v[152:155], v[124:127], v[4:7]
    ds_read_b64_tr_b16 v[180:181], v149 offset:2048
    ds_read_b64_tr_b16 v[182:183], v149 offset:6144
    s_add_u32 m0, s39, 6016
    s_add_u32 s41, s87, 4096
    s_waitcnt vmcnt(4)
    buffer_load_dwordx4 v189, s[12:15], s41 offen offset:128 nt lds
    s_waitcnt lgkmcnt(12)
    v_mfma_f32_16x16x32_bf16 v[8:11], v[156:159], v[120:123], v[8:11]
    v_exp_f32 v140, v104
    v_exp_f32 v141, v105
    v_exp_f32 v142, v106
    v_mfma_f32_16x16x32_bf16 v[12:15], v[156:159], v[124:127], v[12:15]
    v_add_u32 v144, 0x8000, v144
    v_add_u32 v145, 0x8000, v145
    ds_read_b128 v[152:155], v144
    v_add_f32 v138, v140, v141
    v_cvt_pk_bf16_f32 v128, v140, v141
    v_exp_f32 v143, v107
    s_waitcnt lgkmcnt(11)
    v_mfma_f32_16x16x32_bf16 v[16:19], v[160:163], v[120:123], v[16:19]
    v_exp_f32 v140, v108
    v_add_f32 v138, v138, v142
    v_cvt_pk_bf16_f32 v129, v142, v143
    v_add_f32 v138, v138, v143
    v_mfma_f32_16x16x32_bf16 v[20:23], v[160:163], v[124:127], v[20:23]
    ds_read_b128 v[156:159], v144 offset:4096
    v_exp_f32 v141, v109
    v_exp_f32 v142, v110
    v_add_f32 v139, v140, v141
    v_cvt_pk_bf16_f32 v132, v140, v141
    s_waitcnt lgkmcnt(10)
    v_mfma_f32_16x16x32_bf16 v[24:27], v[164:167], v[120:123], v[24:27]
    s_cmp_lg_u32 s33, 0
    s_cbranch_scc1 L_r0w2
    s_cmp_ge_u32 s3, 9
    s_cselect_b32 s87, -9, 1
    s_add_u32 s87, s87, s3
    s_mul_i32 s87, s87, 524288
    s_add_u32 s87, s87, s37
    s_add_u32 m0, s39, 16384
    s_add_u32 s41, s87, 512
    buffer_load_dwordx4 v190, s[16:19], s41 offen lds
    s_add_u32 m0, s39, 18304
    s_add_u32 s41, s87, 512
    buffer_load_dwordx4 v190, s[16:19], s41 offen offset:128 lds
    s_add_u32 m0, s39, 20480
    s_add_u32 s41, s87, 33280
    buffer_load_dwordx4 v190, s[16:19], s41 offen lds
    s_add_u32 m0, s39, 22400
    s_add_u32 s41, s87, 33280
    buffer_load_dwordx4 v190, s[16:19], s41 offen offset:128 lds
L_r0w2:
    v_exp_f32 v143, v111
    v_exp_f32 v140, v112
    v_mfma_f32_16x16x32_bf16 v[28:31], v[164:167], v[124:127], v[28:31]
    ds_read_b128 v[160:163], v145
    v_add_f32 v139, v139, v142
    v_cvt_pk_bf16_f32 v133, v142, v143
    v_add_f32 v139, v139, v143
    v_exp_f32 v141, v113
    s_waitcnt lgkmcnt(9)
    v_mfma_f32_16x16x32_bf16 v[32:35], v[168:171], v[120:123], v[32:35]
    v_exp_f32 v142, v114
    v_add_f32 v138, v138, v140
    v_cvt_pk_bf16_f32 v130, v140, v141
    v_add_f32 v138, v138, v141
    v_mfma_f32_16x16x32_bf16 v[36:39], v[168:171], v[124:127], v[36:39]
    ds_read_b128 v[164:167], v145 offset:4096
    v_exp_f32 v143, v115
    v_exp_f32 v140, v116
    v_add_f32 v138, v138, v142
    v_cvt_pk_bf16_f32 v131, v142, v143
    v_add_f32 v138, v138, v143
    s_waitcnt lgkmcnt(8)
    v_mfma_f32_16x16x32_bf16 v[40:43], v[172:175], v[120:123], v[40:43]
    v_exp_f32 v141, v117
    v_exp_f32 v142, v118
    v_mfma_f32_16x16x32_bf16 v[44:47], v[172:175], v[124:127], v[44:47]
    ds_read_b128 v[168:171], v144 offset:2048
    s_cmp_lg_u32 s33, 0
    s_cbranch_scc1 L_r0w3
    s_cmp_ge_u32 s3, 9
    s_cselect_b32 s87, -9, 1
    s_add_u32 s87, s87, s3
    s_mul_i32 s87, s87, 524288
    s_add_u32 s87, s87, s37
    s_add_u32 m0, s39, 49152
    s_add_u32 s41, s87, 262656
    buffer_load_dwordx4 v190, s[16:19], s41 offen lds
    s_add_u32 m0, s39, 51072
    s_add_u32 s41, s87, 262656
    buffer_load_dwordx4 v190, s[16:19], s41 offen offset:128 lds
    s_add_u32 m0, s39, 53248
    s_add_u32 s41, s87, 295424
    buffer_load_dwordx4 v190, s[16:19], s41 offen lds
    s_add_u32 m0, s39, 55168
    s_add_u32 s41, s87, 295424
    buffer_load_dwordx4 v190, s[16:19], s41 offen offset:128 lds
L_r0w3:
    v_add_f32 v139, v139, v140
    v_cvt_pk_bf16_f32 v134, v140, v141
    v_add_f32 v139, v139, v141
    v_exp_f32 v143, v119
    s_waitcnt lgkmcnt(7)
    v_mfma_f32_16x16x32_bf16 v[48:51], v[176:179], v[120:123], v[48:51]
    v_add_f32 v139, v139, v142
    v_cvt_pk_bf16_f32 v135, v142, v143
    v_add_f32 v139, v139, v143
    v_max_f32 v185, v138, v139
    v_cmp_nge_f32 vcc, 0x46800000, v185
    v_mfma_f32_16x16x32_bf16 v[52:55], v[176:179], v[124:127], v[52:55]
    ds_read_b128 v[172:175], v144 offset:6144
    s_waitcnt lgkmcnt(6)
    v_mfma_f32_16x16x32_bf16 v[56:59], v[180:183], v[120:123], v[56:59]
    v_mfma_f32_16x16x32_bf16 v[60:63], v[180:183], v[124:127], v[60:63]
    ds_read_b128 v[176:179], v145 offset:2048
    s_cbranch_vccnz L_stub12
L_back12:
    s_setprio 0
    s_cmp_eq_u32 s33, 0
    s_cbranch_scc1 L_rw34
    s_waitcnt vmcnt(4)
L_rw34:
    s_waitcnt vmcnt(12)
    s_barrier
    s_waitcnt lgkmcnt(6)
    v_mfma_f32_16x16x32_bf16 v[104:107], v[152:155], v[64:67], v[96:99]
    s_add_u32 s87, s64, 122880
    s_and_b32 s87, s87, 0x1ffff
    s_add_u32 s87, s87, s36
    s_add_u32 m0, s39, 32768
    s_add_u32 s41, s87, 0
    s_waitcnt vmcnt(4)
    buffer_load_dwordx4 v189, s[12:15], s41 offen nt lds
    v_mfma_f32_16x16x32_bf16 v[108:111], v[152:155], v[68:71], v[100:103]
    ds_read_b128 v[180:183], v145 offset:6144
    s_waitcnt lgkmcnt(6)
    v_mfma_f32_16x16x32_bf16 v[112:115], v[156:159], v[64:67], v[96:99]
    v_mfma_f32_16x16x32_bf16 v[116:119], v[156:159], v[68:71], v[100:103]
    v_add_u32 v146, 0x8000, v146
    v_add_u32 v147, 0x8000, v147
    v_add_u32 v148, 0x8000, v148
    v_add_u32 v149, 0x8000, v149
    ds_read_b64_tr_b16 v[152:153], v146
    ds_read_b64_tr_b16 v[154:155], v146 offset:4096
    v_add_f32 v136, v136, v138
    s_waitcnt lgkmcnt(7)
    v_mfma_f32_16x16x32_bf16 v[104:107], v[160:163], v[72:75], v[104:107]
    s_add_u32 m0, s39, 34688
    s_add_u32 s41, s87, 0
    s_waitcnt vmcnt(4)
    buffer_load_dwordx4 v189, s[12:15], s41 offen offset:128 nt lds
    v_mfma_f32_16x16x32_bf16 v[108:111], v[160:163], v[76:79], v[108:111]
    ds_read_b64_tr_b16 v[156:157], v147
    ds_read_b64_tr_b16 v[158:159], v147 offset:4096
    v_add_f32 v137, v137, v139
    s_waitcnt lgkmcnt(8)
    v_mfma_f32_16x16x32_bf16 v[112:115], v[164:167], v[72:75], v[112:115]
    v_mfma_f32_16x16x32_bf16 v[116:119], v[164:167], v[76:79], v[116:119]
    ds_read_b64_tr_b16 v[160:161], v148
    ds_read_b64_tr_b16 v[162:163], v148 offset:4096
    s_waitcnt lgkmcnt(9)
    v_mfma_f32_16x16x32_bf16 v[104:107], v[168:171], v[80:83], v[104:107]
    s_add_u32 m0, s39, 36864
    s_add_u32 s41, s87, 4096
    s_waitcnt vmcnt(4)
    buffer_load_dwordx4 v189, s[12:15], s41 offen nt lds
    v_mfma_f32_16x16x32_bf16 v[108:111], v[168:171], v[84:87], v[108:111]
    ds_read_b64_tr_b16 v[164:165], v149
    ds_read_b64_tr_b16 v[166:167], v149 offset:4096
    s_waitcnt lgkmcnt(10)
    v_mfma_f32_16x16x32_bf16 v[112:115], v[172:175], v[80:83], v[112:115]
    v_mfma_f32_16x16x32_bf16 v[116:119], v[172:175], v[84:87], v[116:119]
    ds_read_b64_tr_b16 v[168:169], v146 offset:2048
    ds_read_b64_tr_b16 v[170:171], v146 offset:6144
    s_waitcnt lgkmcnt(11)
    v_mfma_f32_16x16x32_bf16 v[104:107], v[176:179], v[88:91], v[104:107]
    s_add_u32 m0, s39, 38784
    s_add_u32 s41, s87, 4096
    s_waitcnt vmcnt(4)
    buffer_load_dwordx4 v189, s[12:15], s41 offen offset:128 nt lds
    v_mfma_f32_16x16x32_bf16 v[108:111], v[176:179], v[92:95], v[108:111]
    ds_read_b64_tr_b16 v[172:173], v147 offset:2048
    ds_read_b64_tr_b16 v[174:175], v147 offset:6144
    s_waitcnt lgkmcnt(12)
    v_mfma_f32_16x16x32_bf16 v[112:115], v[180:183], v[88:91], v[112:115]
    v_mfma_f32_16x16x32_bf16 v[116:119], v[180:183], v[92:95], v[116:119]
    ds_read_b64_tr_b16 v[176:177], v148 offset:2048
    ds_read_b64_tr_b16 v[178:179], v148 offset:6144
    s_setprio 1
    s_waitcnt lgkmcnt(12)
    v_mfma_f32_16x16x32_bf16 v[0:3], v[152:155], v[128:131], v[0:3]
    v_mfma_f32_16x16x32_bf16 v[4:7], v[152:155], v[132:135], v[4:7]
    ds_read_b64_tr_b16 v[180:181], v149 offset:2048
    ds_read_b64_tr_b16 v[182:183], v149 offset:6144
    s_cmp_lg_u32 s33, 0
    s_cbranch_scc1 L_r0w0
    s_cmp_ge_u32 s3, 10
    s_cselect_b32 s87, -10, 0
    s_add_u32 s87, s87, s3
    s_mul_i32 s87, s87, 524288
    s_add_u32 s87, s87, s37
    s_add_u32 m0, s39, 65536
    s_add_u32 s41, s87, 512
    buffer_load_dwordx4 v190, s[16:19], s41 offen lds
    s_add_u32 m0, s39, 67456
    s_add_u32 s41, s87, 512
    buffer_load_dwordx4 v190, s[16:19], s41 offen offset:128 lds
    s_add_u32 m0, s39, 69632
    s_add_u32 s41, s87, 33280
    buffer_load_dwordx4 v190, s[16:19], s41 offen lds
    s_add_u32 m0, s39, 71552
    s_add_u32 s41, s87, 33280
    buffer_load_dwordx4 v190, s[16:19], s41 offen offset:128 lds
L_r0w0:
    s_waitcnt lgkmcnt(12)
    v_mfma_f32_16x16x32_bf16 v[8:11], v[156:159], v[128:131], v[8:11]
    v_exp_f32 v140, v104
    v_exp_f32 v141, v105
    v_exp_f32 v142, v106
    v_mfma_f32_16x16x32_bf16 v[12:15], v[156:159], v[132:135], v[12:15]
    v_add_u32 v144, 0x8000, v144
    v_add_u32 v145, 0x8000, v145
    ds_read_b128 v[152:155], v144
    v_add_f32 v138, v140, v141
    v_cvt_pk_bf16_f32 v120, v140, v141
    v_exp_f32 v143, v107
    s_waitcnt lgkmcnt(11)
    v_mfma_f32_16x16x32_bf16 v[16:19], v[160:163], v[128:131], v[16:19]
    v_exp_f32 v140, v108
    v_add_f32 v138, v138, v142
    v_cvt_pk_bf16_f32 v121, v142, v143
    v_add_f32 v138, v138, v143
    v_mfma_f32_16x16x32_bf16 v[20:23], v[160:163], v[132:135], v[20:23]
    ds_read_b128 v[156:159], v144 offset:4096
    v_exp_f32 v141, v109
    v_exp_f32 v142, v110
    v_add_f32 v139, v140, v141
    v_cvt_pk_bf16_f32 v124, v140, v141
    s_waitcnt lgkmcnt(10)
    v_mfma_f32_16x16x32_bf16 v[24:27], v[164:167], v[128:131], v[24:27]
    s_cmp_lg_u32 s33, 0
    s_cbranch_scc1 L_r0w1
    s_cmp_ge_u32 s3, 10
    s_cselect_b32 s87, -10, 0
    s_add_u32 s87, s87, s3
    s_mul_i32 s87, s87, 524288
    s_add_u32 s87, s87, s37
    s_add_u32 m0, s39, 81920
    s_add_u32 s41, s87, 262656
    buffer_load_dwordx4 v190, s[16:19], s41 offen lds
    s_add_u32 m0, s39, 83840
    s_add_u32 s41, s87, 262656
    buffer_load_dwordx4 v190, s[16:19], s41 offen offset:128 lds
    s_add_u32 m0, s39, 86016
    s_add_u32 s41, s87, 295424
    buffer_load_dwordx4 v190, s[16:19], s41 offen lds
    s_add_u32 m0, s39, 87936
    s_add_u32 s41, s87, 295424
    buffer_load_dwordx4 v190, s[16:19], s41 offen offset:128 lds
L_r0w1:
    v_exp_f32 v143, v111
    v_exp_f32 v140, v112
    v_mfma_f32_16x16x32_bf16 v[28:31], v[164:167], v[132:135], v[28:31]
    ds_read_b128 v[160:163], v145
    v_add_f32 v139, v139, v142
    v_cvt_pk_bf16_f32 v125, v142, v143
    v_add_f32 v139, v139, v143
    v_exp_f32 v141, v113
    s_waitcnt lgkmcnt(9)
    v_mfma_f32_16x16x32_bf16 v[32:35], v[168:171], v[128:131], v[32:35]
    v_exp_f32 v142, v114
    v_add_f32 v138, v138, v140
    v_cvt_pk_bf16_f32 v122, v140, v141
    v_add_f32 v138, v138, v141
    v_mfma_f32_16x16x32_bf16 v[36:39], v[168:171], v[132:135], v[36:39]
    ds_read_b128 v[164:167], v145 offset:4096
    v_exp_f32 v143, v115
    v_exp_f32 v140, v116
    v_add_f32 v138, v138, v142
    v_cvt_pk_bf16_f32 v123, v142, v143
    v_add_f32 v138, v138, v143
    s_waitcnt lgkmcnt(8)
    v_mfma_f32_16x16x32_bf16 v[40:43], v[172:175], v[128:131], v[40:43]
    v_exp_f32 v141, v117
    v_exp_f32 v142, v118
    v_mfma_f32_16x16x32_bf16 v[44:47], v[172:175], v[132:135], v[44:47]
    ds_read_b128 v[168:171], v144 offset:2048
    s_lshl_b32 s42, s33, 3
    s_add_u32 s42, s42, s32
    s_cmp_lg_u32 s42, 12
    s_cbranch_scc1 L_g1_back
    v_readfirstlane_b32 s54, v194
    s_nop 0
    s_bfe_u32 s54, s54, 0x40000
    s_cmp_lg_u32 s54, 15
    s_cbranch_scc1 L_g1
L_g1_back:
    v_add_f32 v139, v139, v140
    v_cvt_pk_bf16_f32 v126, v140, v141
    v_add_f32 v139, v139, v141
    v_exp_f32 v143, v119
    s_waitcnt lgkmcnt(7)
    v_mfma_f32_16x16x32_bf16 v[48:51], v[176:179], v[128:131], v[48:51]
    v_add_f32 v139, v139, v142
    v_cvt_pk_bf16_f32 v127, v142, v143
    v_add_f32 v139, v139, v143
    v_max_f32 v185, v138, v139
    v_cmp_nge_f32 vcc, 0x46800000, v185
    v_mfma_f32_16x16x32_bf16 v[52:55], v[176:179], v[132:135], v[52:55]
    ds_read_b128 v[172:175], v144 offset:6144
    s_waitcnt lgkmcnt(6)
    v_mfma_f32_16x16x32_bf16 v[56:59], v[180:183], v[128:131], v[56:59]
    v_mfma_f32_16x16x32_bf16 v[60:63], v[180:183], v[132:135], v[60:63]
    ds_read_b128 v[176:179], v145 offset:2048
    s_cbranch_vccnz L_stub13
L_back13:
    s_setprio 0
    s_cmp_eq_u32 s33, 0
    s_cbranch_scc1 L_rw35
    s_waitcnt vmcnt(4)
L_rw35:
    s_waitcnt vmcnt(20)
    s_barrier
    s_waitcnt lgkmcnt(6)
    v_mfma_f32_16x16x32_bf16 v[104:107], v[152:155], v[64:67], v[96:99]
    s_cmp_lg_u32 s33, 0
    s_cbranch_scc1 L_opre0
    s_cmp_ge_u32 s3, 10
    s_cselect_b32 s87, -10, 0
    s_add_u32 s87, s87, s3
    s_mul_i32 s87, s87, 128
    s_add_u32 s87, s87, s38
    s_add_u32 m0, s40, 98304
    s_add_u32 s41, s87, 0
    buffer_load_dwordx4 v191, s[20:23], s41 offen lds
    s_add_u32 m0, s40, 100352
    s_add_u32 s41, s87, 20480
    buffer_load_dwordx4 v191, s[20:23], s41 offen lds
    s_add_u32 m0, s40, 102400
    s_add_u32 s41, s87, 40960
    buffer_load_dwordx4 v191, s[20:23], s41 offen lds
    s_add_u32 m0, s40, 104448
    s_add_u32 s41, s87, 61440
    buffer_load_dwordx4 v191, s[20:23], s41 offen lds
    s_add_u32 m0, s40, 106496
    s_add_u32 s41, s87, 81920
    buffer_load_dwordx4 v191, s[20:23], s41 offen lds
L_opre0_back:
    v_mfma_f32_16x16x32_bf16 v[108:111], v[152:155], v[68:71], v[100:103]
    ds_read_b128 v[180:183], v145 offset:6144
    s_waitcnt lgkmcnt(6)
    v_mfma_f32_16x16x32_bf16 v[112:115], v[156:159], v[64:67], v[96:99]
    v_mfma_f32_16x16x32_bf16 v[116:119], v[156:159], v[68:71], v[100:103]
    v_add_u32 v146, 0xfffe0000, v146
    v_add_u32 v147, 0xfffe0000, v147
    v_add_u32 v148, 0xfffe0000, v148
    v_add_u32 v149, 0xfffe0000, v149
    ds_read_b64_tr_b16 v[152:153], v146
    ds_read_b64_tr_b16 v[154:155], v146 offset:4096
    v_add_f32 v136, v136, v138
    s_waitcnt lgkmcnt(7)
    v_mfma_f32_16x16x32_bf16 v[104:107], v[160:163], v[72:75], v[104:107]
    v_mfma_f32_16x16x32_bf16 v[108:111], v[160:163], v[76:79], v[108:111]
    ds_read_b64_tr_b16 v[156:157], v147
    ds_read_b64_tr_b16 v[158:159], v147 offset:4096
    v_add_f32 v137, v137, v139
    s_waitcnt lgkmcnt(8)
    v_mfma_f32_16x16x32_bf16 v[112:115], v[164:167], v[72:75], v[112:115]
    v_mfma_f32_16x16x32_bf16 v[116:119], v[164:167], v[76:79], v[116:119]
    ds_read_b64_tr_b16 v[160:161], v148
    ds_read_b64_tr_b16 v[162:163], v148 offset:4096
    s_waitcnt lgkmcnt(9)
    v_mfma_f32_16x16x32_bf16 v[104:107], v[168:171], v[80:83], v[104:107]
    v_mfma_f32_16x16x32_bf16 v[108:111], v[168:171], v[84:87], v[108:111]
    ds_read_b64_tr_b16 v[164:165], v149
    ds_read_b64_tr_b16 v[166:167], v149 offset:4096
    s_waitcnt lgkmcnt(10)
    v_mfma_f32_16x16x32_bf16 v[112:115], v[172:175], v[80:83], v[112:115]
    v_mfma_f32_16x16x32_bf16 v[116:119], v[172:175], v[84:87], v[116:119]
    ds_read_b64_tr_b16 v[168:169], v146 offset:2048
    ds_read_b64_tr_b16 v[170:171], v146 offset:6144
    s_waitcnt lgkmcnt(11)
    v_mfma_f32_16x16x32_bf16 v[104:107], v[176:179], v[88:91], v[104:107]
    v_mfma_f32_16x16x32_bf16 v[108:111], v[176:179], v[92:95], v[108:111]
    ds_read_b64_tr_b16 v[172:173], v147 offset:2048
    ds_read_b64_tr_b16 v[174:175], v147 offset:6144
    s_waitcnt lgkmcnt(12)
    v_mfma_f32_16x16x32_bf16 v[112:115], v[180:183], v[88:91], v[112:115]
    v_mfma_f32_16x16x32_bf16 v[116:119], v[180:183], v[92:95], v[116:119]
    ds_read_b64_tr_b16 v[176:177], v148 offset:2048
    ds_read_b64_tr_b16 v[178:179], v148 offset:6144
    s_setprio 1
    s_waitcnt lgkmcnt(12)
    v_mfma_f32_16x16x32_bf16 v[0:3], v[152:155], v[120:123], v[0:3]
    v_mfma_f32_16x16x32_bf16 v[4:7], v[152:155], v[124:127], v[4:7]
    ds_read_b64_tr_b16 v[180:181], v149 offset:2048
    ds_read_b64_tr_b16 v[182:183], v149 offset:6144
    s_waitcnt lgkmcnt(12)
    v_mfma_f32_16x16x32_bf16 v[8:11], v[156:159], v[120:123], v[8:11]
    v_exp_f32 v140, v104
    v_exp_f32 v141, v105
    v_exp_f32 v142, v106
    v_mfma_f32_16x16x32_bf16 v[12:15], v[156:159], v[124:127], v[12:15]
    v_add_f32 v138, v140, v141
    v_cvt_pk_bf16_f32 v128, v140, v141
    v_exp_f32 v143, v107
    s_waitcnt lgkmcnt(10)
    v_mfma_f32_16x16x32_bf16 v[16:19], v[160:163], v[120:123], v[16:19]
    v_exp_f32 v140, v108
    v_add_f32 v138, v138, v142
    v_cvt_pk_bf16_f32 v129, v142, v143
    v_add_f32 v138, v138, v143
    v_mfma_f32_16x16x32_bf16 v[20:23], v[160:163], v[124:127], v[20:23]
    v_exp_f32 v141, v109
    v_exp_f32 v142, v110
    v_add_f32 v139, v140, v141
    v_cvt_pk_bf16_f32 v132, v140, v141
    s_waitcnt lgkmcnt(8)
    v_mfma_f32_16x16x32_bf16 v[24:27], v[164:167], v[120:123], v[24:27]
    v_exp_f32 v143, v111
    v_exp_f32 v140, v112
    v_mfma_f32_16x16x32_bf16 v[28:31], v[164:167], v[124:127], v[28:31]
    v_add_f32 v139, v139, v142
    v_cvt_pk_bf16_f32 v133, v142, v143
    v_add_f32 v139, v139, v143
    v_exp_f32 v141, v113
    s_waitcnt lgkmcnt(6)
    v_mfma_f32_16x16x32_bf16 v[32:35], v[168:171], v[120:123], v[32:35]
    v_exp_f32 v142, v114
    v_add_f32 v138, v138, v140
    v_cvt_pk_bf16_f32 v130, v140, v141
    v_add_f32 v138, v138, v141
    v_mfma_f32_16x16x32_bf16 v[36:39], v[168:171], v[124:127], v[36:39]
    v_exp_f32 v143, v115
    v_exp_f32 v140, v116
    v_add_f32 v138, v138, v142
    v_cvt_pk_bf16_f32 v131, v142, v143
    v_add_f32 v138, v138, v143
    s_waitcnt lgkmcnt(4)
    v_mfma_f32_16x16x32_bf16 v[40:43], v[172:175], v[120:123], v[40:43]
    v_exp_f32 v141, v117
    v_exp_f32 v142, v118
    v_mfma_f32_16x16x32_bf16 v[44:47], v[172:175], v[124:127], v[44:47]
    v_add_f32 v139, v139, v140
    v_cvt_pk_bf16_f32 v134, v140, v141
    v_add_f32 v139, v139, v141
    v_exp_f32 v143, v119
    s_waitcnt lgkmcnt(2)
    v_mfma_f32_16x16x32_bf16 v[48:51], v[176:179], v[120:123], v[48:51]
    v_add_f32 v139, v139, v142
    v_cvt_pk_bf16_f32 v135, v142, v143
    v_add_f32 v139, v139, v143
    v_max_f32 v185, v138, v139
    v_cmp_nge_f32 vcc, 0x46800000, v185
    v_mfma_f32_16x16x32_bf16 v[52:55], v[176:179], v[124:127], v[52:55]
    s_waitcnt lgkmcnt(0)
    v_mfma_f32_16x16x32_bf16 v[56:59], v[180:183], v[120:123], v[56:59]
    v_mfma_f32_16x16x32_bf16 v[60:63], v[180:183], v[124:127], v[60:63]
    s_cbranch_vccnz L_stub14
L_back14:
    s_setprio 0
    s_cmp_eq_u32 s33, 0
    s_cbranch_scc1 L_rw36
    s_waitcnt vmcnt(10)
L_rw36:
    s_waitcnt vmcnt(13)
    s_barrier
    s_cmp_lg_u32 s33, 0
    s_cbranch_scc1 L_opre1
L_opre1_back:
    v_add_f32 v136, v136, v138
    v_add_f32 v137, v137, v139
    s_and_b32 s42, s91, s33
    s_cselect_b64 vcc, -1, 0
    v_add_u32 v146, 0x8000, v146
    v_add_u32 v147, 0x8000, v147
    v_add_u32 v148, 0x8000, v148
    v_add_u32 v149, 0x8000, v149
    ds_read_b64_tr_b16 v[152:153], v146
    ds_read_b64_tr_b16 v[154:155], v146 offset:4096
    ds_read_b64_tr_b16 v[156:157], v147
    ds_read_b64_tr_b16 v[158:159], v147 offset:4096
    ds_read_b64_tr_b16 v[160:161], v148
    ds_read_b64_tr_b16 v[162:163], v148 offset:4096
    ds_read_b64_tr_b16 v[164:165], v149
    ds_read_b64_tr_b16 v[166:167], v149 offset:4096
    ds_read_b64_tr_b16 v[168:169], v146 offset:2048
    ds_read_b64_tr_b16 v[170:171], v146 offset:6144
    ds_read_b64_tr_b16 v[172:173], v147 offset:2048
    ds_read_b64_tr_b16 v[174:175], v147 offset:6144
    ds_read_b64_tr_b16 v[176:177], v148 offset:2048
    ds_read_b64_tr_b16 v[178:179], v148 offset:6144
    s_waitcnt lgkmcnt(12)
    v_mfma_f32_16x16x32_bf16 v[0:3], v[152:155], v[128:131], v[0:3]
    v_mov_b32 v140, v136
    v_mov_b32 v141, v137
    s_nop 0
    v_permlane32_swap_b32 v136, v140
    v_permlane32_swap_b32 v137, v141
    v_mfma_f32_16x16x32_bf16 v[4:7], v[152:155], v[132:135], v[4:7]
    ds_read_b64_tr_b16 v[180:181], v149 offset:2048
    ds_read_b64_tr_b16 v[182:183], v149 offset:6144
    v_add_f32 v136, v136, v140
    v_add_f32 v137, v137, v141
    v_mov_b32 v140, v136
    s_waitcnt lgkmcnt(12)
    v_mfma_f32_16x16x32_bf16 v[8:11], v[156:159], v[128:131], v[8:11]
    v_mov_b32 v141, v137
    v_permlane16_swap_b32 v136, v140
    s_nop 0
    v_permlane16_swap_b32 v137, v141
    v_add_f32 v136, v136, v140
    v_mfma_f32_16x16x32_bf16 v[12:15], v[156:159], v[132:135], v[12:15]
    v_add_f32 v137, v137, v141
    v_rcp_f32 v136, v136
    v_rcp_f32 v137, v137
    s_waitcnt lgkmcnt(10)
    v_mfma_f32_16x16x32_bf16 v[16:19], v[160:163], v[128:131], v[16:19]
    v_mbcnt_lo_u32_b32 v185, -1, 0
    v_mbcnt_hi_u32_b32 v185, -1, v185
    v_lshlrev_b32 v185, 4, v185
    v_mfma_f32_16x16x32_bf16 v[20:23], v[160:163], v[132:135], v[20:23]
    s_waitcnt lgkmcnt(8)
    v_mfma_f32_16x16x32_bf16 v[24:27], v[164:167], v[128:131], v[24:27]
    v_mul_f32 v0, v0, v136
    v_mul_f32 v1, v1, v136
    v_mul_f32 v2, v2, v136
    v_mul_f32 v3, v3, v136
    v_cvt_pk_bf16_f32 v64, v0, v1
    v_cvt_pk_bf16_f32 v65, v2, v3
    v_mul_f32 v8, v8, v136
    v_mfma_f32_16x16x32_bf16 v[28:31], v[164:167], v[132:135], v[28:31]
    v_mul_f32 v9, v9, v136
    v_mul_f32 v10, v10, v136
    v_mul_f32 v11, v11, v136
    v_cvt_pk_bf16_f32 v66, v8, v9
    v_cvt_pk_bf16_f32 v67, v10, v11
    s_add_u32 s42, s48, 0
    s_cbranch_vccz L_slow0
    buffer_store_dwordx4 v[64:67], v185, s[24:27], s42 offen
L_slowb0:
    s_waitcnt lgkmcnt(6)
    v_mfma_f32_16x16x32_bf16 v[32:35], v[168:171], v[128:131], v[32:35]
    v_mul_f32 v4, v4, v137
    v_mul_f32 v5, v5, v137
    v_mul_f32 v6, v6, v137
    v_mul_f32 v7, v7, v137
    v_cvt_pk_bf16_f32 v68, v4, v5
    v_cvt_pk_bf16_f32 v69, v6, v7
    v_mul_f32 v12, v12, v137
    v_mfma_f32_16x16x32_bf16 v[36:39], v[168:171], v[132:135], v[36:39]
    v_mul_f32 v13, v13, v137
    v_mul_f32 v14, v14, v137
    v_mul_f32 v15, v15, v137
    v_cvt_pk_bf16_f32 v70, v12, v13
    v_cvt_pk_bf16_f32 v71, v14, v15
    s_add_u32 s42, s48, 0
    s_cbranch_vccz L_slow1
    buffer_store_dwordx4 v[68:71], v185, s[24:27], s42 offen offset:1024
L_slowb1:
    s_waitcnt lgkmcnt(4)
    v_mfma_f32_16x16x32_bf16 v[40:43], v[172:175], v[128:131], v[40:43]
    v_mul_f32 v16, v16, v136
    v_mul_f32 v17, v17, v136
    v_mul_f32 v18, v18, v136
    v_mul_f32 v19, v19, v136
    v_cvt_pk_bf16_f32 v72, v16, v17
    v_cvt_pk_bf16_f32 v73, v18, v19
    v_mul_f32 v24, v24, v136
    v_mfma_f32_16x16x32_bf16 v[44:47], v[172:175], v[132:135], v[44:47]
    v_mul_f32 v25, v25, v136
    v_mul_f32 v26, v26, v136
    v_mul_f32 v27, v27, v136
    v_cvt_pk_bf16_f32 v74, v24, v25
    v_cvt_pk_bf16_f32 v75, v26, v27
    s_add_u32 s42, s48, 10240
    s_cbranch_vccz L_slow2
    buffer_store_dwordx4 v[72:75], v185, s[24:27], s42 offen
L_slowb2:
    s_waitcnt lgkmcnt(2)
    v_mfma_f32_16x16x32_bf16 v[48:51], v[176:179], v[128:131], v[48:51]
    v_mul_f32 v20, v20, v137
    v_mul_f32 v21, v21, v137
    v_mul_f32 v22, v22, v137
    v_mul_f32 v23, v23, v137
    v_cvt_pk_bf16_f32 v76, v20, v21
    v_cvt_pk_bf16_f32 v77, v22, v23
    v_mul_f32 v28, v28, v137
    v_mfma_f32_16x16x32_bf16 v[52:55], v[176:179], v[132:135], v[52:55]
    v_mul_f32 v29, v29, v137
    v_mul_f32 v30, v30, v137
    v_mul_f32 v31, v31, v137
    v_cvt_pk_bf16_f32 v78, v28, v29
    v_cvt_pk_bf16_f32 v79, v30, v31
    s_add_u32 s42, s48, 10240
    s_cbranch_vccz L_slow3
    buffer_store_dwordx4 v[76:79], v185, s[24:27], s42 offen offset:1024
L_slowb3:
    s_waitcnt lgkmcnt(0)
    v_mfma_f32_16x16x32_bf16 v[56:59], v[180:183], v[128:131], v[56:59]
    v_mul_f32 v32, v32, v136
    v_mul_f32 v33, v33, v136
    v_mul_f32 v34, v34, v136
    v_mul_f32 v35, v35, v136
    v_cvt_pk_bf16_f32 v80, v32, v33
    v_cvt_pk_bf16_f32 v81, v34, v35
    v_mul_f32 v40, v40, v136
    v_mul_f32 v41, v41, v136
    v_mul_f32 v42, v42, v136
    v_mul_f32 v43, v43, v136
    v_cvt_pk_bf16_f32 v82, v40, v41
    v_cvt_pk_bf16_f32 v83, v42, v43
    s_add_u32 s42, s48, 20480
    s_cbranch_vccz L_slow4
    buffer_store_dwordx4 v[80:83], v185, s[24:27], s42 offen
L_slowb4:
    v_mfma_f32_16x16x32_bf16 v[60:63], v[180:183], v[132:135], v[60:63]
    v_mul_f32 v36, v36, v137
    v_mul_f32 v37, v37, v137
    v_mul_f32 v38, v38, v137
    v_mul_f32 v39, v39, v137
    v_cvt_pk_bf16_f32 v84, v36, v37
    v_cvt_pk_bf16_f32 v85, v38, v39
    v_mul_f32 v44, v44, v137
    v_mul_f32 v45, v45, v137
    v_mul_f32 v46, v46, v137
    v_mul_f32 v47, v47, v137
    v_cvt_pk_bf16_f32 v86, v44, v45
    v_cvt_pk_bf16_f32 v87, v46, v47
    s_add_u32 s42, s48, 20480
    s_cbranch_vccz L_slow5
    buffer_store_dwordx4 v[84:87], v185, s[24:27], s42 offen offset:1024
L_slowb5:
    v_mul_f32 v48, v48, v136
    v_mul_f32 v49, v49, v136
    v_mul_f32 v50, v50, v136
    v_mul_f32 v51, v51, v136
    v_cvt_pk_bf16_f32 v88, v48, v49
    v_cvt_pk_bf16_f32 v89, v50, v51
    v_mul_f32 v56, v56, v136
    v_mul_f32 v57, v57, v136
    v_mul_f32 v58, v58, v136
    v_mul_f32 v59, v59, v136
    v_cvt_pk_bf16_f32 v90, v56, v57
    v_cvt_pk_bf16_f32 v91, v58, v59
    s_add_u32 s42, s48, 30720
    s_cbranch_vccz L_slow6
    buffer_store_dwordx4 v[88:91], v185, s[24:27], s42 offen
L_slowb6:
    v_mul_f32 v52, v52, v137
    v_mul_f32 v53, v53, v137
    v_mul_f32 v54, v54, v137
    v_mul_f32 v55, v55, v137
    v_cvt_pk_bf16_f32 v92, v52, v53
    v_cvt_pk_bf16_f32 v93, v54, v55
    v_mul_f32 v60, v60, v137
    v_mul_f32 v61, v61, v137
    v_mul_f32 v62, v62, v137
    v_mul_f32 v63, v63, v137
    v_cvt_pk_bf16_f32 v94, v60, v61
    v_cvt_pk_bf16_f32 v95, v62, v63
    s_add_u32 s42, s48, 30720
    s_cbranch_vccz L_slow7
    buffer_store_dwordx4 v[92:95], v185, s[24:27], s42 offen offset:1024
L_slowb7:
    v_add_u32 v146, 0x8000, v146
    v_bfe_u32 v140, v146, 3, 2
    v_and_b32 v146, 0xffffffe7, v146
    v_lshlrev_b32 v140, 4, v140
    v_xor_b32 v146, v146, v140
    v_xor_b32 v147, 64, v146
    v_add_u32 v144, 0xffff4000, v144
    v_add_u32 v145, 0xffff4000, v145
    v_subrev_u32 v144, s52, v144
    v_subrev_u32 v145, s52, v145
    s_add_u32 s36, s36, 262144
    s_add_u32 s37, s37, 512
    s_add_u32 s48, s48, 81920
    s_add_u32 s33, s33, 1
    s_cmp_lt_u32 s33, 2
    s_cbranch_scc1 L_w2_round
    s_branch L_o
L_opre0:
    s_bitcmp1_b32 s32, 1
    s_cbranch_scc1 L_opre0_1
L_opre0_0:
    v_mbcnt_lo_u32_b32 v186, -1, 0
    v_mbcnt_hi_u32_b32 v186, -1, v186
    v_lshlrev_b32 v193, 4, v186
    s_and_b32 s89, s32, 1
    s_mul_i32 s89, s89, 5120
    s_mul_i32 s88, s34, 1310720
    s_add_u32 s88, s88, s89
    s_add_u32 s55, s35, s34
    s_add_u32 s54, s55, 0
    s_and_b32 s54, s54, 3
    s_mul_i32 s56, s54, 10240
    s_add_u32 s54, s55, 1
    s_and_b32 s54, s54, 3
    s_mul_i32 s57, s54, 10240
    s_add_u32 s54, s55, 2
    s_and_b32 s54, s54, 3
    s_mul_i32 s58, s54, 10240
    s_add_u32 s54, s55, 3
    s_and_b32 s54, s54, 3
    s_mul_i32 s59, s54, 10240
    s_and_b32 s55, s35, 4
    s_mul_i32 s55, s55, 163840
    s_add_u32 s88, s88, s55
    s_add_u32 m0, s89, 81920
    s_add_u32 s41, s88, s56
    buffer_load_dwordx4 v193, s[24:27], s41 offen sc1 lds
    buffer_load_dwordx4 v193, s[24:27], s41 offen offset:1024 sc1 lds
    buffer_load_dwordx4 v193, s[24:27], s41 offen offset:2048 sc1 lds
    buffer_load_dwordx4 v193, s[24:27], s41 offen offset:3072 sc1 lds
    s_add_u32 m0, s89, 86016
    s_add_u32 s41, s88, s56
    s_add_u32 s41, s41, 4096
    buffer_load_dwordx4 v193, s[24:27], s41 offen sc1 lds
    s_add_u32 m0, s89, 102400
    s_add_u32 s41, s88, s56
    s_add_u32 s41, s41, 40960
    buffer_load_dwordx4 v193, s[24:27], s41 offen sc1 lds
    buffer_load_dwordx4 v193, s[24:27], s41 offen offset:1024 sc1 lds
    buffer_load_dwordx4 v193, s[24:27], s41 offen offset:2048 sc1 lds
    buffer_load_dwordx4 v193, s[24:27], s41 offen offset:3072 sc1 lds
    s_add_u32 m0, s89, 106496
    s_add_u32 s41, s88, s56
    s_add_u32 s41, s41, 45056
    buffer_load_dwordx4 v193, s[24:27], s41 offen sc1 lds
    s_branch L_opre0_back
L_opre0_1:
    v_mbcnt_lo_u32_b32 v186, -1, 0
    v_mbcnt_hi_u32_b32 v186, -1, v186
    v_lshrrev_b32 v184, 2, v186
    v_mul_u32_u24 v184, 1280, v184
    v_bfe_u32 v192, v186, 4, 1
    v_lshlrev_b32 v192, 1, v192
    v_and_b32 v193, 3, v186
    v_xor_b32 v193, v193, v192
    v_lshl_add_u32 v193, v193, 4, v184
    s_and_b32 s89, s32, 1
    s_mul_i32 s89, s89, 5120
    s_lshl_b32 s88, s89, 2
    s_and_b32 s54, s35, 3
    s_mul_i32 s54, s54, 320
    s_add_u32 s88, s88, s54
    s_add_u32 s89, s89, 10240
    s_add_u32 s55, s35, s34
    s_add_u32 s54, s55, 0
    s_and_b32 s54, s54, 3
    s_mul_i32 s56, s54, 40960
    s_add_u32 s54, s55, 1
    s_and_b32 s54, s54, 3
    s_mul_i32 s57, s54, 40960
    s_add_u32 s54, s55, 2
    s_and_b32 s54, s54, 3
    s_mul_i32 s58, s54, 40960
    s_add_u32 s54, s55, 3
    s_and_b32 s54, s54, 3
    s_mul_i32 s59, s54, 40960
    s_and_b32 s55, s35, 4
    s_mul_i32 s55, s55, 655360
    s_add_u32 s88, s88, s55
    s_add_u32 m0, s89, 81920
    s_add_u32 s41, s88, s56
    buffer_load_dwordx4 v193, s[28:31], s41 offen lds
    s_add_u32 m0, s89, 82880
    s_nop 0
    buffer_load_dwordx4 v193, s[28:31], s41 offen offset:64 lds
    s_add_u32 m0, s89, 83840
    s_nop 0
    buffer_load_dwordx4 v193, s[28:31], s41 offen offset:128 lds
    s_add_u32 m0, s89, 84800
    s_nop 0
    buffer_load_dwordx4 v193, s[28:31], s41 offen offset:192 lds
    s_add_u32 m0, s89, 85760
    s_nop 0
    buffer_load_dwordx4 v193, s[28:31], s41 offen offset:256 lds
    s_add_u32 m0, s89, 102400
    s_add_u32 s41, s88, s56
    s_add_u32 s41, s41, 163840
    buffer_load_dwordx4 v193, s[28:31], s41 offen lds
    s_add_u32 m0, s89, 103360
    s_nop 0
    buffer_load_dwordx4 v193, s[28:31], s41 offen offset:64 lds
    s_add_u32 m0, s89, 104320
    s_nop 0
    buffer_load_dwordx4 v193, s[28:31], s41 offen offset:128 lds
    s_add_u32 m0, s89, 105280
    s_nop 0
    buffer_load_dwordx4 v193, s[28:31], s41 offen offset:192 lds
    s_add_u32 m0, s89, 106240
    s_nop 0
    buffer_load_dwordx4 v193, s[28:31], s41 offen offset:256 lds
    s_branch L_opre0_back
L_opre1:
    s_bitcmp1_b32 s32, 1
    s_cbranch_scc1 L_opre1_1
L_opre1_0:
    s_add_u32 m0, s89, 122880
    s_add_u32 s41, s88, s57
    buffer_load_dwordx4 v193, s[24:27], s41 offen sc1 lds
    buffer_load_dwordx4 v193, s[24:27], s41 offen offset:1024 sc1 lds
    buffer_load_dwordx4 v193, s[24:27], s41 offen offset:2048 sc1 lds
    buffer_load_dwordx4 v193, s[24:27], s41 offen offset:3072 sc1 lds
    s_add_u32 m0, s89, 126976
    s_add_u32 s41, s88, s57
    s_add_u32 s41, s41, 4096
    buffer_load_dwordx4 v193, s[24:27], s41 offen sc1 lds
    s_add_u32 m0, s89, 143360
    s_add_u32 s41, s88, s57
    s_add_u32 s41, s41, 40960
    buffer_load_dwordx4 v193, s[24:27], s41 offen sc1 lds
    buffer_load_dwordx4 v193, s[24:27], s41 offen offset:1024 sc1 lds
    buffer_load_dwordx4 v193, s[24:27], s41 offen offset:2048 sc1 lds
    buffer_load_dwordx4 v193, s[24:27], s41 offen offset:3072 sc1 lds
    s_add_u32 m0, s89, 147456
    s_add_u32 s41, s88, s57
    s_add_u32 s41, s41, 45056
    buffer_load_dwordx4 v193, s[24:27], s41 offen sc1 lds
    s_branch L_opre1_back
L_opre1_1:
    s_add_u32 m0, s89, 122880
    s_add_u32 s41, s88, s57
    buffer_load_dwordx4 v193, s[28:31], s41 offen lds
    s_add_u32 m0, s89, 123840
    s_nop 0
    buffer_load_dwordx4 v193, s[28:31], s41 offen offset:64 lds
    s_add_u32 m0, s89, 124800
    s_nop 0
    buffer_load_dwordx4 v193, s[28:31], s41 offen offset:128 lds
    s_add_u32 m0, s89, 125760
    s_nop 0
    buffer_load_dwordx4 v193, s[28:31], s41 offen offset:192 lds
    s_add_u32 m0, s89, 126720
    s_nop 0
    buffer_load_dwordx4 v193, s[28:31], s41 offen offset:256 lds
    s_add_u32 m0, s89, 143360
    s_add_u32 s41, s88, s57
    s_add_u32 s41, s41, 163840
    buffer_load_dwordx4 v193, s[28:31], s41 offen lds
    s_add_u32 m0, s89, 144320
    s_nop 0
    buffer_load_dwordx4 v193, s[28:31], s41 offen offset:64 lds
    s_add_u32 m0, s89, 145280
    s_nop 0
    buffer_load_dwordx4 v193, s[28:31], s41 offen offset:128 lds
    s_add_u32 m0, s89, 146240
    s_nop 0
    buffer_load_dwordx4 v193, s[28:31], s41 offen offset:192 lds
    s_add_u32 m0, s89, 147200
    s_nop 0
    buffer_load_dwordx4 v193, s[28:31], s41 offen offset:256 lds
    s_branch L_opre1_back
L_g1:
    s_mov_b32 s49, 0x8000
    v_mov_b32 v187, s53
L_g1_spin:
    buffer_load_dword v194, v187, s[80:83], 0 offen sc1
    s_sub_u32 s49, s49, 1
    s_cmp_lt_i32 s49, 0
    s_cbranch_scc1 L_g1_back
    s_waitcnt vmcnt(0)
    v_readfirstlane_b32 s54, v194
    s_nop 0
    s_bfe_u32 s54, s54, 0x40000
    s_cmp_eq_u32 s54, 15
    s_cbranch_scc1 L_g1_back
    s_sleep 8
    s_branch L_g1_spin
L_w3:
    s_waitcnt lgkmcnt(0)
    s_getpc_b64 s[46:47]
L_pc0:
    s_sub_u32 s46, s46, L_pc0-KSTART
    s_subb_u32 s47, s47, 0
    s_lshr_b32 s41, s2, 3
    s_lshl_b32 s41, s41, 2
    s_add_u32 s41, s41, s32
    s_lshl_b32 s41, s41, 7
    v_and_b32 v254, 7, v0
    v_lshlrev_b32 v254, 14, v254
    v_add_u32 v254, s41, v254
    v_min_u32 v254, KEND-KSTART-4, v254
    global_load_dword v252, v254, s[46:47]
    s_mov_b32 s8, s58
    s_mov_b32 s9, s59
    s_mov_b32 s10, 134217728
    s_mov_b32 s11, 0x20000
    s_mov_b32 s12, s60
    s_mov_b32 s13, s61
    s_mov_b32 s14, 134217728
    s_mov_b32 s15, 0x20000
    s_mov_b32 s28, s64
    s_mov_b32 s29, s65
    s_mov_b32 s30, 5242880
    s_mov_b32 s31, 0x20000
    s_mov_b32 s76, s66
    s_mov_b32 s77, s67
    s_mov_b32 s78, 6553600
    s_mov_b32 s79, 0x20000
    s_mov_b32 s80, s68
    s_mov_b32 s81, s69
    s_mov_b32 s82, 256
    s_mov_b32 s83, 0x20000
    s_mov_b32 s24, s70
    s_mov_b32 s25, s71
    s_mov_b32 s26, 50593792
    s_mov_b32 s27, 0x20000
    s_lshr_b32 s54, s37, 8
    s_lshl_b32 s55, s34, 5
    s_add_u32 s55, s55, s54
    s_lshl_b32 s36, s55, 17
    s_mul_i32 s48, s55, 40960
    s_lshl_b32 s53, s34, 1
    s_lshr_b32 s54, s35, 2
    s_add_u32 s53, s53, s54
    s_lshl_b32 s53, s53, 2
    s_mul_i32 s64, s55, 8
    s_lshr_b32 s54, s55, 2
    s_add_u32 s64, s64, s54
    s_and_b32 s64, s64, 15
    s_lshl_b32 s64, s64, 13
    s_mov_b32 s33, 0
    s_mov_b32 s91, 0
    s_mov_b32 s72, 0x3e0293ee
    s_mov_b32 s73, 0x22d2c1
    s_mov_b32 s74, 32768
    s_mov_b32 s75, 20480
    s_mov_b32 s88, s36
    s_mov_b32 s89, s36
    s_cmp_lg_u32 s32, 0
    s_cbranch_scc1 L_noxcc
    s_getreg_b32 s41, hwreg(HW_REG_XCC_ID, 0, 3)
    s_lshl_b32 s41, 0x1000000, s41
    s_lshl_b32 s42, 1114112, s35
    s_lshr_b32 s54, s42, 4
    s_or_b32 s42, s42, s54
    s_and_b32 s42, s42, 0xff0000
    s_or_b32 s41, s41, s42
    s_mov_b32 s42, s53
    v_mov_b32 v254, s41
    v_mov_b32 v255, s42
    s_mov_b64 exec, 1
    buffer_atomic_or v254, v255, s[80:83], 0 offen sc1
    s_mov_b64 exec, 0xff
    v_mul_u32_u24 v254, 4224, v0
    v_mov_b32 v255, 0
    s_mul_i32 s41, s2, 33792
    s_add_u32 s41, s41, 41947136
    buffer_store_dword v255, v254, s[24:27], s41 offen sc1
    s_mov_b64 exec, -1
L_noxcc:
    v_mbcnt_lo_u32_b32 v228, -1, 0
    v_mbcnt_hi_u32_b32 v228, -1, v228
    v_and_b32 v229, 15, v228
    v_lshrrev_b32 v230, 4, v228
    v_lshrrev_b32 v231, 1, v229
    v_xor_b32 v231, v231, v230
    v_lshlrev_b32 v231, 4, v231
    v_lshl_add_u32 v214, v229, 7, v231
    v_xor_b32 v215, 64, v214
    v_lshrrev_b32 v231, 2, v228
    v_and_b32 v232, 6, v231
    v_bfe_u32 v233, v228, 1, 1
    v_xor_b32 v232, v232, v233
    v_lshlrev_b32 v232, 4, v232
    v_lshl_add_u32 v232, v231, 7, v232
    v_and_b32 v233, 1, v228
    v_lshl_add_u32 v216, v233, 3, v232
    v_xor_b32 v217, 32, v216
    v_xor_b32 v218, 64, v216
    v_xor_b32 v219, 96, v216
    s_bfe_u32 s41, s32, 0x10001
    s_lshl_b32 s41, s41, 13
    s_and_b32 s42, s32, 1
    s_mul_i32 s42, s42, 3072
    s_add_u32 s42, s42, 0
    s_add_u32 s48, s48, s42
    s_lshl_b32 s42, s42, 1
    s_sub_u32 s52, s41, s42
    s_add_u32 s42, s42, 98304
    v_add_u32 v216, s41, v216
    v_add_u32 v217, s41, v217
    v_add_u32 v218, s41, v218
    v_add_u32 v219, s41, v219
    v_add_u32 v214, s42, v214
    v_add_u32 v215, s42, v215
    v_add_u32 v218, 0x8000, v218
    v_add_u32 v219, 0x8000, v219
    v_add_u32 v216, 0x10000, v216
    v_bfe_u32 v210, v216, 3, 2
    v_and_b32 v216, 0xffffffe7, v216
    v_lshlrev_b32 v210, 4, v210
    v_xor_b32 v216, v216, v210
    v_xor_b32 v217, 64, v216
L_w3_round:
    s_barrier
    ds_read_b128 v[128:131], v214
    ds_read_b128 v[132:135], v214 offset:2048
    ds_read_b128 v[136:139], v214 offset:4096
    ds_read_b64_tr_b16 v[96:97], v216
    ds_read_b64_tr_b16 v[98:99], v216 offset:4096
    ds_read_b64_tr_b16 v[100:101], v216 offset:8
    ds_read_b64_tr_b16 v[102:103], v216 offset:4104
    ds_read_b64_tr_b16 v[104:105], v217
    ds_read_b64_tr_b16 v[106:107], v217 offset:4096
    ds_read_b64_tr_b16 v[108:109], v217 offset:8
    ds_read_b64_tr_b16 v[110:111], v217 offset:4104
    ds_read_b64_tr_b16 v[112:113], v216 offset:2048
    ds_read_b64_tr_b16 v[114:115], v216 offset:6144
    ds_read_b64_tr_b16 v[116:117], v216 offset:2056
    ds_read_b64_tr_b16 v[118:119], v216 offset:6152
    ds_read_b64_tr_b16 v[120:121], v217 offset:2048
    ds_read_b64_tr_b16 v[122:123], v217 offset:6144
    ds_read_b64_tr_b16 v[124:125], v217 offset:2056
    ds_read_b64_tr_b16 v[126:127], v217 offset:6152
    v_add_u32 v216, 0x4000, v216
    v_add_u32 v217, 0x4000, v217
    s_mov_b32 s49, 0x40004
    s_mov_b32 s90, 0
    s_mov_b32 s51, 8
    s_waitcnt lgkmcnt(0)
    s_barrier
    v_mfma_f32_16x16x32_bf16 v[0:3], v[96:99], v[128:131], 0
    ds_read_b128 v[188:191], v215
    ds_read_b128 v[192:195], v215 offset:2048
    v_mfma_f32_16x16x32_bf16 v[4:7], v[96:99], v[132:135], 0
    ds_read_b128 v[196:199], v215 offset:4096
    v_mfma_f32_16x16x32_bf16 v[8:11], v[96:99], v[136:139], 0
    ds_read_b64_tr_b16 v[156:157], v216
    v_mfma_f32_16x16x32_bf16 v[12:15], v[100:103], v[128:131], 0
    ds_read_b64_tr_b16 v[158:159], v216 offset:4096
    v_mfma_f32_16x16x32_bf16 v[16:19], v[100:103], v[132:135], 0
    ds_read_b64_tr_b16 v[160:161], v216 offset:8
    v_mfma_f32_16x16x32_bf16 v[20:23], v[100:103], v[136:139], 0
    ds_read_b64_tr_b16 v[162:163], v216 offset:4104
    v_mfma_f32_16x16x32_bf16 v[24:27], v[104:107], v[128:131], 0
    ds_read_b64_tr_b16 v[164:165], v217
    v_mfma_f32_16x16x32_bf16 v[28:31], v[104:107], v[132:135], 0
    ds_read_b64_tr_b16 v[166:167], v217 offset:4096
    v_mfma_f32_16x16x32_bf16 v[32:35], v[104:107], v[136:139], 0
    ds_read_b64_tr_b16 v[168:169], v217 offset:8
    v_mfma_f32_16x16x32_bf16 v[36:39], v[108:111], v[128:131], 0
    ds_read_b64_tr_b16 v[170:171], v217 offset:4104
    v_mfma_f32_16x16x32_bf16 v[40:43], v[108:111], v[132:135], 0
    ds_read_b64_tr_b16 v[172:173], v216 offset:2048
    v_mfma_f32_16x16x32_bf16 v[44:47], v[108:111], v[136:139], 0
    ds_read_b64_tr_b16 v[174:175], v216 offset:6144
    v_mfma_f32_16x16x32_bf16 v[48:51], v[112:115], v[128:131], 0
    ds_read_b64_tr_b16 v[176:177], v216 offset:2056
    v_mfma_f32_16x16x32_bf16 v[52:55], v[112:115], v[132:135], 0
    ds_read_b64_tr_b16 v[178:179], v216 offset:6152
    v_mfma_f32_16x16x32_bf16 v[56:59], v[112:115], v[136:139], 0
    ds_read_b64_tr_b16 v[180:181], v217 offset:2048
    v_mfma_f32_16x16x32_bf16 v[60:63], v[116:119], v[128:131], 0
    ds_read_b64_tr_b16 v[182:183], v217 offset:6144
    v_mfma_f32_16x16x32_bf16 v[64:67], v[116:119], v[132:135], 0
    ds_read_b64_tr_b16 v[184:185], v217 offset:2056
    v_mfma_f32_16x16x32_bf16 v[68:71], v[116:119], v[136:139], 0
    ds_read_b64_tr_b16 v[186:187], v217 offset:6152
    v_mfma_f32_16x16x32_bf16 v[72:75], v[120:123], v[128:131], 0
    v_mfma_f32_16x16x32_bf16 v[76:79], v[120:123], v[132:135], 0
    s_bfe_i32 s45, s73, s49
    s_lshl_b32 s45, s45, 14
    s_add_u32 s49, s49, 4
    s_cmp_eq_u32 s49, 0x40018
    v_mfma_f32_16x16x32_bf16 v[80:83], v[120:123], v[136:139], 0
    s_cselect_b32 s49, 0x40000, s49
    v_add_u32 v216, s45, v216
    v_add_u32 v217, s45, v217
    v_mfma_f32_16x16x32_bf16 v[84:87], v[124:127], v[128:131], 0
    s_add_u32 s90, s90, 1
    s_cmp_eq_u32 s90, 3
    s_cselect_b32 s50, 0xffff6000, s75
    v_mfma_f32_16x16x32_bf16 v[88:91], v[124:127], v[132:135], 0
    s_cselect_b32 s90, 0, s90
    v_add_u32 v214, s50, v214
    v_add_u32 v215, s50, v215
    v_mfma_f32_16x16x32_bf16 v[92:95], v[124:127], v[136:139], 0
    s_waitcnt lgkmcnt(0)
    s_waitcnt vmcnt(0)
    s_barrier
    v_mfma_f32_16x16x32_bf16 v[0:3], v[156:159], v[188:191], v[0:3]
    ds_read_b128 v[128:131], v214
    ds_read_b128 v[132:135], v214 offset:2048
    v_mfma_f32_16x16x32_bf16 v[4:7], v[156:159], v[192:195], v[4:7]
    ds_read_b128 v[136:139], v214 offset:4096
    v_mfma_f32_16x16x32_bf16 v[8:11], v[156:159], v[196:199], v[8:11]
    ds_read_b64_tr_b16 v[96:97], v216
    v_mfma_f32_16x16x32_bf16 v[12:15], v[160:163], v[188:191], v[12:15]
    ds_read_b64_tr_b16 v[98:99], v216 offset:4096
L_w3_q:
    v_mfma_f32_16x16x32_bf16 v[16:19], v[160:163], v[192:195], v[16:19]
    ds_read_b64_tr_b16 v[100:101], v216 offset:8
    v_mfma_f32_16x16x32_bf16 v[20:23], v[160:163], v[196:199], v[20:23]
    ds_read_b64_tr_b16 v[102:103], v216 offset:4104
    v_mfma_f32_16x16x32_bf16 v[24:27], v[164:167], v[188:191], v[24:27]
    ds_read_b64_tr_b16 v[104:105], v217
    v_mfma_f32_16x16x32_bf16 v[28:31], v[164:167], v[192:195], v[28:31]
    ds_read_b64_tr_b16 v[106:107], v217 offset:4096
    v_mfma_f32_16x16x32_bf16 v[32:35], v[164:167], v[196:199], v[32:35]
    ds_read_b64_tr_b16 v[108:109], v217 offset:8
    v_mfma_f32_16x16x32_bf16 v[36:39], v[168:171], v[188:191], v[36:39]
    ds_read_b64_tr_b16 v[110:111], v217 offset:4104
    v_mfma_f32_16x16x32_bf16 v[40:43], v[168:171], v[192:195], v[40:43]
    ds_read_b64_tr_b16 v[112:113], v216 offset:2048
    v_mfma_f32_16x16x32_bf16 v[44:47], v[168:171], v[196:199], v[44:47]
    ds_read_b64_tr_b16 v[114:115], v216 offset:6144
    v_mfma_f32_16x16x32_bf16 v[48:51], v[172:175], v[188:191], v[48:51]
    ds_read_b64_tr_b16 v[116:117], v216 offset:2056
    v_mfma_f32_16x16x32_bf16 v[52:55], v[172:175], v[192:195], v[52:55]
    ds_read_b64_tr_b16 v[118:119], v216 offset:6152
    v_mfma_f32_16x16x32_bf16 v[56:59], v[172:175], v[196:199], v[56:59]
    ds_read_b64_tr_b16 v[120:121], v217 offset:2048
    v_mfma_f32_16x16x32_bf16 v[60:63], v[176:179], v[188:191], v[60:63]
    ds_read_b64_tr_b16 v[122:123], v217 offset:6144
    v_mfma_f32_16x16x32_bf16 v[64:67], v[176:179], v[192:195], v[64:67]
    ds_read_b64_tr_b16 v[124:125], v217 offset:2056
    v_mfma_f32_16x16x32_bf16 v[68:71], v[176:179], v[196:199], v[68:71]
    ds_read_b64_tr_b16 v[126:127], v217 offset:6152
    v_mfma_f32_16x16x32_bf16 v[72:75], v[180:183], v[188:191], v[72:75]
    v_mfma_f32_16x16x32_bf16 v[76:79], v[180:183], v[192:195], v[76:79]
    s_bfe_i32 s45, s73, s49
    s_lshl_b32 s45, s45, 14
    v_mfma_f32_16x16x32_bf16 v[80:83], v[180:183], v[196:199], v[80:83]
    s_add_u32 s49, s49, 4
    s_cmp_eq_u32 s49, 0x40018
    v_mfma_f32_16x16x32_bf16 v[84:87], v[184:187], v[188:191], v[84:87]
    s_cselect_b32 s49, 0x40000, s49
    v_add_u32 v216, s45, v216
    v_mfma_f32_16x16x32_bf16 v[88:91], v[184:187], v[192:195], v[88:91]
    v_add_u32 v217, s45, v217
    v_mfma_f32_16x16x32_bf16 v[92:95], v[184:187], v[196:199], v[92:95]
    s_waitcnt lgkmcnt(0)
    s_barrier
    v_mfma_f32_16x16x32_bf16 v[0:3], v[96:99], v[128:131], v[0:3]
    ds_read_b128 v[188:191], v215
    ds_read_b128 v[192:195], v215 offset:2048
    v_mfma_f32_16x16x32_bf16 v[4:7], v[96:99], v[132:135], v[4:7]
    ds_read_b128 v[196:199], v215 offset:4096
    v_mfma_f32_16x16x32_bf16 v[8:11], v[96:99], v[136:139], v[8:11]
    ds_read_b64_tr_b16 v[156:157], v216
    v_mfma_f32_16x16x32_bf16 v[12:15], v[100:103], v[128:131], v[12:15]
    ds_read_b64_tr_b16 v[158:159], v216 offset:4096
    v_mfma_f32_16x16x32_bf16 v[16:19], v[100:103], v[132:135], v[16:19]
    ds_read_b64_tr_b16 v[160:161], v216 offset:8
    v_mfma_f32_16x16x32_bf16 v[20:23], v[100:103], v[136:139], v[20:23]
    ds_read_b64_tr_b16 v[162:163], v216 offset:4104
    v_mfma_f32_16x16x32_bf16 v[24:27], v[104:107], v[128:131], v[24:27]
    ds_read_b64_tr_b16 v[164:165], v217
    v_mfma_f32_16x16x32_bf16 v[28:31], v[104:107], v[132:135], v[28:31]
    ds_read_b64_tr_b16 v[166:167], v217 offset:4096
    v_mfma_f32_16x16x32_bf16 v[32:35], v[104:107], v[136:139], v[32:35]
    ds_read_b64_tr_b16 v[168:169], v217 offset:8
    v_mfma_f32_16x16x32_bf16 v[36:39], v[108:111], v[128:131], v[36:39]
    ds_read_b64_tr_b16 v[170:171], v217 offset:4104
    v_mfma_f32_16x16x32_bf16 v[40:43], v[108:111], v[132:135], v[40:43]
    ds_read_b64_tr_b16 v[172:173], v216 offset:2048
    v_mfma_f32_16x16x32_bf16 v[44:47], v[108:111], v[136:139], v[44:47]
    ds_read_b64_tr_b16 v[174:175], v216 offset:6144
    v_mfma_f32_16x16x32_bf16 v[48:51], v[112:115], v[128:131], v[48:51]
    ds_read_b64_tr_b16 v[176:177], v216 offset:2056
    v_mfma_f32_16x16x32_bf16 v[52:55], v[112:115], v[132:135], v[52:55]
    ds_read_b64_tr_b16 v[178:179], v216 offset:6152
    v_mfma_f32_16x16x32_bf16 v[56:59], v[112:115], v[136:139], v[56:59]
    ds_read_b64_tr_b16 v[180:181], v217 offset:2048
    v_mfma_f32_16x16x32_bf16 v[60:63], v[116:119], v[128:131], v[60:63]
    ds_read_b64_tr_b16 v[182:183], v217 offset:6144
    v_mfma_f32_16x16x32_bf16 v[64:67], v[116:119], v[132:135], v[64:67]
    ds_read_b64_tr_b16 v[184:185], v217 offset:2056
    v_mfma_f32_16x16x32_bf16 v[68:71], v[116:119], v[136:139], v[68:71]
    ds_read_b64_tr_b16 v[186:187], v217 offset:6152
    v_mfma_f32_16x16x32_bf16 v[72:75], v[120:123], v[128:131], v[72:75]
    v_mfma_f32_16x16x32_bf16 v[76:79], v[120:123], v[132:135], v[76:79]
    s_bfe_i32 s45, s73, s49
    s_lshl_b32 s45, s45, 14
    s_add_u32 s49, s49, 4
    s_cmp_eq_u32 s49, 0x40018
    v_mfma_f32_16x16x32_bf16 v[80:83], v[120:123], v[136:139], v[80:83]
    s_cselect_b32 s49, 0x40000, s49
    v_add_u32 v216, s45, v216
    v_add_u32 v217, s45, v217
    v_mfma_f32_16x16x32_bf16 v[84:87], v[124:127], v[128:131], v[84:87]
    s_add_u32 s90, s90, 1
    s_cmp_eq_u32 s90, 3
    s_cselect_b32 s50, 0xffff6000, s75
    v_mfma_f32_16x16x32_bf16 v[88:91], v[124:127], v[132:135], v[88:91]
    s_cselect_b32 s90, 0, s90
    v_add_u32 v214, s50, v214
    v_add_u32 v215, s50, v215
    v_mfma_f32_16x16x32_bf16 v[92:95], v[124:127], v[136:139], v[92:95]
    s_waitcnt lgkmcnt(0)
    s_barrier
    v_mfma_f32_16x16x32_bf16 v[0:3], v[156:159], v[188:191], v[0:3]
    ds_read_b128 v[128:131], v214
    ds_read_b128 v[132:135], v214 offset:2048
    v_mfma_f32_16x16x32_bf16 v[4:7], v[156:159], v[192:195], v[4:7]
    ds_read_b128 v[136:139], v214 offset:4096
    v_mfma_f32_16x16x32_bf16 v[8:11], v[156:159], v[196:199], v[8:11]
    ds_read_b64_tr_b16 v[96:97], v216
    v_mfma_f32_16x16x32_bf16 v[12:15], v[160:163], v[188:191], v[12:15]
    ds_read_b64_tr_b16 v[98:99], v216 offset:4096
    s_sub_u32 s51, s51, 1
    s_cmp_lg_u32 s51, 0
    s_cbranch_scc1 L_w3_q
    v_mov_b32 v210, 163836
    ds_read_b32 v210, v210
    v_mfma_f32_16x16x32_bf16 v[16:19], v[160:163], v[192:195], v[16:19]
    ds_read_b64_tr_b16 v[100:101], v216 offset:8
    v_mfma_f32_16x16x32_bf16 v[20:23], v[160:163], v[196:199], v[20:23]
    ds_read_b64_tr_b16 v[102:103], v216 offset:4104
    v_mfma_f32_16x16x32_bf16 v[24:27], v[164:167], v[188:191], v[24:27]
    ds_read_b64_tr_b16 v[104:105], v217
    v_mfma_f32_16x16x32_bf16 v[28:31], v[164:167], v[192:195], v[28:31]
    ds_read_b64_tr_b16 v[106:107], v217 offset:4096
    v_mfma_f32_16x16x32_bf16 v[32:35], v[164:167], v[196:199], v[32:35]
    ds_read_b64_tr_b16 v[108:109], v217 offset:8
    v_mfma_f32_16x16x32_bf16 v[36:39], v[168:171], v[188:191], v[36:39]
    ds_read_b64_tr_b16 v[110:111], v217 offset:4104
    v_mfma_f32_16x16x32_bf16 v[40:43], v[168:171], v[192:195], v[40:43]
    ds_read_b64_tr_b16 v[112:113], v216 offset:2048
    v_mfma_f32_16x16x32_bf16 v[44:47], v[168:171], v[196:199], v[44:47]
    ds_read_b64_tr_b16 v[114:115], v216 offset:6144
    v_mfma_f32_16x16x32_bf16 v[48:51], v[172:175], v[188:191], v[48:51]
    ds_read_b64_tr_b16 v[116:117], v216 offset:2056
    v_mfma_f32_16x16x32_bf16 v[52:55], v[172:175], v[192:195], v[52:55]
    ds_read_b64_tr_b16 v[118:119], v216 offset:6152
    v_mfma_f32_16x16x32_bf16 v[56:59], v[172:175], v[196:199], v[56:59]
    ds_read_b64_tr_b16 v[120:121], v217 offset:2048
    v_mfma_f32_16x16x32_bf16 v[60:63], v[176:179], v[188:191], v[60:63]
    ds_read_b64_tr_b16 v[122:123], v217 offset:6144
    v_mfma_f32_16x16x32_bf16 v[64:67], v[176:179], v[192:195], v[64:67]
    ds_read_b64_tr_b16 v[124:125], v217 offset:2056
    v_mfma_f32_16x16x32_bf16 v[68:71], v[176:179], v[196:199], v[68:71]
    ds_read_b64_tr_b16 v[126:127], v217 offset:6152
    v_mfma_f32_16x16x32_bf16 v[72:75], v[180:183], v[188:191], v[72:75]
    v_mfma_f32_16x16x32_bf16 v[76:79], v[180:183], v[192:195], v[76:79]
    s_bfe_i32 s45, s73, s49
    s_lshl_b32 s45, s45, 14
    v_mfma_f32_16x16x32_bf16 v[80:83], v[180:183], v[196:199], v[80:83]
    s_add_u32 s49, s49, 4
    s_cmp_eq_u32 s49, 0x40018
    v_mfma_f32_16x16x32_bf16 v[84:87], v[184:187], v[188:191], v[84:87]
    s_cselect_b32 s49, 0x40000, s49
    v_add_u32 v216, s45, v216
    v_mfma_f32_16x16x32_bf16 v[88:91], v[184:187], v[192:195], v[88:91]
    v_add_u32 v217, s45, v217
    v_mfma_f32_16x16x32_bf16 v[92:95], v[184:187], v[196:199], v[92:95]
    s_waitcnt lgkmcnt(0)
    v_readfirstlane_b32 s42, v210
    s_cmp_eq_u32 s33, 0
    s_cselect_b32 s91, s42, s91
    s_barrier
    v_mfma_f32_16x16x32_bf16 v[0:3], v[96:99], v[128:131], v[0:3]
    ds_read_b128 v[188:191], v215
    ds_read_b128 v[192:195], v215 offset:2048
    v_mfma_f32_16x16x32_bf16 v[4:7], v[96:99], v[132:135], v[4:7]
    ds_read_b128 v[196:199], v215 offset:4096
    v_mfma_f32_16x16x32_bf16 v[8:11], v[96:99], v[136:139], v[8:11]
    ds_read_b64_tr_b16 v[156:157], v216
    v_mfma_f32_16x16x32_bf16 v[12:15], v[100:103], v[128:131], v[12:15]
    ds_read_b64_tr_b16 v[158:159], v216 offset:4096
    v_mfma_f32_16x16x32_bf16 v[16:19], v[100:103], v[132:135], v[16:19]
    ds_read_b64_tr_b16 v[160:161], v216 offset:8
    v_mfma_f32_16x16x32_bf16 v[20:23], v[100:103], v[136:139], v[20:23]
    ds_read_b64_tr_b16 v[162:163], v216 offset:4104
    v_mfma_f32_16x16x32_bf16 v[24:27], v[104:107], v[128:131], v[24:27]
    ds_read_b64_tr_b16 v[164:165], v217
    v_mfma_f32_16x16x32_bf16 v[28:31], v[104:107], v[132:135], v[28:31]
    ds_read_b64_tr_b16 v[166:167], v217 offset:4096
    v_mfma_f32_16x16x32_bf16 v[32:35], v[104:107], v[136:139], v[32:35]
    ds_read_b64_tr_b16 v[168:169], v217 offset:8
    v_mfma_f32_16x16x32_bf16 v[36:39], v[108:111], v[128:131], v[36:39]
    ds_read_b64_tr_b16 v[170:171], v217 offset:4104
    v_mfma_f32_16x16x32_bf16 v[40:43], v[108:111], v[132:135], v[40:43]
    ds_read_b64_tr_b16 v[172:173], v216 offset:2048
    v_mfma_f32_16x16x32_bf16 v[44:47], v[108:111], v[136:139], v[44:47]
    ds_read_b64_tr_b16 v[174:175], v216 offset:6144
    v_mfma_f32_16x16x32_bf16 v[48:51], v[112:115], v[128:131], v[48:51]
    ds_read_b64_tr_b16 v[176:177], v216 offset:2056
    v_mfma_f32_16x16x32_bf16 v[52:55], v[112:115], v[132:135], v[52:55]
    ds_read_b64_tr_b16 v[178:179], v216 offset:6152
    v_mfma_f32_16x16x32_bf16 v[56:59], v[112:115], v[136:139], v[56:59]
    ds_read_b64_tr_b16 v[180:181], v217 offset:2048
    v_mfma_f32_16x16x32_bf16 v[60:63], v[116:119], v[128:131], v[60:63]
    ds_read_b64_tr_b16 v[182:183], v217 offset:6144
    v_mfma_f32_16x16x32_bf16 v[64:67], v[116:119], v[132:135], v[64:67]
    ds_read_b64_tr_b16 v[184:185], v217 offset:2056
    v_mfma_f32_16x16x32_bf16 v[68:71], v[116:119], v[136:139], v[68:71]
    ds_read_b64_tr_b16 v[186:187], v217 offset:6152
    v_mfma_f32_16x16x32_bf16 v[72:75], v[120:123], v[128:131], v[72:75]
    v_mfma_f32_16x16x32_bf16 v[76:79], v[120:123], v[132:135], v[76:79]
    s_bfe_i32 s45, s73, s49
    s_lshl_b32 s45, s45, 14
    s_add_u32 s49, s49, 4
    s_cmp_eq_u32 s49, 0x40018
    s_cselect_b32 s49, 0x40000, s49
    v_mfma_f32_16x16x32_bf16 v[80:83], v[120:123], v[136:139], v[80:83]
    v_add_u32 v216, s45, v216
    v_add_u32 v217, s45, v217
    s_add_u32 s90, s90, 1
    s_cmp_eq_u32 s90, 3
    s_cselect_b32 s50, 0xffff6000, s75
    v_mfma_f32_16x16x32_bf16 v[84:87], v[124:127], v[128:131], v[84:87]
    s_cselect_b32 s90, 0, s90
    v_add_u32 v214, s50, v214
    v_add_u32 v215, s50, v215
    v_add_u32 v214, s52, v214
    v_add_u32 v215, s52, v215
    v_mfma_f32_16x16x32_bf16 v[88:91], v[124:127], v[132:135], v[88:91]
    v_add_u32 v214, 0xfffe3000, v214
    v_add_u32 v215, 0xfffe3000, v215
    v_xor_b32 v216, 64, v218
    v_xor_b32 v217, 64, v219
    v_mfma_f32_16x16x32_bf16 v[92:95], v[124:127], v[136:139], v[92:95]
    s_waitcnt lgkmcnt(0)
    s_barrier
    ds_read_b128 v[220:223], v214
    ds_read_b128 v[224:227], v214 offset:4096
    ds_read_b128 v[228:231], v215
    ds_read_b128 v[232:235], v215 offset:4096
    ds_read_b128 v[236:239], v214 offset:2048
    ds_read_b128 v[240:243], v214 offset:6144
    ds_read_b128 v[244:247], v215 offset:2048
    v_mfma_f32_16x16x32_bf16 v[0:3], v[156:159], v[188:191], v[0:3]
    v_mfma_f32_16x16x32_bf16 v[4:7], v[156:159], v[192:195], v[4:7]
    v_mfma_f32_16x16x32_bf16 v[8:11], v[156:159], v[196:199], v[8:11]
    v_mfma_f32_16x16x32_bf16 v[12:15], v[160:163], v[188:191], v[12:15]
    v_mfma_f32_16x16x32_bf16 v[16:19], v[160:163], v[192:195], v[16:19]
    v_mfma_f32_16x16x32_bf16 v[20:23], v[160:163], v[196:199], v[20:23]
    v_mfma_f32_16x16x32_bf16 v[24:27], v[164:167], v[188:191], v[24:27]
    v_mfma_f32_16x16x32_bf16 v[28:31], v[164:167], v[192:195], v[28:31]
    v_mfma_f32_16x16x32_bf16 v[32:35], v[164:167], v[196:199], v[32:35]
    v_mul_f32 v0, s72, v0
    v_mul_f32 v1, s72, v1
    v_mul_f32 v2, s72, v2
    v_mul_f32 v3, s72, v3
    v_cvt_pk_bf16_f32 v96, v0, v1
    v_cvt_pk_bf16_f32 v97, v2, v3
    v_mfma_f32_16x16x32_bf16 v[36:39], v[168:171], v[188:191], v[36:39]
    v_mul_f32 v12, s72, v12
    v_mul_f32 v13, s72, v13
    v_mul_f32 v14, s72, v14
    v_mul_f32 v15, s72, v15
    v_cvt_pk_bf16_f32 v98, v12, v13
    v_mfma_f32_16x16x32_bf16 v[40:43], v[168:171], v[192:195], v[40:43]
    v_cvt_pk_bf16_f32 v99, v14, v15
    v_mul_f32 v4, s72, v4
    v_mul_f32 v5, s72, v5
    v_mul_f32 v6, s72, v6
    v_mul_f32 v7, s72, v7
    v_mfma_f32_16x16x32_bf16 v[44:47], v[168:171], v[196:199], v[44:47]
    v_cvt_pk_bf16_f32 v100, v4, v5
    v_cvt_pk_bf16_f32 v101, v6, v7
    v_mul_f32 v16, s72, v16
    v_mul_f32 v17, s72, v17
    v_mul_f32 v18, s72, v18
    v_mfma_f32_16x16x32_bf16 v[48:51], v[172:175], v[188:191], v[48:51]
    v_mul_f32 v19, s72, v19
    v_cvt_pk_bf16_f32 v102, v16, v17
    v_cvt_pk_bf16_f32 v103, v18, v19
    v_mul_f32 v8, s72, v8
    v_mul_f32 v9, s72, v9
    v_mfma_f32_16x16x32_bf16 v[52:55], v[172:175], v[192:195], v[52:55]
    v_mul_f32 v10, s72, v10
    v_mul_f32 v11, s72, v11
    v_cvt_pk_bf16_f32 v104, v8, v9
    v_cvt_pk_bf16_f32 v105, v10, v11
    v_mul_f32 v20, s72, v20
    v_mfma_f32_16x16x32_bf16 v[56:59], v[172:175], v[196:199], v[56:59]
    v_mul_f32 v21, s72, v21
    v_mul_f32 v22, s72, v22
    v_mul_f32 v23, s72, v23
    v_cvt_pk_bf16_f32 v106, v20, v21
    v_cvt_pk_bf16_f32 v107, v22, v23
    v_mfma_f32_16x16x32_bf16 v[60:63], v[176:179], v[188:191], v[60:63]
    v_mul_f32 v24, s72, v24
    v_mul_f32 v25, s72, v25
    v_mul_f32 v26, s72, v26
    v_mul_f32 v27, s72, v27
    v_mfma_f32_16x16x32_bf16 v[64:67], v[176:179], v[192:195], v[64:67]
    v_cvt_pk_bf16_f32 v108, v24, v25
    v_cvt_pk_bf16_f32 v109, v26, v27
    v_mul_f32 v36, s72, v36
    v_mul_f32 v37, s72, v37
    v_mfma_f32_16x16x32_bf16 v[68:71], v[176:179], v[196:199], v[68:71]
    v_mul_f32 v38, s72, v38
    v_mul_f32 v39, s72, v39
    v_cvt_pk_bf16_f32 v110, v36, v37
    v_cvt_pk_bf16_f32 v111, v38, v39
    v_mfma_f32_16x16x32_bf16 v[72:75], v[180:183], v[188:191], v[72:75]
    v_mul_f32 v28, s72, v28
    v_mul_f32 v29, s72, v29
    v_mul_f32 v30, s72, v30
    v_mul_f32 v31, s72, v31
    v_mfma_f32_16x16x32_bf16 v[76:79], v[180:183], v[192:195], v[76:79]
    v_cvt_pk_bf16_f32 v112, v28, v29
    v_cvt_pk_bf16_f32 v113, v30, v31
    v_mul_f32 v40, s72, v40
    v_mul_f32 v41, s72, v41
    v_mfma_f32_16x16x32_bf16 v[80:83], v[180:183], v[196:199], v[80:83]
    v_mul_f32 v42, s72, v42
    v_mul_f32 v43, s72, v43
    v_cvt_pk_bf16_f32 v114, v40, v41
    v_cvt_pk_bf16_f32 v115, v42, v43
    v_mfma_f32_16x16x32_bf16 v[84:87], v[184:187], v[188:191], v[84:87]
    v_mul_f32 v32, s72, v32
    v_mul_f32 v33, s72, v33
    v_mul_f32 v34, s72, v34
    v_mul_f32 v35, s72, v35
    v_mfma_f32_16x16x32_bf16 v[88:91], v[184:187], v[192:195], v[88:91]
    v_cvt_pk_bf16_f32 v116, v32, v33
    v_cvt_pk_bf16_f32 v117, v34, v35
    v_mul_f32 v44, s72, v44
    v_mul_f32 v45, s72, v45
    v_mfma_f32_16x16x32_bf16 v[92:95], v[184:187], v[196:199], v[92:95]
    v_mul_f32 v46, s72, v46
    v_mul_f32 v47, s72, v47
    v_cvt_pk_bf16_f32 v118, v44, v45
    v_cvt_pk_bf16_f32 v119, v46, v47
    s_waitcnt lgkmcnt(6)
    v_mfma_f32_16x16x32_bf16 v[156:159], v[220:223], v[96:99], 0
    v_mul_f32 v48, s72, v48
    v_mul_f32 v49, s72, v49
    v_mul_f32 v50, s72, v50
    v_mul_f32 v51, s72, v51
    v_mfma_f32_16x16x32_bf16 v[160:163], v[220:223], v[100:103], 0
    v_cvt_pk_bf16_f32 v120, v48, v49
    v_cvt_pk_bf16_f32 v121, v50, v51
    v_mul_f32 v60, s72, v60
    v_mul_f32 v61, s72, v61
    v_mfma_f32_16x16x32_bf16 v[164:167], v[220:223], v[104:107], 0
    ds_read_b128 v[248:251], v215 offset:6144
    v_mul_f32 v62, s72, v62
    v_mul_f32 v63, s72, v63
    v_cvt_pk_bf16_f32 v122, v60, v61
    v_cvt_pk_bf16_f32 v123, v62, v63
    s_waitcnt lgkmcnt(6)
    v_mfma_f32_16x16x32_bf16 v[168:171], v[224:227], v[96:99], 0
    v_mul_f32 v52, s72, v52
    v_mul_f32 v53, s72, v53
    v_mul_f32 v54, s72, v54
    v_mul_f32 v55, s72, v55
    v_mfma_f32_16x16x32_bf16 v[172:175], v[224:227], v[100:103], 0
    v_cvt_pk_bf16_f32 v124, v52, v53
    v_cvt_pk_bf16_f32 v125, v54, v55
    v_mul_f32 v64, s72, v64
    v_mul_f32 v65, s72, v65
    v_mfma_f32_16x16x32_bf16 v[176:179], v[224:227], v[104:107], 0
    v_add_u32 v214, 0x4000, v214
    v_add_u32 v215, 0x4000, v215
    ds_read_b128 v[220:223], v214
    v_mul_f32 v66, s72, v66
    v_mul_f32 v67, s72, v67
    v_cvt_pk_bf16_f32 v126, v64, v65
    v_cvt_pk_bf16_f32 v127, v66, v67
    s_waitcnt lgkmcnt(6)
    v_mfma_f32_16x16x32_bf16 v[156:159], v[228:231], v[108:111], v[156:159]
    v_mul_f32 v56, s72, v56
    v_mul_f32 v57, s72, v57
    v_mul_f32 v58, s72, v58
    v_mul_f32 v59, s72, v59
    v_mfma_f32_16x16x32_bf16 v[160:163], v[228:231], v[112:115], v[160:163]
    v_cvt_pk_bf16_f32 v128, v56, v57
    v_cvt_pk_bf16_f32 v129, v58, v59
    v_mul_f32 v68, s72, v68
    v_mul_f32 v69, s72, v69
    v_mfma_f32_16x16x32_bf16 v[164:167], v[228:231], v[116:119], v[164:167]
    ds_read_b128 v[224:227], v214 offset:4096
    v_mul_f32 v70, s72, v70
    v_mul_f32 v71, s72, v71
    v_cvt_pk_bf16_f32 v130, v68, v69
    v_cvt_pk_bf16_f32 v131, v70, v71
    s_waitcnt lgkmcnt(6)
    v_mfma_f32_16x16x32_bf16 v[168:171], v[232:235], v[108:111], v[168:171]
    v_mul_f32 v72, s72, v72
    v_mul_f32 v73, s72, v73
    v_mul_f32 v74, s72, v74
    v_mul_f32 v75, s72, v75
    v_cvt_pk_bf16_f32 v132, v72, v73
    v_mfma_f32_16x16x32_bf16 v[172:175], v[232:235], v[112:115], v[172:175]
    v_cvt_pk_bf16_f32 v133, v74, v75
    v_mul_f32 v84, s72, v84
    v_mul_f32 v85, s72, v85
    v_mul_f32 v86, s72, v86
    v_mfma_f32_16x16x32_bf16 v[176:179], v[232:235], v[116:119], v[176:179]
    ds_read_b128 v[228:231], v215
    v_mul_f32 v87, s72, v87
    v_cvt_pk_bf16_f32 v134, v84, v85
    v_cvt_pk_bf16_f32 v135, v86, v87
    v_mul_f32 v76, s72, v76
    v_mul_f32 v77, s72, v77
    s_waitcnt lgkmcnt(6)
    v_mfma_f32_16x16x32_bf16 v[156:159], v[236:239], v[120:123], v[156:159]
    v_mul_f32 v78, s72, v78
    v_mul_f32 v79, s72, v79
    v_cvt_pk_bf16_f32 v136, v76, v77
    v_cvt_pk_bf16_f32 v137, v78, v79
    v_mfma_f32_16x16x32_bf16 v[160:163], v[236:239], v[124:127], v[160:163]
    v_mul_f32 v88, s72, v88
    v_mul_f32 v89, s72, v89
    v_mul_f32 v90, s72, v90
    v_mul_f32 v91, s72, v91
    v_cvt_pk_bf16_f32 v138, v88, v89
    v_mfma_f32_16x16x32_bf16 v[164:167], v[236:239], v[128:131], v[164:167]
    ds_read_b128 v[232:235], v215 offset:4096
    v_cvt_pk_bf16_f32 v139, v90, v91
    v_mul_f32 v80, s72, v80
    v_mul_f32 v81, s72, v81
    v_mul_f32 v82, s72, v82
    s_waitcnt lgkmcnt(6)
    v_mfma_f32_16x16x32_bf16 v[168:171], v[240:243], v[120:123], v[168:171]
    v_mul_f32 v83, s72, v83
    v_cvt_pk_bf16_f32 v140, v80, v81
    v_cvt_pk_bf16_f32 v141, v82, v83
    v_mul_f32 v92, s72, v92
    v_mul_f32 v93, s72, v93
    v_mfma_f32_16x16x32_bf16 v[172:175], v[240:243], v[124:127], v[172:175]
    v_mul_f32 v94, s72, v94
    v_mul_f32 v95, s72, v95
    v_cvt_pk_bf16_f32 v142, v92, v93
    v_cvt_pk_bf16_f32 v143, v94, v95
    v_mfma_f32_16x16x32_bf16 v[176:179], v[240:243], v[128:131], v[176:179]
    ds_read_b128 v[236:239], v214 offset:2048
    s_waitcnt lgkmcnt(6)
    v_mfma_f32_16x16x32_bf16 v[156:159], v[244:247], v[132:135], v[156:159]
    v_mfma_f32_16x16x32_bf16 v[160:163], v[244:247], v[136:139], v[160:163]
    v_mfma_f32_16x16x32_bf16 v[164:167], v[244:247], v[140:143], v[164:167]
    ds_read_b128 v[240:243], v214 offset:6144
    s_waitcnt lgkmcnt(6)
    v_mfma_f32_16x16x32_bf16 v[168:171], v[248:251], v[132:135], v[168:171]
    v_mfma_f32_16x16x32_bf16 v[172:175], v[248:251], v[136:139], v[172:175]
    v_mfma_f32_16x16x32_bf16 v[176:179], v[248:251], v[140:143], v[176:179]
    ds_read_b128 v[244:247], v215 offset:2048
    v_max3_f32 v207, v156, v157, v158
    s_nop 3
    v_max3_f32 v207, v207, v159, v168
    v_max3_f32 v207, v207, v169, v170
    v_max_f32 v207, v207, v171
    v_max3_f32 v208, v160, v161, v162
    v_max3_f32 v208, v208, v163, v172
    v_max3_f32 v208, v208, v173, v174
    v_max_f32 v208, v208, v175
    v_max3_f32 v209, v164, v165, v166
    v_max3_f32 v209, v209, v167, v176
    v_max3_f32 v209, v209, v177, v178
    v_max_f32 v209, v209, v179
    v_mov_b32 v210, v207
    v_mov_b32 v211, v208
    v_mov_b32 v212, v209
    v_permlane32_swap_b32 v207, v210
    v_permlane32_swap_b32 v208, v211
    v_permlane32_swap_b32 v209, v212
    v_max_f32 v207, v207, v210
    v_max_f32 v208, v208, v211
    v_max_f32 v209, v209, v212
    v_mov_b32 v210, v207
    v_mov_b32 v211, v208
    v_mov_b32 v212, v209
    v_permlane16_swap_b32 v207, v210
    v_permlane16_swap_b32 v208, v211
    v_permlane16_swap_b32 v209, v212
    v_max_f32 v207, v207, v210
    v_max_f32 v208, v208, v211
    v_max_f32 v209, v209, v212
    v_sub_f32 v144, 0, v207
    v_sub_f32 v145, 0, v207
    v_sub_f32 v146, 0, v207
    v_sub_f32 v147, 0, v207
    v_sub_f32 v156, v156, v207
    v_sub_f32 v157, v157, v207
    v_sub_f32 v158, v158, v207
    v_sub_f32 v159, v159, v207
    v_sub_f32 v168, v168, v207
    v_sub_f32 v169, v169, v207
    v_sub_f32 v170, v170, v207
    v_sub_f32 v171, v171, v207
    v_sub_f32 v148, 0, v208
    v_sub_f32 v149, 0, v208
    v_sub_f32 v150, 0, v208
    v_sub_f32 v151, 0, v208
    v_sub_f32 v160, v160, v208
    v_sub_f32 v161, v161, v208
    v_sub_f32 v162, v162, v208
    v_sub_f32 v163, v163, v208
    v_sub_f32 v172, v172, v208
    v_sub_f32 v173, v173, v208
    v_sub_f32 v174, v174, v208
    v_sub_f32 v175, v175, v208
    v_sub_f32 v152, 0, v209
    v_sub_f32 v153, 0, v209
    v_sub_f32 v154, 0, v209
    v_sub_f32 v155, 0, v209
    v_sub_f32 v164, v164, v209
    v_sub_f32 v165, v165, v209
    v_sub_f32 v166, v166, v209
    v_sub_f32 v167, v167, v209
    v_sub_f32 v176, v176, v209
    v_sub_f32 v177, v177, v209
    v_sub_f32 v178, v178, v209
    v_sub_f32 v179, v179, v209
    s_barrier
    v_exp_f32 v210, v156
    v_exp_f32 v211, v157
    v_exp_f32 v212, v158
    v_add_f32 v207, v210, v211
    v_cvt_pk_bf16_f32 v180, v210, v211
    v_exp_f32 v213, v159
    v_exp_f32 v210, v160
    v_add_f32 v207, v207, v212
    v_cvt_pk_bf16_f32 v181, v212, v213
    v_add_f32 v207, v207, v213
    v_exp_f32 v211, v161
    v_exp_f32 v212, v162
    v_add_f32 v208, v210, v211
    v_cvt_pk_bf16_f32 v184, v210, v211
    v_exp_f32 v213, v163
    v_exp_f32 v210, v164
    v_add_f32 v208, v208, v212
    v_cvt_pk_bf16_f32 v185, v212, v213
    v_add_f32 v208, v208, v213
    v_exp_f32 v211, v165
    v_exp_f32 v212, v166
    v_add_f32 v209, v210, v211
    v_cvt_pk_bf16_f32 v188, v210, v211
    v_exp_f32 v213, v167
    v_exp_f32 v210, v168
    v_add_f32 v209, v209, v212
    v_cvt_pk_bf16_f32 v189, v212, v213
    v_add_f32 v209, v209, v213
    v_exp_f32 v211, v169
    v_exp_f32 v212, v170
    v_add_f32 v207, v207, v210
    v_cvt_pk_bf16_f32 v182, v210, v211
    v_add_f32 v207, v207, v211
    v_exp_f32 v213, v171
    v_exp_f32 v210, v172
    v_add_f32 v207, v207, v212
    v_cvt_pk_bf16_f32 v183, v212, v213
    v_add_f32 v207, v207, v213
    v_exp_f32 v211, v173
    v_exp_f32 v212, v174
    v_add_f32 v208, v208, v210
    v_cvt_pk_bf16_f32 v186, v210, v211
    v_add_f32 v208, v208, v211
    v_exp_f32 v213, v175
    v_exp_f32 v210, v176
    v_add_f32 v208, v208, v212
    v_cvt_pk_bf16_f32 v187, v212, v213
    v_add_f32 v208, v208, v213
    v_exp_f32 v211, v177
    v_exp_f32 v212, v178
    v_add_f32 v209, v209, v210
    v_cvt_pk_bf16_f32 v190, v210, v211
    v_add_f32 v209, v209, v211
    v_exp_f32 v213, v179
    v_add_f32 v209, v209, v212
    v_cvt_pk_bf16_f32 v191, v212, v213
    v_add_f32 v209, v209, v213
    v_mov_b32 v204, v207
    v_mov_b32 v205, v208
    v_mov_b32 v206, v209
    s_cmp_lg_u32 s33, 1
    s_cbranch_scc1 L_ex_code
    s_getpc_b64 s[46:47]
L_pc1:
    s_add_u32 s46, s46, L_o-L_pc1
    s_addc_u32 s47, s47, 0
    v_mbcnt_lo_u32_b32 v254, -1, 0
    v_mbcnt_hi_u32_b32 v254, -1, v254
    s_lshl_b32 s41, s32, 13
    v_lshlrev_b32 v254, 7, v254
    v_add_u32 v254, s41, v254
    v_min_u32 v254, KEND-L_o-4, v254
    global_load_dword v252, v254, s[46:47]
L_ex_code:
    s_mov_b32 s43, 16384
    s_mov_b32 s44, 32768
    s_mov_b32 s51, 7
    s_waitcnt lgkmcnt(6)
    v_mfma_f32_16x16x32_bf16 v[156:159], v[220:223], v[96:99], v[144:147]
    v_mfma_f32_16x16x32_bf16 v[160:163], v[220:223], v[100:103], v[148:151]
    v_mfma_f32_16x16x32_bf16 v[164:167], v[220:223], v[104:107], v[152:155]
    ds_read_b128 v[248:251], v215 offset:6144
    s_waitcnt lgkmcnt(6)
    v_mfma_f32_16x16x32_bf16 v[168:171], v[224:227], v[96:99], v[144:147]
    v_mfma_f32_16x16x32_bf16 v[172:175], v[224:227], v[100:103], v[148:151]
    v_mfma_f32_16x16x32_bf16 v[176:179], v[224:227], v[104:107], v[152:155]
    ds_read_b64_tr_b16 v[220:221], v216
    ds_read_b64_tr_b16 v[222:223], v216 offset:4096
    s_waitcnt lgkmcnt(7)
    v_mfma_f32_16x16x32_bf16 v[156:159], v[228:231], v[108:111], v[156:159]
    v_mfma_f32_16x16x32_bf16 v[160:163], v[228:231], v[112:115], v[160:163]
    v_mfma_f32_16x16x32_bf16 v[164:167], v[228:231], v[116:119], v[164:167]
    ds_read_b64_tr_b16 v[224:225], v217
    ds_read_b64_tr_b16 v[226:227], v217 offset:4096
    s_waitcnt lgkmcnt(8)
    v_mfma_f32_16x16x32_bf16 v[168:171], v[232:235], v[108:111], v[168:171]
    v_mfma_f32_16x16x32_bf16 v[172:175], v[232:235], v[112:115], v[172:175]
    v_mfma_f32_16x16x32_bf16 v[176:179], v[232:235], v[116:119], v[176:179]
    ds_read_b64_tr_b16 v[228:229], v218
    ds_read_b64_tr_b16 v[230:231], v218 offset:4096
    s_waitcnt lgkmcnt(9)
    v_mfma_f32_16x16x32_bf16 v[156:159], v[236:239], v[120:123], v[156:159]
    v_mfma_f32_16x16x32_bf16 v[160:163], v[236:239], v[124:127], v[160:163]
    v_mfma_f32_16x16x32_bf16 v[164:167], v[236:239], v[128:131], v[164:167]
    ds_read_b64_tr_b16 v[232:233], v219
    ds_read_b64_tr_b16 v[234:235], v219 offset:4096
    s_waitcnt lgkmcnt(10)
    v_mfma_f32_16x16x32_bf16 v[168:171], v[240:243], v[120:123], v[168:171]
    v_mfma_f32_16x16x32_bf16 v[172:175], v[240:243], v[124:127], v[172:175]
    v_mfma_f32_16x16x32_bf16 v[176:179], v[240:243], v[128:131], v[176:179]
    ds_read_b64_tr_b16 v[236:237], v216 offset:2048
    ds_read_b64_tr_b16 v[238:239], v216 offset:6144
    s_waitcnt lgkmcnt(11)
    v_mfma_f32_16x16x32_bf16 v[156:159], v[244:247], v[132:135], v[156:159]
    v_mfma_f32_16x16x32_bf16 v[160:163], v[244:247], v[136:139], v[160:163]
    v_mfma_f32_16x16x32_bf16 v[164:167], v[244:247], v[140:143], v[164:167]
    ds_read_b64_tr_b16 v[240:241], v217 offset:2048
    ds_read_b64_tr_b16 v[242:243], v217 offset:6144
    s_waitcnt lgkmcnt(12)
    v_mfma_f32_16x16x32_bf16 v[168:171], v[248:251], v[132:135], v[168:171]
    v_mfma_f32_16x16x32_bf16 v[172:175], v[248:251], v[136:139], v[172:175]
    v_mfma_f32_16x16x32_bf16 v[176:179], v[248:251], v[140:143], v[176:179]
    ds_read_b64_tr_b16 v[244:245], v218 offset:2048
    ds_read_b64_tr_b16 v[246:247], v218 offset:6144
    s_barrier
    s_waitcnt lgkmcnt(12)
    v_mfma_f32_16x16x32_bf16 v[0:3], v[220:223], v[180:183], 0
    v_exp_f32 v210, v156
    v_exp_f32 v211, v157
    v_mfma_f32_16x16x32_bf16 v[4:7], v[220:223], v[184:187], 0
    v_exp_f32 v212, v158
    v_add_f32 v207, v210, v211
    v_cvt_pk_bf16_f32 v192, v210, v211
    v_mfma_f32_16x16x32_bf16 v[8:11], v[220:223], v[188:191], 0
    ds_read_b64_tr_b16 v[248:249], v219 offset:2048
    ds_read_b64_tr_b16 v[250:251], v219 offset:6144
    v_exp_f32 v213, v159
    v_exp_f32 v210, v160
    s_waitcnt lgkmcnt(12)
    v_mfma_f32_16x16x32_bf16 v[12:15], v[224:227], v[180:183], 0
    v_add_f32 v207, v207, v212
    v_cvt_pk_bf16_f32 v193, v212, v213
    v_add_f32 v207, v207, v213
    v_exp_f32 v211, v161
    v_mfma_f32_16x16x32_bf16 v[16:19], v[224:227], v[184:187], 0
    v_exp_f32 v212, v162
    v_mfma_f32_16x16x32_bf16 v[20:23], v[224:227], v[188:191], 0
    s_cmp_ge_u32 s43, 131072
    s_cselect_b32 s45, 0xfffe0000, s74
    s_add_u32 s43, s43, s45
    v_add_u32 v214, s45, v214
    v_add_u32 v215, s45, v215
    ds_read_b128 v[220:223], v214
    v_add_f32 v208, v210, v211
    v_cvt_pk_bf16_f32 v196, v210, v211
    v_exp_f32 v213, v163
    s_waitcnt lgkmcnt(11)
    v_mfma_f32_16x16x32_bf16 v[24:27], v[228:231], v[180:183], 0
    v_exp_f32 v210, v164
    v_add_f32 v208, v208, v212
    v_cvt_pk_bf16_f32 v197, v212, v213
    v_add_f32 v208, v208, v213
    v_mfma_f32_16x16x32_bf16 v[28:31], v[228:231], v[184:187], 0
    v_exp_f32 v211, v165
    v_exp_f32 v212, v166
    v_mfma_f32_16x16x32_bf16 v[32:35], v[228:231], v[188:191], 0
    ds_read_b128 v[224:227], v214 offset:4096
    v_add_f32 v209, v210, v211
    v_cvt_pk_bf16_f32 v200, v210, v211
    s_waitcnt lgkmcnt(10)
    v_mfma_f32_16x16x32_bf16 v[36:39], v[232:235], v[180:183], 0
    v_exp_f32 v213, v167
    v_exp_f32 v210, v168
    v_mfma_f32_16x16x32_bf16 v[40:43], v[232:235], v[184:187], 0
    v_add_f32 v209, v209, v212
    v_cvt_pk_bf16_f32 v201, v212, v213
    v_add_f32 v209, v209, v213
    v_exp_f32 v211, v169
    v_mfma_f32_16x16x32_bf16 v[44:47], v[232:235], v[188:191], 0
    ds_read_b128 v[228:231], v215
    v_exp_f32 v212, v170
    v_add_f32 v207, v207, v210
    v_cvt_pk_bf16_f32 v194, v210, v211
    v_add_f32 v207, v207, v211
    s_waitcnt lgkmcnt(9)
    v_mfma_f32_16x16x32_bf16 v[48:51], v[236:239], v[180:183], 0
    v_exp_f32 v213, v171
    v_mfma_f32_16x16x32_bf16 v[52:55], v[236:239], v[184:187], 0
    v_exp_f32 v210, v172
    v_add_f32 v207, v207, v212
    v_cvt_pk_bf16_f32 v195, v212, v213
    v_add_f32 v207, v207, v213
    v_mfma_f32_16x16x32_bf16 v[56:59], v[236:239], v[188:191], 0
    ds_read_b128 v[232:235], v215 offset:4096
    v_exp_f32 v211, v173
    v_exp_f32 v212, v174
    s_waitcnt lgkmcnt(8)
    v_mfma_f32_16x16x32_bf16 v[60:63], v[240:243], v[180:183], 0
    v_add_f32 v208, v208, v210
    v_cvt_pk_bf16_f32 v198, v210, v211
    v_add_f32 v208, v208, v211
    v_exp_f32 v213, v175
    v_mfma_f32_16x16x32_bf16 v[64:67], v[240:243], v[184:187], 0
    v_exp_f32 v210, v176
    v_mfma_f32_16x16x32_bf16 v[68:71], v[240:243], v[188:191], 0
    ds_read_b128 v[236:239], v214 offset:2048
    v_add_f32 v208, v208, v212
    v_cvt_pk_bf16_f32 v199, v212, v213
    v_add_f32 v208, v208, v213
    v_exp_f32 v211, v177
    s_waitcnt lgkmcnt(7)
    v_mfma_f32_16x16x32_bf16 v[72:75], v[244:247], v[180:183], 0
    v_exp_f32 v212, v178
    v_add_f32 v209, v209, v210
    v_cvt_pk_bf16_f32 v202, v210, v211
    v_add_f32 v209, v209, v211
    v_mfma_f32_16x16x32_bf16 v[76:79], v[244:247], v[184:187], 0
    v_exp_f32 v213, v179
    v_add_f32 v209, v209, v212
    v_cvt_pk_bf16_f32 v203, v212, v213
    v_add_f32 v209, v209, v213
    v_mfma_f32_16x16x32_bf16 v[80:83], v[244:247], v[188:191], 0
    ds_read_b128 v[240:243], v214 offset:6144
    v_max3_f32 v253, v207, v208, v209
    v_cmp_nge_f32 vcc, 0x46800000, v253
    s_waitcnt lgkmcnt(6)
    v_mfma_f32_16x16x32_bf16 v[84:87], v[248:251], v[180:183], 0
    v_mfma_f32_16x16x32_bf16 v[88:91], v[248:251], v[184:187], 0
    v_mfma_f32_16x16x32_bf16 v[92:95], v[248:251], v[188:191], 0
    ds_read_b128 v[244:247], v215 offset:2048
    s_cbranch_vccnz L_stub15
L_back15:
L_w3_a:
    s_waitcnt lgkmcnt(6)
    v_mfma_f32_16x16x32_bf16 v[156:159], v[220:223], v[96:99], v[144:147]
    v_mfma_f32_16x16x32_bf16 v[160:163], v[220:223], v[100:103], v[148:151]
    v_mfma_f32_16x16x32_bf16 v[164:167], v[220:223], v[104:107], v[152:155]
    ds_read_b128 v[248:251], v215 offset:6144
    s_waitcnt lgkmcnt(6)
    v_mfma_f32_16x16x32_bf16 v[168:171], v[224:227], v[96:99], v[144:147]
    v_mfma_f32_16x16x32_bf16 v[172:175], v[224:227], v[100:103], v[148:151]
    v_add_f32 v204, v204, v207
    v_mfma_f32_16x16x32_bf16 v[176:179], v[224:227], v[104:107], v[152:155]
    s_cmp_ge_u32 s44, 131072
    s_cselect_b32 s45, 0xfffe0000, s74
    s_add_u32 s44, s44, s45
    v_add_u32 v216, s45, v216
    v_add_u32 v217, s45, v217
    v_add_u32 v218, s45, v218
    v_add_u32 v219, s45, v219
    ds_read_b64_tr_b16 v[220:221], v216
    ds_read_b64_tr_b16 v[222:223], v216 offset:4096
    s_waitcnt lgkmcnt(7)
    v_mfma_f32_16x16x32_bf16 v[156:159], v[228:231], v[108:111], v[156:159]
    v_add_f32 v205, v205, v208
    v_mfma_f32_16x16x32_bf16 v[160:163], v[228:231], v[112:115], v[160:163]
    v_mfma_f32_16x16x32_bf16 v[164:167], v[228:231], v[116:119], v[164:167]
    ds_read_b64_tr_b16 v[224:225], v217
    ds_read_b64_tr_b16 v[226:227], v217 offset:4096
    v_add_f32 v206, v206, v209
    s_waitcnt lgkmcnt(8)
    v_mfma_f32_16x16x32_bf16 v[168:171], v[232:235], v[108:111], v[168:171]
    v_mfma_f32_16x16x32_bf16 v[172:175], v[232:235], v[112:115], v[172:175]
    v_mfma_f32_16x16x32_bf16 v[176:179], v[232:235], v[116:119], v[176:179]
    ds_read_b64_tr_b16 v[228:229], v218
    ds_read_b64_tr_b16 v[230:231], v218 offset:4096
    s_waitcnt lgkmcnt(9)
    v_mfma_f32_16x16x32_bf16 v[156:159], v[236:239], v[120:123], v[156:159]
    v_mfma_f32_16x16x32_bf16 v[160:163], v[236:239], v[124:127], v[160:163]
    v_mfma_f32_16x16x32_bf16 v[164:167], v[236:239], v[128:131], v[164:167]
    ds_read_b64_tr_b16 v[232:233], v219
    ds_read_b64_tr_b16 v[234:235], v219 offset:4096
    s_waitcnt lgkmcnt(10)
    v_mfma_f32_16x16x32_bf16 v[168:171], v[240:243], v[120:123], v[168:171]
    v_mfma_f32_16x16x32_bf16 v[172:175], v[240:243], v[124:127], v[172:175]
    v_mfma_f32_16x16x32_bf16 v[176:179], v[240:243], v[128:131], v[176:179]
    ds_read_b64_tr_b16 v[236:237], v216 offset:2048
    ds_read_b64_tr_b16 v[238:239], v216 offset:6144
    s_waitcnt lgkmcnt(11)
    v_mfma_f32_16x16x32_bf16 v[156:159], v[244:247], v[132:135], v[156:159]
    v_mfma_f32_16x16x32_bf16 v[160:163], v[244:247], v[136:139], v[160:163]
    v_mfma_f32_16x16x32_bf16 v[164:167], v[244:247], v[140:143], v[164:167]
    ds_read_b64_tr_b16 v[240:241], v217 offset:2048
    ds_read_b64_tr_b16 v[242:243], v217 offset:6144
    s_waitcnt lgkmcnt(12)
    v_mfma_f32_16x16x32_bf16 v[168:171], v[248:251], v[132:135], v[168:171]
    v_mfma_f32_16x16x32_bf16 v[172:175], v[248:251], v[136:139], v[172:175]
    v_mfma_f32_16x16x32_bf16 v[176:179], v[248:251], v[140:143], v[176:179]
    ds_read_b64_tr_b16 v[244:245], v218 offset:2048
    ds_read_b64_tr_b16 v[246:247], v218 offset:6144
    s_barrier
    s_waitcnt lgkmcnt(12)
    v_mfma_f32_16x16x32_bf16 v[0:3], v[220:223], v[192:195], v[0:3]
    v_exp_f32 v210, v156
    v_exp_f32 v211, v157
    v_mfma_f32_16x16x32_bf16 v[4:7], v[220:223], v[196:199], v[4:7]
    v_exp_f32 v212, v158
    v_add_f32 v207, v210, v211
    v_cvt_pk_bf16_f32 v180, v210, v211
    v_mfma_f32_16x16x32_bf16 v[8:11], v[220:223], v[200:203], v[8:11]
    ds_read_b64_tr_b16 v[248:249], v219 offset:2048
    ds_read_b64_tr_b16 v[250:251], v219 offset:6144
    v_exp_f32 v213, v159
    v_exp_f32 v210, v160
    s_waitcnt lgkmcnt(12)
    v_mfma_f32_16x16x32_bf16 v[12:15], v[224:227], v[192:195], v[12:15]
    v_add_f32 v207, v207, v212
    v_cvt_pk_bf16_f32 v181, v212, v213
    v_add_f32 v207, v207, v213
    v_exp_f32 v211, v161
    v_mfma_f32_16x16x32_bf16 v[16:19], v[224:227], v[196:199], v[16:19]
    v_exp_f32 v212, v162
    v_mfma_f32_16x16x32_bf16 v[20:23], v[224:227], v[200:203], v[20:23]
    s_cmp_ge_u32 s43, 131072
    s_cselect_b32 s45, 0xfffe0000, s74
    s_add_u32 s43, s43, s45
    v_add_u32 v214, s45, v214
    v_add_u32 v215, s45, v215
    ds_read_b128 v[220:223], v214
    v_add_f32 v208, v210, v211
    v_cvt_pk_bf16_f32 v184, v210, v211
    v_exp_f32 v213, v163
    s_waitcnt lgkmcnt(11)
    v_mfma_f32_16x16x32_bf16 v[24:27], v[228:231], v[192:195], v[24:27]
    v_exp_f32 v210, v164
    v_add_f32 v208, v208, v212
    v_cvt_pk_bf16_f32 v185, v212, v213
    v_add_f32 v208, v208, v213
    v_mfma_f32_16x16x32_bf16 v[28:31], v[228:231], v[196:199], v[28:31]
    v_exp_f32 v211, v165
    v_exp_f32 v212, v166
    v_mfma_f32_16x16x32_bf16 v[32:35], v[228:231], v[200:203], v[32:35]
    ds_read_b128 v[224:227], v214 offset:4096
    v_add_f32 v209, v210, v211
    v_cvt_pk_bf16_f32 v188, v210, v211
    s_waitcnt lgkmcnt(10)
    v_mfma_f32_16x16x32_bf16 v[36:39], v[232:235], v[192:195], v[36:39]
    v_exp_f32 v213, v167
    v_exp_f32 v210, v168
    v_mfma_f32_16x16x32_bf16 v[40:43], v[232:235], v[196:199], v[40:43]
    v_add_f32 v209, v209, v212
    v_cvt_pk_bf16_f32 v189, v212, v213
    v_add_f32 v209, v209, v213
    v_exp_f32 v211, v169
    v_mfma_f32_16x16x32_bf16 v[44:47], v[232:235], v[200:203], v[44:47]
    ds_read_b128 v[228:231], v215
    v_exp_f32 v212, v170
    v_add_f32 v207, v207, v210
    v_cvt_pk_bf16_f32 v182, v210, v211
    v_add_f32 v207, v207, v211
    s_waitcnt lgkmcnt(9)
    v_mfma_f32_16x16x32_bf16 v[48:51], v[236:239], v[192:195], v[48:51]
    v_exp_f32 v213, v171
    v_mfma_f32_16x16x32_bf16 v[52:55], v[236:239], v[196:199], v[52:55]
    v_exp_f32 v210, v172
    v_add_f32 v207, v207, v212
    v_cvt_pk_bf16_f32 v183, v212, v213
    v_add_f32 v207, v207, v213
    v_mfma_f32_16x16x32_bf16 v[56:59], v[236:239], v[200:203], v[56:59]
    ds_read_b128 v[232:235], v215 offset:4096
    v_exp_f32 v211, v173
    v_exp_f32 v212, v174
    s_waitcnt lgkmcnt(8)
    v_mfma_f32_16x16x32_bf16 v[60:63], v[240:243], v[192:195], v[60:63]
    v_add_f32 v208, v208, v210
    v_cvt_pk_bf16_f32 v186, v210, v211
    v_add_f32 v208, v208, v211
    v_exp_f32 v213, v175
    v_mfma_f32_16x16x32_bf16 v[64:67], v[240:243], v[196:199], v[64:67]
    v_exp_f32 v210, v176
    v_mfma_f32_16x16x32_bf16 v[68:71], v[240:243], v[200:203], v[68:71]
    ds_read_b128 v[236:239], v214 offset:2048
    v_add_f32 v208, v208, v212
    v_cvt_pk_bf16_f32 v187, v212, v213
    v_add_f32 v208, v208, v213
    v_exp_f32 v211, v177
    s_waitcnt lgkmcnt(7)
    v_mfma_f32_16x16x32_bf16 v[72:75], v[244:247], v[192:195], v[72:75]
    v_exp_f32 v212, v178
    v_add_f32 v209, v209, v210
    v_cvt_pk_bf16_f32 v190, v210, v211
    v_add_f32 v209, v209, v211
    v_mfma_f32_16x16x32_bf16 v[76:79], v[244:247], v[196:199], v[76:79]
    v_exp_f32 v213, v179
    v_add_f32 v209, v209, v212
    v_cvt_pk_bf16_f32 v191, v212, v213
    v_add_f32 v209, v209, v213
    v_mfma_f32_16x16x32_bf16 v[80:83], v[244:247], v[200:203], v[80:83]
    ds_read_b128 v[240:243], v214 offset:6144
    v_max3_f32 v253, v207, v208, v209
    v_cmp_nge_f32 vcc, 0x46800000, v253
    s_waitcnt lgkmcnt(6)
    v_mfma_f32_16x16x32_bf16 v[84:87], v[248:251], v[192:195], v[84:87]
    v_mfma_f32_16x16x32_bf16 v[88:91], v[248:251], v[196:199], v[88:91]
    v_mfma_f32_16x16x32_bf16 v[92:95], v[248:251], v[200:203], v[92:95]
    ds_read_b128 v[244:247], v215 offset:2048
    s_cbranch_vccnz L_stub16
L_back16:
    s_waitcnt lgkmcnt(6)
    v_mfma_f32_16x16x32_bf16 v[156:159], v[220:223], v[96:99], v[144:147]
    v_mfma_f32_16x16x32_bf16 v[160:163], v[220:223], v[100:103], v[148:151]
    v_mfma_f32_16x16x32_bf16 v[164:167], v[220:223], v[104:107], v[152:155]
    ds_read_b128 v[248:251], v215 offset:6144
    s_waitcnt lgkmcnt(6)
    v_mfma_f32_16x16x32_bf16 v[168:171], v[224:227], v[96:99], v[144:147]
    v_mfma_f32_16x16x32_bf16 v[172:175], v[224:227], v[100:103], v[148:151]
    v_add_f32 v204, v204, v207
    v_mfma_f32_16x16x32_bf16 v[176:179], v[224:227], v[104:107], v[152:155]
    s_cmp_ge_u32 s44, 131072
    s_cselect_b32 s45, 0xfffe0000, s74
    s_add_u32 s44, s44, s45
    v_add_u32 v216, s45, v216
    v_add_u32 v217, s45, v217
    v_add_u32 v218, s45, v218
    v_add_u32 v219, s45, v219
    ds_read_b64_tr_b16 v[220:221], v216
    ds_read_b64_tr_b16 v[222:223], v216 offset:4096
    s_waitcnt lgkmcnt(7)
    v_mfma_f32_16x16x32_bf16 v[156:159], v[228:231], v[108:111], v[156:159]
    v_add_f32 v205, v205, v208
    v_mfma_f32_16x16x32_bf16 v[160:163], v[228:231], v[112:115], v[160:163]
    v_mfma_f32_16x16x32_bf16 v[164:167], v[228:231], v[116:119], v[164:167]
    ds_read_b64_tr_b16 v[224:225], v217
    ds_read_b64_tr_b16 v[226:227], v217 offset:4096
    v_add_f32 v206, v206, v209
    s_waitcnt lgkmcnt(8)
    v_mfma_f32_16x16x32_bf16 v[168:171], v[232:235], v[108:111], v[168:171]
    v_mfma_f32_16x16x32_bf16 v[172:175], v[232:235], v[112:115], v[172:175]
    v_mfma_f32_16x16x32_bf16 v[176:179], v[232:235], v[116:119], v[176:179]
    ds_read_b64_tr_b16 v[228:229], v218
    ds_read_b64_tr_b16 v[230:231], v218 offset:4096
    s_waitcnt lgkmcnt(9)
    v_mfma_f32_16x16x32_bf16 v[156:159], v[236:239], v[120:123], v[156:159]
    v_mfma_f32_16x16x32_bf16 v[160:163], v[236:239], v[124:127], v[160:163]
    v_mfma_f32_16x16x32_bf16 v[164:167], v[236:239], v[128:131], v[164:167]
    ds_read_b64_tr_b16 v[232:233], v219
    ds_read_b64_tr_b16 v[234:235], v219 offset:4096
    s_waitcnt lgkmcnt(10)
    v_mfma_f32_16x16x32_bf16 v[168:171], v[240:243], v[120:123], v[168:171]
    v_mfma_f32_16x16x32_bf16 v[172:175], v[240:243], v[124:127], v[172:175]
    v_mfma_f32_16x16x32_bf16 v[176:179], v[240:243], v[128:131], v[176:179]
    ds_read_b64_tr_b16 v[236:237], v216 offset:2048
    ds_read_b64_tr_b16 v[238:239], v216 offset:6144
    s_waitcnt lgkmcnt(11)
    v_mfma_f32_16x16x32_bf16 v[156:159], v[244:247], v[132:135], v[156:159]
    v_mfma_f32_16x16x32_bf16 v[160:163], v[244:247], v[136:139], v[160:163]
    v_mfma_f32_16x16x32_bf16 v[164:167], v[244:247], v[140:143], v[164:167]
    ds_read_b64_tr_b16 v[240:241], v217 offset:2048
    ds_read_b64_tr_b16 v[242:243], v217 offset:6144
    s_waitcnt lgkmcnt(12)
    v_mfma_f32_16x16x32_bf16 v[168:171], v[248:251], v[132:135], v[168:171]
    v_mfma_f32_16x16x32_bf16 v[172:175], v[248:251], v[136:139], v[172:175]
    v_mfma_f32_16x16x32_bf16 v[176:179], v[248:251], v[140:143], v[176:179]
    ds_read_b64_tr_b16 v[244:245], v218 offset:2048
    ds_read_b64_tr_b16 v[246:247], v218 offset:6144
    s_barrier
    s_waitcnt lgkmcnt(12)
    v_mfma_f32_16x16x32_bf16 v[0:3], v[220:223], v[180:183], v[0:3]
    v_exp_f32 v210, v156
    v_exp_f32 v211, v157
    v_mfma_f32_16x16x32_bf16 v[4:7], v[220:223], v[184:187], v[4:7]
    v_exp_f32 v212, v158
    v_add_f32 v207, v210, v211
    v_cvt_pk_bf16_f32 v192, v210, v211
    v_mfma_f32_16x16x32_bf16 v[8:11], v[220:223], v[188:191], v[8:11]
    ds_read_b64_tr_b16 v[248:249], v219 offset:2048
    ds_read_b64_tr_b16 v[250:251], v219 offset:6144
    v_exp_f32 v213, v159
    v_exp_f32 v210, v160
    s_waitcnt lgkmcnt(12)
    v_mfma_f32_16x16x32_bf16 v[12:15], v[224:227], v[180:183], v[12:15]
    v_add_f32 v207, v207, v212
    v_cvt_pk_bf16_f32 v193, v212, v213
    v_add_f32 v207, v207, v213
    v_exp_f32 v211, v161
    v_mfma_f32_16x16x32_bf16 v[16:19], v[224:227], v[184:187], v[16:19]
    v_exp_f32 v212, v162
    v_mfma_f32_16x16x32_bf16 v[20:23], v[224:227], v[188:191], v[20:23]
    s_cmp_ge_u32 s43, 131072
    s_cselect_b32 s45, 0xfffe0000, s74
    s_add_u32 s43, s43, s45
    v_add_u32 v214, s45, v214
    v_add_u32 v215, s45, v215
    ds_read_b128 v[220:223], v214
    v_add_f32 v208, v210, v211
    v_cvt_pk_bf16_f32 v196, v210, v211
    v_exp_f32 v213, v163
    s_waitcnt lgkmcnt(11)
    v_mfma_f32_16x16x32_bf16 v[24:27], v[228:231], v[180:183], v[24:27]
    v_exp_f32 v210, v164
    v_add_f32 v208, v208, v212
    v_cvt_pk_bf16_f32 v197, v212, v213
    v_add_f32 v208, v208, v213
    v_mfma_f32_16x16x32_bf16 v[28:31], v[228:231], v[184:187], v[28:31]
    v_exp_f32 v211, v165
    v_exp_f32 v212, v166
    v_mfma_f32_16x16x32_bf16 v[32:35], v[228:231], v[188:191], v[32:35]
    ds_read_b128 v[224:227], v214 offset:4096
    v_add_f32 v209, v210, v211
    v_cvt_pk_bf16_f32 v200, v210, v211
    s_waitcnt lgkmcnt(10)
    v_mfma_f32_16x16x32_bf16 v[36:39], v[232:235], v[180:183], v[36:39]
    v_exp_f32 v213, v167
    v_exp_f32 v210, v168
    v_mfma_f32_16x16x32_bf16 v[40:43], v[232:235], v[184:187], v[40:43]
    v_add_f32 v209, v209, v212
    v_cvt_pk_bf16_f32 v201, v212, v213
    v_add_f32 v209, v209, v213
    v_exp_f32 v211, v169
    v_mfma_f32_16x16x32_bf16 v[44:47], v[232:235], v[188:191], v[44:47]
    ds_read_b128 v[228:231], v215
    v_exp_f32 v212, v170
    v_add_f32 v207, v207, v210
    v_cvt_pk_bf16_f32 v194, v210, v211
    v_add_f32 v207, v207, v211
    s_waitcnt lgkmcnt(9)
    v_mfma_f32_16x16x32_bf16 v[48:51], v[236:239], v[180:183], v[48:51]
    v_exp_f32 v213, v171
    v_mfma_f32_16x16x32_bf16 v[52:55], v[236:239], v[184:187], v[52:55]
    v_exp_f32 v210, v172
    v_add_f32 v207, v207, v212
    v_cvt_pk_bf16_f32 v195, v212, v213
    v_add_f32 v207, v207, v213
    v_mfma_f32_16x16x32_bf16 v[56:59], v[236:239], v[188:191], v[56:59]
    ds_read_b128 v[232:235], v215 offset:4096
    v_exp_f32 v211, v173
    v_exp_f32 v212, v174
    s_waitcnt lgkmcnt(8)
    v_mfma_f32_16x16x32_bf16 v[60:63], v[240:243], v[180:183], v[60:63]
    v_add_f32 v208, v208, v210
    v_cvt_pk_bf16_f32 v198, v210, v211
    v_add_f32 v208, v208, v211
    v_exp_f32 v213, v175
    v_mfma_f32_16x16x32_bf16 v[64:67], v[240:243], v[184:187], v[64:67]
    v_exp_f32 v210, v176
    v_mfma_f32_16x16x32_bf16 v[68:71], v[240:243], v[188:191], v[68:71]
    ds_read_b128 v[236:239], v214 offset:2048
    v_add_f32 v208, v208, v212
    v_cvt_pk_bf16_f32 v199, v212, v213
    v_add_f32 v208, v208, v213
    v_exp_f32 v211, v177
    s_waitcnt lgkmcnt(7)
    v_mfma_f32_16x16x32_bf16 v[72:75], v[244:247], v[180:183], v[72:75]
    v_exp_f32 v212, v178
    v_add_f32 v209, v209, v210
    v_cvt_pk_bf16_f32 v202, v210, v211
    v_add_f32 v209, v209, v211
    v_mfma_f32_16x16x32_bf16 v[76:79], v[244:247], v[184:187], v[76:79]
    v_exp_f32 v213, v179
    v_add_f32 v209, v209, v212
    v_cvt_pk_bf16_f32 v203, v212, v213
    v_add_f32 v209, v209, v213
    v_mfma_f32_16x16x32_bf16 v[80:83], v[244:247], v[188:191], v[80:83]
    ds_read_b128 v[240:243], v214 offset:6144
    v_max3_f32 v253, v207, v208, v209
    v_cmp_nge_f32 vcc, 0x46800000, v253
    s_waitcnt lgkmcnt(6)
    v_mfma_f32_16x16x32_bf16 v[84:87], v[248:251], v[180:183], v[84:87]
    v_mfma_f32_16x16x32_bf16 v[88:91], v[248:251], v[184:187], v[88:91]
    v_mfma_f32_16x16x32_bf16 v[92:95], v[248:251], v[188:191], v[92:95]
    ds_read_b128 v[244:247], v215 offset:2048
    s_cbranch_vccnz L_stub17
L_back17:
    s_sub_u32 s51, s51, 1
    s_cmp_lg_u32 s51, 0
    s_cbranch_scc1 L_w3_a
    v_add_f32 v204, v204, v207
    v_add_f32 v205, v205, v208
    v_add_f32 v206, v206, v209
    s_and_b32 s42, s91, s33
    s_cselect_b64 vcc, -1, 0
    s_cmp_ge_u32 s44, 131072
    s_cselect_b32 s45, 0xfffe0000, s74
    s_add_u32 s44, s44, s45
    v_add_u32 v216, s45, v216
    v_add_u32 v217, s45, v217
    v_add_u32 v218, s45, v218
    v_add_u32 v219, s45, v219
    s_waitcnt lgkmcnt(6)
    ds_read_b64_tr_b16 v[220:221], v216
    ds_read_b64_tr_b16 v[222:223], v216 offset:4096
    s_waitcnt lgkmcnt(7)
    ds_read_b64_tr_b16 v[224:225], v217
    ds_read_b64_tr_b16 v[226:227], v217 offset:4096
    s_waitcnt lgkmcnt(8)
    ds_read_b64_tr_b16 v[228:229], v218
    ds_read_b64_tr_b16 v[230:231], v218 offset:4096
    s_waitcnt lgkmcnt(9)
    ds_read_b64_tr_b16 v[232:233], v219
    ds_read_b64_tr_b16 v[234:235], v219 offset:4096
    s_waitcnt lgkmcnt(10)
    ds_read_b64_tr_b16 v[236:237], v216 offset:2048
    ds_read_b64_tr_b16 v[238:239], v216 offset:6144
    s_waitcnt lgkmcnt(11)
    ds_read_b64_tr_b16 v[240:241], v217 offset:2048
    ds_read_b64_tr_b16 v[242:243], v217 offset:6144
    s_waitcnt lgkmcnt(12)
    ds_read_b64_tr_b16 v[244:245], v218 offset:2048
    ds_read_b64_tr_b16 v[246:247], v218 offset:6144
    s_waitcnt lgkmcnt(12)
    v_mfma_f32_16x16x32_bf16 v[0:3], v[220:223], v[192:195], v[0:3]
    v_mov_b32 v210, v204
    v_mov_b32 v211, v205
    v_mov_b32 v212, v206
    v_permlane32_swap_b32 v204, v210
    v_mfma_f32_16x16x32_bf16 v[4:7], v[220:223], v[196:199], v[4:7]
    v_permlane32_swap_b32 v205, v211
    v_permlane32_swap_b32 v206, v212
    v_add_f32 v204, v204, v210
    v_mfma_f32_16x16x32_bf16 v[8:11], v[220:223], v[200:203], v[8:11]
    ds_read_b64_tr_b16 v[248:249], v219 offset:2048
    ds_read_b64_tr_b16 v[250:251], v219 offset:6144
    v_add_f32 v205, v205, v211
    v_add_f32 v206, v206, v212
    v_mov_b32 v210, v204
    v_mov_b32 v211, v205
    s_waitcnt lgkmcnt(12)
    v_mfma_f32_16x16x32_bf16 v[12:15], v[224:227], v[192:195], v[12:15]
    v_mov_b32 v212, v206
    v_permlane16_swap_b32 v204, v210
    v_permlane16_swap_b32 v205, v211
    v_mfma_f32_16x16x32_bf16 v[16:19], v[224:227], v[196:199], v[16:19]
    v_permlane16_swap_b32 v206, v212
    v_add_f32 v204, v204, v210
    v_add_f32 v205, v205, v211
    v_add_f32 v206, v206, v212
    v_mfma_f32_16x16x32_bf16 v[20:23], v[224:227], v[200:203], v[20:23]
    v_rcp_f32 v204, v204
    v_rcp_f32 v205, v205
    v_rcp_f32 v206, v206
    s_waitcnt lgkmcnt(10)
    v_mfma_f32_16x16x32_bf16 v[24:27], v[228:231], v[192:195], v[24:27]
    v_mbcnt_lo_u32_b32 v253, -1, 0
    v_mbcnt_hi_u32_b32 v253, -1, v253
    v_lshlrev_b32 v253, 4, v253
    v_mfma_f32_16x16x32_bf16 v[28:31], v[228:231], v[196:199], v[28:31]
    v_mfma_f32_16x16x32_bf16 v[32:35], v[228:231], v[200:203], v[32:35]
    v_mul_f32 v0, v0, v204
    v_mul_f32 v1, v1, v204
    v_mul_f32 v2, v2, v204
    v_mul_f32 v3, v3, v204
    v_cvt_pk_bf16_f32 v96, v0, v1
    v_cvt_pk_bf16_f32 v97, v2, v3
    v_mul_f32 v12, v12, v204
    s_waitcnt lgkmcnt(8)
    v_mfma_f32_16x16x32_bf16 v[36:39], v[232:235], v[192:195], v[36:39]
    v_mul_f32 v13, v13, v204
    v_mul_f32 v14, v14, v204
    v_mul_f32 v15, v15, v204
    v_cvt_pk_bf16_f32 v98, v12, v13
    v_cvt_pk_bf16_f32 v99, v14, v15
    s_add_u32 s42, s48, 0
    s_cbranch_vccz L_slow8
    buffer_store_dwordx4 v[96:99], v253, s[24:27], s42 offen
L_slowb8:
    v_mfma_f32_16x16x32_bf16 v[40:43], v[232:235], v[196:199], v[40:43]
    v_mul_f32 v4, v4, v205
    v_mul_f32 v5, v5, v205
    v_mul_f32 v6, v6, v205
    v_mul_f32 v7, v7, v205
    v_cvt_pk_bf16_f32 v100, v4, v5
    v_cvt_pk_bf16_f32 v101, v6, v7
    v_mul_f32 v16, v16, v205
    v_mfma_f32_16x16x32_bf16 v[44:47], v[232:235], v[200:203], v[44:47]
    v_mul_f32 v17, v17, v205
    v_mul_f32 v18, v18, v205
    v_mul_f32 v19, v19, v205
    v_cvt_pk_bf16_f32 v102, v16, v17
    v_cvt_pk_bf16_f32 v103, v18, v19
    s_add_u32 s42, s48, 0
    s_cbranch_vccz L_slow9
    buffer_store_dwordx4 v[100:103], v253, s[24:27], s42 offen offset:1024
L_slowb9:
    s_waitcnt lgkmcnt(6)
    v_mfma_f32_16x16x32_bf16 v[48:51], v[236:239], v[192:195], v[48:51]
    v_mul_f32 v8, v8, v206
    v_mul_f32 v9, v9, v206
    v_mul_f32 v10, v10, v206
    v_mul_f32 v11, v11, v206
    v_cvt_pk_bf16_f32 v104, v8, v9
    v_cvt_pk_bf16_f32 v105, v10, v11
    v_mul_f32 v20, v20, v206
    v_mfma_f32_16x16x32_bf16 v[52:55], v[236:239], v[196:199], v[52:55]
    v_mul_f32 v21, v21, v206
    v_mul_f32 v22, v22, v206
    v_mul_f32 v23, v23, v206
    v_cvt_pk_bf16_f32 v106, v20, v21
    v_cvt_pk_bf16_f32 v107, v22, v23
    s_add_u32 s42, s48, 0
    s_cbranch_vccz L_slow10
    buffer_store_dwordx4 v[104:107], v253, s[24:27], s42 offen offset:2048
L_slowb10:
    v_mfma_f32_16x16x32_bf16 v[56:59], v[236:239], v[200:203], v[56:59]
    v_mul_f32 v24, v24, v204
    v_mul_f32 v25, v25, v204
    v_mul_f32 v26, v26, v204
    v_mul_f32 v27, v27, v204
    v_cvt_pk_bf16_f32 v108, v24, v25
    v_cvt_pk_bf16_f32 v109, v26, v27
    v_mul_f32 v36, v36, v204
    s_waitcnt lgkmcnt(4)
    v_mfma_f32_16x16x32_bf16 v[60:63], v[240:243], v[192:195], v[60:63]
    v_mul_f32 v37, v37, v204
    v_mul_f32 v38, v38, v204
    v_mul_f32 v39, v39, v204
    v_cvt_pk_bf16_f32 v110, v36, v37
    v_cvt_pk_bf16_f32 v111, v38, v39
    s_add_u32 s42, s48, 10240
    s_cbranch_vccz L_slow11
    buffer_store_dwordx4 v[108:111], v253, s[24:27], s42 offen
L_slowb11:
    v_mfma_f32_16x16x32_bf16 v[64:67], v[240:243], v[196:199], v[64:67]
    v_mul_f32 v28, v28, v205
    v_mul_f32 v29, v29, v205
    v_mul_f32 v30, v30, v205
    v_mul_f32 v31, v31, v205
    v_cvt_pk_bf16_f32 v112, v28, v29
    v_cvt_pk_bf16_f32 v113, v30, v31
    v_mul_f32 v40, v40, v205
    v_mfma_f32_16x16x32_bf16 v[68:71], v[240:243], v[200:203], v[68:71]
    v_mul_f32 v41, v41, v205
    v_mul_f32 v42, v42, v205
    v_mul_f32 v43, v43, v205
    v_cvt_pk_bf16_f32 v114, v40, v41
    v_cvt_pk_bf16_f32 v115, v42, v43
    s_add_u32 s42, s48, 10240
    s_cbranch_vccz L_slow12
    buffer_store_dwordx4 v[112:115], v253, s[24:27], s42 offen offset:1024
L_slowb12:
    s_waitcnt lgkmcnt(2)
    v_mfma_f32_16x16x32_bf16 v[72:75], v[244:247], v[192:195], v[72:75]
    v_mul_f32 v32, v32, v206
    v_mul_f32 v33, v33, v206
    v_mul_f32 v34, v34, v206
    v_mul_f32 v35, v35, v206
    v_cvt_pk_bf16_f32 v116, v32, v33
    v_cvt_pk_bf16_f32 v117, v34, v35
    v_mul_f32 v44, v44, v206
    v_mfma_f32_16x16x32_bf16 v[76:79], v[244:247], v[196:199], v[76:79]
    v_mul_f32 v45, v45, v206
    v_mul_f32 v46, v46, v206
    v_mul_f32 v47, v47, v206
    v_cvt_pk_bf16_f32 v118, v44, v45
    v_cvt_pk_bf16_f32 v119, v46, v47
    s_add_u32 s42, s48, 10240
    s_cbranch_vccz L_slow13
    buffer_store_dwordx4 v[116:119], v253, s[24:27], s42 offen offset:2048
L_slowb13:
    v_mfma_f32_16x16x32_bf16 v[80:83], v[244:247], v[200:203], v[80:83]
    v_mul_f32 v48, v48, v204
    v_mul_f32 v49, v49, v204
    v_mul_f32 v50, v50, v204
    v_mul_f32 v51, v51, v204
    v_cvt_pk_bf16_f32 v120, v48, v49
    v_cvt_pk_bf16_f32 v121, v50, v51
    v_mul_f32 v60, v60, v204
    v_mul_f32 v61, v61, v204
    v_mul_f32 v62, v62, v204
    v_mul_f32 v63, v63, v204
    s_waitcnt lgkmcnt(0)
    v_mfma_f32_16x16x32_bf16 v[84:87], v[248:251], v[192:195], v[84:87]
    v_cvt_pk_bf16_f32 v122, v60, v61
    v_cvt_pk_bf16_f32 v123, v62, v63
    s_add_u32 s42, s48, 20480
    s_cbranch_vccz L_slow14
    buffer_store_dwordx4 v[120:123], v253, s[24:27], s42 offen
L_slowb14:
    v_mul_f32 v52, v52, v205
    v_mul_f32 v53, v53, v205
    v_mul_f32 v54, v54, v205
    v_mul_f32 v55, v55, v205
    v_cvt_pk_bf16_f32 v124, v52, v53
    v_cvt_pk_bf16_f32 v125, v54, v55
    v_mul_f32 v64, v64, v205
    v_mfma_f32_16x16x32_bf16 v[88:91], v[248:251], v[196:199], v[88:91]
    v_mul_f32 v65, v65, v205
    v_mul_f32 v66, v66, v205
    v_mul_f32 v67, v67, v205
    v_cvt_pk_bf16_f32 v126, v64, v65
    v_cvt_pk_bf16_f32 v127, v66, v67
    s_add_u32 s42, s48, 20480
    s_cbranch_vccz L_slow15
    buffer_store_dwordx4 v[124:127], v253, s[24:27], s42 offen offset:1024
L_slowb15:
    v_mul_f32 v56, v56, v206
    v_mul_f32 v57, v57, v206
    v_mul_f32 v58, v58, v206
    v_mul_f32 v59, v59, v206
    v_mfma_f32_16x16x32_bf16 v[92:95], v[248:251], v[200:203], v[92:95]
    v_cvt_pk_bf16_f32 v128, v56, v57
    v_cvt_pk_bf16_f32 v129, v58, v59
    v_mul_f32 v68, v68, v206
    v_mul_f32 v69, v69, v206
    v_mul_f32 v70, v70, v206
    v_mul_f32 v71, v71, v206
    v_cvt_pk_bf16_f32 v130, v68, v69
    v_cvt_pk_bf16_f32 v131, v70, v71
    s_add_u32 s42, s48, 20480
    s_cbranch_vccz L_slow16
    buffer_store_dwordx4 v[128:131], v253, s[24:27], s42 offen offset:2048
L_slowb16:
    v_mul_f32 v72, v72, v204
    v_mul_f32 v73, v73, v204
    v_mul_f32 v74, v74, v204
    v_mul_f32 v75, v75, v204
    v_cvt_pk_bf16_f32 v132, v72, v73
    v_cvt_pk_bf16_f32 v133, v74, v75
    v_mul_f32 v84, v84, v204
    v_mul_f32 v85, v85, v204
    v_mul_f32 v86, v86, v204
    v_mul_f32 v87, v87, v204
    v_cvt_pk_bf16_f32 v134, v84, v85
    v_cvt_pk_bf16_f32 v135, v86, v87
    s_add_u32 s42, s48, 30720
    s_cbranch_vccz L_slow17
    buffer_store_dwordx4 v[132:135], v253, s[24:27], s42 offen
L_slowb17:
    v_mul_f32 v76, v76, v205
    v_mul_f32 v77, v77, v205
    v_mul_f32 v78, v78, v205
    v_mul_f32 v79, v79, v205
    v_cvt_pk_bf16_f32 v136, v76, v77
    v_cvt_pk_bf16_f32 v137, v78, v79
    v_mul_f32 v88, v88, v205
    v_mul_f32 v89, v89, v205
    v_mul_f32 v90, v90, v205
    v_mul_f32 v91, v91, v205
    v_cvt_pk_bf16_f32 v138, v88, v89
    v_cvt_pk_bf16_f32 v139, v90, v91
    s_add_u32 s42, s48, 30720
    s_cbranch_vccz L_slow18
    buffer_store_dwordx4 v[136:139], v253, s[24:27], s42 offen offset:1024
L_slowb18:
    v_mul_f32 v80, v80, v206
    v_mul_f32 v81, v81, v206
    v_mul_f32 v82, v82, v206
    v_mul_f32 v83, v83, v206
    v_cvt_pk_bf16_f32 v140, v80, v81
    v_cvt_pk_bf16_f32 v141, v82, v83
    v_mul_f32 v92, v92, v206
    v_mul_f32 v93, v93, v206
    v_mul_f32 v94, v94, v206
    v_mul_f32 v95, v95, v206
    v_cvt_pk_bf16_f32 v142, v92, v93
    v_cvt_pk_bf16_f32 v143, v94, v95
    s_add_u32 s42, s48, 30720
    s_cbranch_vccz L_slow19
    buffer_store_dwordx4 v[140:143], v253, s[24:27], s42 offen offset:2048
L_slowb19:
    v_add_u32 v216, 0x8000, v216
    v_bfe_u32 v210, v216, 3, 2
    v_and_b32 v216, 0xffffffe7, v216
    v_lshlrev_b32 v210, 4, v210
    v_xor_b32 v216, v216, v210
    v_xor_b32 v217, 64, v216
    v_add_u32 v214, 0x14000, v214
    v_add_u32 v215, 0x14000, v215
    v_subrev_u32 v214, s52, v214
    v_subrev_u32 v215, s52, v215
    s_add_u32 s36, s36, 262144
    s_add_u32 s37, s37, 512
    s_add_u32 s48, s48, 81920
    s_add_u32 s33, s33, 1
    s_cmp_lt_u32 s33, 2
    s_cbranch_scc1 L_w3_round
    s_branch L_o
L_o:
    s_setprio 0
    v_mbcnt_lo_u32_b32 v190, -1, 0
    v_mbcnt_hi_u32_b32 v190, -1, v190
    v_lshlrev_b32 v196, 4, v190
    s_lshr_b32 s43, s32, 2
    s_mul_i32 s41, s43, 20480
    s_and_b32 s42, s32, 1
    s_mul_i32 s42, s42, 5120
    s_add_u32 s42, s41, s42
    v_add_u32 v180, s42, v196
    v_add_u32 v181, 81920, v180
    v_lshrrev_b32 v191, 2, v190
    v_bfe_u32 v195, v190, 4, 1
    v_lshlrev_b32 v195, 5, v195
    v_lshl_add_u32 v195, v191, 6, v195
    v_and_b32 v191, 3, v190
    v_lshl_add_u32 v195, v191, 3, v195
    s_add_u32 s42, s41, 10240
    v_add_u32 v182, s42, v195
    v_xor_b32 v184, 32, v182
    v_add_u32 v183, 81920, v182
    v_add_u32 v185, 81920, v184
    s_mov_b32 s37, 0
    s_bitcmp1_b32 s32, 1
    s_cbranch_scc1 L_o_1
L_o_0:
    v_lshlrev_b32 v186, 4, v190
    s_and_b32 s39, s32, 1
    s_mul_i32 s39, s39, 5120
    s_mul_i32 s40, s34, 1310720
    s_add_u32 s40, s40, s39
    s_add_u32 s55, s35, s34
    s_add_u32 s54, s55, 0
    s_and_b32 s54, s54, 3
    s_mul_i32 s56, s54, 10240
    s_add_u32 s54, s55, 1
    s_and_b32 s54, s54, 3
    s_mul_i32 s57, s54, 10240
    s_add_u32 s54, s55, 2
    s_and_b32 s54, s54, 3
    s_mul_i32 s58, s54, 10240
    s_add_u32 s54, s55, 3
    s_and_b32 s54, s54, 3
    s_mul_i32 s59, s54, 10240
    s_add_u32 s39, s39, s41
    s_mov_b32 s8, s24
    s_mov_b32 s9, s25
    s_mov_b32 s10, s26
    s_and_b32 s54, s37, 3
    s_and_b32 s55, s35, 4
    s_add_u32 s54, s54, s55
    s_lshl_b32 s54, s54, 2
    s_lshr_b32 s55, s37, 2
    s_lshl_b32 s55, s55, 1
    s_add_u32 s54, s54, s55
    s_add_u32 s54, s54, s43
    s_mul_i32 s54, s54, 40960
    s_add_u32 s36, s40, s54
    s_add_u32 s37, s37, 1
    s_waitcnt vmcnt(18)
    s_barrier
    ds_read_b64_tr_b16 v[120:121], v183
    ds_read_b64_tr_b16 v[122:123], v183 offset:5120
    ds_read_b128 v[100:103], v181
    ds_read_b64_tr_b16 v[124:125], v185
    ds_read_b64_tr_b16 v[126:127], v185 offset:5120
    ds_read_b128 v[104:107], v181 offset:1024
    ds_read_b64_tr_b16 v[128:129], v183 offset:1024
    ds_read_b64_tr_b16 v[130:131], v183 offset:6144
    ds_read_b128 v[108:111], v181 offset:2048
    ds_read_b64_tr_b16 v[132:133], v185 offset:1024
    ds_read_b64_tr_b16 v[134:135], v185 offset:6144
    ds_read_b128 v[112:115], v181 offset:3072
    ds_read_b64_tr_b16 v[136:137], v183 offset:2048
    ds_read_b64_tr_b16 v[138:139], v183 offset:7168
    ds_read_b128 v[116:119], v181 offset:4096
    v_pk_mov_b32 v[0:1], 0, 0
    v_pk_mov_b32 v[2:3], 0, 0
    v_pk_mov_b32 v[4:5], 0, 0
    v_pk_mov_b32 v[6:7], 0, 0
    v_pk_mov_b32 v[8:9], 0, 0
    v_pk_mov_b32 v[10:11], 0, 0
    v_pk_mov_b32 v[12:13], 0, 0
    v_pk_mov_b32 v[14:15], 0, 0
    v_pk_mov_b32 v[16:17], 0, 0
    v_pk_mov_b32 v[18:19], 0, 0
    v_pk_mov_b32 v[20:21], 0, 0
    v_pk_mov_b32 v[22:23], 0, 0
    v_pk_mov_b32 v[24:25], 0, 0
    v_pk_mov_b32 v[26:27], 0, 0
    v_pk_mov_b32 v[28:29], 0, 0
    v_pk_mov_b32 v[30:31], 0, 0
    v_pk_mov_b32 v[32:33], 0, 0
    v_pk_mov_b32 v[34:35], 0, 0
    v_pk_mov_b32 v[36:37], 0, 0
    v_pk_mov_b32 v[38:39], 0, 0
    v_pk_mov_b32 v[40:41], 0, 0
    v_pk_mov_b32 v[42:43], 0, 0
    v_pk_mov_b32 v[44:45], 0, 0
    v_pk_mov_b32 v[46:47], 0, 0
    v_pk_mov_b32 v[48:49], 0, 0
    v_pk_mov_b32 v[50:51], 0, 0
    v_pk_mov_b32 v[52:53], 0, 0
    v_pk_mov_b32 v[54:55], 0, 0
    v_pk_mov_b32 v[56:57], 0, 0
    v_pk_mov_b32 v[58:59], 0, 0
    v_pk_mov_b32 v[60:61], 0, 0
    v_pk_mov_b32 v[62:63], 0, 0
    v_pk_mov_b32 v[64:65], 0, 0
    v_pk_mov_b32 v[66:67], 0, 0
    v_pk_mov_b32 v[68:69], 0, 0
    v_pk_mov_b32 v[70:71], 0, 0
    v_pk_mov_b32 v[72:73], 0, 0
    v_pk_mov_b32 v[74:75], 0, 0
    v_pk_mov_b32 v[76:77], 0, 0
    v_pk_mov_b32 v[78:79], 0, 0
    v_pk_mov_b32 v[80:81], 0, 0
    v_pk_mov_b32 v[82:83], 0, 0
    v_pk_mov_b32 v[84:85], 0, 0
    v_pk_mov_b32 v[86:87], 0, 0
    v_pk_mov_b32 v[88:89], 0, 0
    v_pk_mov_b32 v[90:91], 0, 0
    v_pk_mov_b32 v[92:93], 0, 0
    v_pk_mov_b32 v[94:95], 0, 0
    v_pk_mov_b32 v[96:97], 0, 0
    v_pk_mov_b32 v[98:99], 0, 0
    v_mov_b32 v188, s53
    v_xor_b32 v189, 4, v188
    v_mov_b32 v187, 0
    v_mov_b32 v198, 0
    s_and_b32 s44, s35, 3
    s_mov_b32 s49, 0x8000
    s_mul_i32 s41, s32, 13312
    v_add_u32 v192, s41, v196
    s_xor_b32 s42, s32, 4
    s_mul_i32 s41, s42, 13312
    v_add_u32 v193, s41, v196
    s_lshl_b32 s41, s2, 3
    s_add_u32 s41, s41, s32
    s_mul_i32 s60, s41, 4224
    s_add_u32 s60, s60, 41943040
    s_xor_b32 s41, s41, 8
    s_mul_i32 s61, s41, 4224
    s_add_u32 s61, s61, 41943040
    v_bfe_u32 v194, v196, 4, 4
    v_mul_u32_u24 v194, 1280, v194
    v_bfe_u32 v191, v196, 8, 1
    v_lshl_add_u32 v199, v191, 5, v194
    v_lshrrev_b32 v191, 9, v196
    v_lshl_add_u32 v199, v191, 4, v199
    v_lshrrev_b32 v191, 8, v196
    v_lshl_add_u32 v194, v191, 3, v194
    s_mul_i32 s62, s34, 204800
    s_and_b32 s41, s32, 1
    s_mul_i32 s41, s41, 102400
    s_add_u32 s62, s62, s41
    s_mul_i32 s41, s44, 320
    s_add_u32 s62, s62, s41
    s_bfe_u32 s41, s32, 0x10001
    s_mul_i32 s41, s41, 160
    s_add_u32 s62, s62, s41
    s_lshr_b32 s63, s35, 2
    s_lshl_b32 s42, s43, 1
    s_add_u32 s63, s63, s42
    s_and_b32 s42, s91, s33
    s_cselect_b64 vcc, -1, 0
    s_add_u32 m0, s39, 0
    s_add_u32 s41, s36, s58
    buffer_load_dwordx4 v186, s[8:11], s41 offen sc1 lds
    buffer_load_dwordx4 v186, s[8:11], s41 offen offset:1024 sc1 lds
    buffer_load_dwordx4 v186, s[8:11], s41 offen offset:2048 sc1 lds
    buffer_load_dwordx4 v186, s[8:11], s41 offen offset:3072 sc1 lds
    s_add_u32 m0, s39, 4096
    s_add_u32 s41, s36, s58
    s_add_u32 s41, s41, 4096
    buffer_load_dwordx4 v186, s[8:11], s41 offen sc1 lds
    s_waitcnt vmcnt(13)
    s_branch L_o_in0
L_o_loop0:
    s_waitcnt vmcnt(5)
L_o_in0:
    s_waitcnt lgkmcnt(0)
    s_setprio 3
    s_barrier
    v_mfma_f32_16x16x32_bf16 v[0:3], v[120:123], v[100:103], v[0:3]
    ds_read_b64_tr_b16 v[160:161], v183 offset:40960
    ds_read_b64_tr_b16 v[162:163], v183 offset:46080
    v_mfma_f32_16x16x32_bf16 v[4:7], v[124:127], v[100:103], v[4:7]
    s_add_u32 m0, s39, 40960
    s_add_u32 s41, s36, s59
    buffer_load_dwordx4 v186, s[8:11], s41 offen sc1 lds
    v_mfma_f32_16x16x32_bf16 v[8:11], v[128:131], v[100:103], v[8:11]
    ds_read_b128 v[140:143], v181 offset:40960
    v_mfma_f32_16x16x32_bf16 v[12:15], v[132:135], v[100:103], v[12:15]
    v_mfma_f32_16x16x32_bf16 v[16:19], v[136:139], v[100:103], v[16:19]
    ds_read_b64_tr_b16 v[164:165], v185 offset:40960
    ds_read_b64_tr_b16 v[166:167], v185 offset:46080
    buffer_load_dwordx4 v186, s[8:11], s41 offen offset:1024 sc1 lds
    v_mfma_f32_16x16x32_bf16 v[20:23], v[120:123], v[104:107], v[20:23]
    s_setprio 2
    v_mfma_f32_16x16x32_bf16 v[24:27], v[124:127], v[104:107], v[24:27]
    ds_read_b128 v[144:147], v181 offset:41984
    v_mfma_f32_16x16x32_bf16 v[28:31], v[128:131], v[104:107], v[28:31]
    buffer_load_dwordx4 v186, s[8:11], s41 offen offset:2048 sc1 lds
    v_mfma_f32_16x16x32_bf16 v[32:35], v[132:135], v[104:107], v[32:35]
    ds_read_b64_tr_b16 v[168:169], v183 offset:41984
    ds_read_b64_tr_b16 v[170:171], v183 offset:47104
    v_mfma_f32_16x16x32_bf16 v[36:39], v[136:139], v[104:107], v[36:39]
    v_mfma_f32_16x16x32_bf16 v[40:43], v[120:123], v[108:111], v[40:43]
    ds_read_b128 v[148:151], v181 offset:43008
    buffer_load_dwordx4 v186, s[8:11], s41 offen offset:3072 sc1 lds
    v_mfma_f32_16x16x32_bf16 v[44:47], v[124:127], v[108:111], v[44:47]
    s_setprio 1
    v_mfma_f32_16x16x32_bf16 v[48:51], v[128:131], v[108:111], v[48:51]
    ds_read_b64_tr_b16 v[172:173], v185 offset:41984
    ds_read_b64_tr_b16 v[174:175], v185 offset:47104
    v_mfma_f32_16x16x32_bf16 v[52:55], v[132:135], v[108:111], v[52:55]
    v_mfma_f32_16x16x32_bf16 v[56:59], v[136:139], v[108:111], v[56:59]
    ds_read_b128 v[152:155], v181 offset:44032
    s_add_u32 m0, s39, 45056
    s_add_u32 s41, s36, s59
    s_add_u32 s41, s41, 4096
    buffer_load_dwordx4 v186, s[8:11], s41 offen sc1 lds
    v_mfma_f32_16x16x32_bf16 v[60:63], v[120:123], v[112:115], v[60:63]
    v_mfma_f32_16x16x32_bf16 v[64:67], v[124:127], v[112:115], v[64:67]
    ds_read_b64_tr_b16 v[176:177], v183 offset:43008
    ds_read_b64_tr_b16 v[178:179], v183 offset:48128
    v_mfma_f32_16x16x32_bf16 v[68:71], v[128:131], v[112:115], v[68:71]
    s_and_b32 s54, s37, 3
    s_and_b32 s55, s35, 4
    s_add_u32 s54, s54, s55
    s_lshl_b32 s54, s54, 2
    s_lshr_b32 s55, s37, 2
    s_lshl_b32 s55, s55, 1
    s_add_u32 s54, s54, s55
    s_add_u32 s54, s54, s43
    s_mul_i32 s54, s54, 40960
    s_add_u32 s36, s40, s54
    s_add_u32 s37, s37, 1
    s_cmp_gt_u32 s37, 8
    s_cselect_b32 s10, 0, s10
    s_setprio 0
    v_mfma_f32_16x16x32_bf16 v[72:75], v[132:135], v[112:115], v[72:75]
    ds_read_b128 v[156:159], v181 offset:45056
    v_mfma_f32_16x16x32_bf16 v[76:79], v[136:139], v[112:115], v[76:79]
    v_mfma_f32_16x16x32_bf16 v[80:83], v[120:123], v[116:119], v[80:83]
    s_lshl_b32 s54, s37, 3
    s_add_u32 s54, s54, s32
    s_cmp_lg_u32 s54, 40
    s_cbranch_scc1 L_g3_back
    v_readfirstlane_b32 s54, v187
    s_nop 0
    s_bfe_u32 s54, s54, 0x40008
    s_cmp_lg_u32 s54, 15
    s_cbranch_scc1 L_g2
L_g2_back:
    v_readfirstlane_b32 s54, v198
    s_nop 0
    s_bfe_u32 s54, s54, 0x40000
    s_cmp_lg_u32 s54, 15
    s_cbranch_scc1 L_g3
L_g3_back:
    v_mfma_f32_16x16x32_bf16 v[84:87], v[124:127], v[116:119], v[84:87]
    v_mfma_f32_16x16x32_bf16 v[88:91], v[128:131], v[116:119], v[88:91]
    v_mfma_f32_16x16x32_bf16 v[92:95], v[132:135], v[116:119], v[92:95]
    v_mfma_f32_16x16x32_bf16 v[96:99], v[136:139], v[116:119], v[96:99]
    s_waitcnt vmcnt(5) lgkmcnt(0)
    s_setprio 3
    s_barrier
    v_mfma_f32_16x16x32_bf16 v[0:3], v[160:163], v[140:143], v[0:3]
    ds_read_b64_tr_b16 v[120:121], v182
    ds_read_b64_tr_b16 v[122:123], v182 offset:5120
    v_mfma_f32_16x16x32_bf16 v[4:7], v[164:167], v[140:143], v[4:7]
    s_add_u32 m0, s39, 81920
    s_add_u32 s41, s36, s56
    buffer_load_dwordx4 v186, s[8:11], s41 offen sc1 lds
    v_mfma_f32_16x16x32_bf16 v[8:11], v[168:171], v[140:143], v[8:11]
    ds_read_b128 v[100:103], v180
    v_mfma_f32_16x16x32_bf16 v[12:15], v[172:175], v[140:143], v[12:15]
    v_mfma_f32_16x16x32_bf16 v[16:19], v[176:179], v[140:143], v[16:19]
    ds_read_b64_tr_b16 v[124:125], v184
    ds_read_b64_tr_b16 v[126:127], v184 offset:5120
    v_mfma_f32_16x16x32_bf16 v[20:23], v[160:163], v[144:147], v[20:23]
    buffer_load_dwordx4 v186, s[8:11], s41 offen offset:1024 sc1 lds
    s_setprio 2
    v_mfma_f32_16x16x32_bf16 v[24:27], v[164:167], v[144:147], v[24:27]
    ds_read_b128 v[104:107], v180 offset:1024
    v_mfma_f32_16x16x32_bf16 v[28:31], v[168:171], v[144:147], v[28:31]
    v_mfma_f32_16x16x32_bf16 v[32:35], v[172:175], v[144:147], v[32:35]
    ds_read_b64_tr_b16 v[128:129], v182 offset:1024
    ds_read_b64_tr_b16 v[130:131], v182 offset:6144
    v_mfma_f32_16x16x32_bf16 v[36:39], v[176:179], v[144:147], v[36:39]
    v_mfma_f32_16x16x32_bf16 v[40:43], v[160:163], v[148:151], v[40:43]
    ds_read_b128 v[108:111], v180 offset:2048
    buffer_load_dwordx4 v186, s[8:11], s41 offen offset:2048 sc1 lds
    v_mfma_f32_16x16x32_bf16 v[44:47], v[164:167], v[148:151], v[44:47]
    s_setprio 1
    v_mfma_f32_16x16x32_bf16 v[48:51], v[168:171], v[148:151], v[48:51]
    ds_read_b64_tr_b16 v[132:133], v184 offset:1024
    ds_read_b64_tr_b16 v[134:135], v184 offset:6144
    v_mfma_f32_16x16x32_bf16 v[52:55], v[172:175], v[148:151], v[52:55]
    v_mfma_f32_16x16x32_bf16 v[56:59], v[176:179], v[148:151], v[56:59]
    ds_read_b128 v[112:115], v180 offset:3072
    buffer_load_dwordx4 v186, s[8:11], s41 offen offset:3072 sc1 lds
    v_mfma_f32_16x16x32_bf16 v[60:63], v[160:163], v[152:155], v[60:63]
    v_mfma_f32_16x16x32_bf16 v[64:67], v[164:167], v[152:155], v[64:67]
    ds_read_b64_tr_b16 v[136:137], v182 offset:2048
    ds_read_b64_tr_b16 v[138:139], v182 offset:7168
    v_mfma_f32_16x16x32_bf16 v[68:71], v[168:171], v[152:155], v[68:71]
    s_setprio 0
    v_mfma_f32_16x16x32_bf16 v[72:75], v[172:175], v[152:155], v[72:75]
    ds_read_b128 v[116:119], v180 offset:4096
    v_mfma_f32_16x16x32_bf16 v[76:79], v[176:179], v[152:155], v[76:79]
    s_add_u32 m0, s39, 86016
    s_add_u32 s41, s36, s56
    s_add_u32 s41, s41, 4096
    buffer_load_dwordx4 v186, s[8:11], s41 offen sc1 lds
    v_mfma_f32_16x16x32_bf16 v[80:83], v[160:163], v[156:159], v[80:83]
    v_mfma_f32_16x16x32_bf16 v[84:87], v[164:167], v[156:159], v[84:87]
    v_mfma_f32_16x16x32_bf16 v[88:91], v[168:171], v[156:159], v[88:91]
    v_mfma_f32_16x16x32_bf16 v[92:95], v[172:175], v[156:159], v[92:95]
    v_mfma_f32_16x16x32_bf16 v[96:99], v[176:179], v[156:159], v[96:99]
    s_waitcnt vmcnt(5) lgkmcnt(0)
    s_setprio 3
    s_barrier
    v_mfma_f32_16x16x32_bf16 v[0:3], v[120:123], v[100:103], v[0:3]
    ds_read_b64_tr_b16 v[160:161], v182 offset:40960
    ds_read_b64_tr_b16 v[162:163], v182 offset:46080
    v_mfma_f32_16x16x32_bf16 v[4:7], v[124:127], v[100:103], v[4:7]
    s_lshl_b32 s54, s37, 3
    s_add_u32 s54, s54, s32
    s_cmp_lg_u32 s54, 32
    s_cbranch_scc1 L_p2
    buffer_load_dword v187, v188, s[80:83], 0 offen sc1
    buffer_load_dword v198, v189, s[80:83], 0 offen sc1
L_p2:
    v_mfma_f32_16x16x32_bf16 v[8:11], v[128:131], v[100:103], v[8:11]
    ds_read_b128 v[140:143], v180 offset:40960
    v_mfma_f32_16x16x32_bf16 v[12:15], v[132:135], v[100:103], v[12:15]
    v_mfma_f32_16x16x32_bf16 v[16:19], v[136:139], v[100:103], v[16:19]
    ds_read_b64_tr_b16 v[164:165], v184 offset:40960
    ds_read_b64_tr_b16 v[166:167], v184 offset:46080
    s_add_u32 m0, s39, 122880
    s_add_u32 s41, s36, s57
    buffer_load_dwordx4 v186, s[8:11], s41 offen sc1 lds
    v_mfma_f32_16x16x32_bf16 v[20:23], v[120:123], v[104:107], v[20:23]
    s_setprio 2
    v_mfma_f32_16x16x32_bf16 v[24:27], v[124:127], v[104:107], v[24:27]
    ds_read_b128 v[144:147], v180 offset:41984
    v_mfma_f32_16x16x32_bf16 v[28:31], v[128:131], v[104:107], v[28:31]
    buffer_load_dwordx4 v186, s[8:11], s41 offen offset:1024 sc1 lds
    v_mfma_f32_16x16x32_bf16 v[32:35], v[132:135], v[104:107], v[32:35]
    ds_read_b64_tr_b16 v[168:169], v182 offset:41984
    ds_read_b64_tr_b16 v[170:171], v182 offset:47104
    v_mfma_f32_16x16x32_bf16 v[36:39], v[136:139], v[104:107], v[36:39]
    v_mfma_f32_16x16x32_bf16 v[40:43], v[120:123], v[108:111], v[40:43]
    ds_read_b128 v[148:151], v180 offset:43008
    buffer_load_dwordx4 v186, s[8:11], s41 offen offset:2048 sc1 lds
    v_mfma_f32_16x16x32_bf16 v[44:47], v[124:127], v[108:111], v[44:47]
    s_setprio 1
    v_mfma_f32_16x16x32_bf16 v[48:51], v[128:131], v[108:111], v[48:51]
    ds_read_b64_tr_b16 v[172:173], v184 offset:41984
    ds_read_b64_tr_b16 v[174:175], v184 offset:47104
    v_mfma_f32_16x16x32_bf16 v[52:55], v[132:135], v[108:111], v[52:55]
    v_mfma_f32_16x16x32_bf16 v[56:59], v[136:139], v[108:111], v[56:59]
    ds_read_b128 v[152:155], v180 offset:44032
    buffer_load_dwordx4 v186, s[8:11], s41 offen offset:3072 sc1 lds
    v_mfma_f32_16x16x32_bf16 v[60:63], v[120:123], v[112:115], v[60:63]
    v_mfma_f32_16x16x32_bf16 v[64:67], v[124:127], v[112:115], v[64:67]
    ds_read_b64_tr_b16 v[176:177], v182 offset:43008
    ds_read_b64_tr_b16 v[178:179], v182 offset:48128
    v_mfma_f32_16x16x32_bf16 v[68:71], v[128:131], v[112:115], v[68:71]
    s_add_u32 m0, s39, 126976
    s_add_u32 s41, s36, s57
    s_add_u32 s41, s41, 4096
    buffer_load_dwordx4 v186, s[8:11], s41 offen sc1 lds
    s_setprio 0
    v_mfma_f32_16x16x32_bf16 v[72:75], v[132:135], v[112:115], v[72:75]
    ds_read_b128 v[156:159], v180 offset:45056
    v_mfma_f32_16x16x32_bf16 v[76:79], v[136:139], v[112:115], v[76:79]
    v_mfma_f32_16x16x32_bf16 v[80:83], v[120:123], v[116:119], v[80:83]
    s_cmp_gt_u32 s37, 8
    v_mfma_f32_16x16x32_bf16 v[84:87], v[124:127], v[116:119], v[84:87]
    v_mfma_f32_16x16x32_bf16 v[88:91], v[128:131], v[116:119], v[88:91]
    v_mfma_f32_16x16x32_bf16 v[92:95], v[132:135], v[116:119], v[92:95]
    v_mfma_f32_16x16x32_bf16 v[96:99], v[136:139], v[116:119], v[96:99]
    s_cbranch_scc1 L_o_fin
    s_waitcnt vmcnt(5) lgkmcnt(0)
    s_setprio 3
    s_barrier
    v_mfma_f32_16x16x32_bf16 v[0:3], v[160:163], v[140:143], v[0:3]
    ds_read_b64_tr_b16 v[120:121], v183
    ds_read_b64_tr_b16 v[122:123], v183 offset:5120
    v_mfma_f32_16x16x32_bf16 v[4:7], v[164:167], v[140:143], v[4:7]
    s_add_u32 m0, s39, 0
    s_add_u32 s41, s36, s58
    buffer_load_dwordx4 v186, s[8:11], s41 offen sc1 lds
    v_mfma_f32_16x16x32_bf16 v[8:11], v[168:171], v[140:143], v[8:11]
    ds_read_b128 v[100:103], v181
    v_mfma_f32_16x16x32_bf16 v[12:15], v[172:175], v[140:143], v[12:15]
    v_mfma_f32_16x16x32_bf16 v[16:19], v[176:179], v[140:143], v[16:19]
    ds_read_b64_tr_b16 v[124:125], v185
    ds_read_b64_tr_b16 v[126:127], v185 offset:5120
    v_mfma_f32_16x16x32_bf16 v[20:23], v[160:163], v[144:147], v[20:23]
    buffer_load_dwordx4 v186, s[8:11], s41 offen offset:1024 sc1 lds
    s_setprio 2
    v_mfma_f32_16x16x32_bf16 v[24:27], v[164:167], v[144:147], v[24:27]
    ds_read_b128 v[104:107], v181 offset:1024
    v_mfma_f32_16x16x32_bf16 v[28:31], v[168:171], v[144:147], v[28:31]
    v_mfma_f32_16x16x32_bf16 v[32:35], v[172:175], v[144:147], v[32:35]
    ds_read_b64_tr_b16 v[128:129], v183 offset:1024
    ds_read_b64_tr_b16 v[130:131], v183 offset:6144
    v_mfma_f32_16x16x32_bf16 v[36:39], v[176:179], v[144:147], v[36:39]
    v_mfma_f32_16x16x32_bf16 v[40:43], v[160:163], v[148:151], v[40:43]
    ds_read_b128 v[108:111], v181 offset:2048
    buffer_load_dwordx4 v186, s[8:11], s41 offen offset:2048 sc1 lds
    v_mfma_f32_16x16x32_bf16 v[44:47], v[164:167], v[148:151], v[44:47]
    s_setprio 1
    v_mfma_f32_16x16x32_bf16 v[48:51], v[168:171], v[148:151], v[48:51]
    ds_read_b64_tr_b16 v[132:133], v185 offset:1024
    ds_read_b64_tr_b16 v[134:135], v185 offset:6144
    v_mfma_f32_16x16x32_bf16 v[52:55], v[172:175], v[148:151], v[52:55]
    v_mfma_f32_16x16x32_bf16 v[56:59], v[176:179], v[148:151], v[56:59]
    ds_read_b128 v[112:115], v181 offset:3072
    buffer_load_dwordx4 v186, s[8:11], s41 offen offset:3072 sc1 lds
    v_mfma_f32_16x16x32_bf16 v[60:63], v[160:163], v[152:155], v[60:63]
    v_mfma_f32_16x16x32_bf16 v[64:67], v[164:167], v[152:155], v[64:67]
    ds_read_b64_tr_b16 v[136:137], v183 offset:2048
    ds_read_b64_tr_b16 v[138:139], v183 offset:7168
    v_mfma_f32_16x16x32_bf16 v[68:71], v[168:171], v[152:155], v[68:71]
    s_setprio 0
    v_mfma_f32_16x16x32_bf16 v[72:75], v[172:175], v[152:155], v[72:75]
    ds_read_b128 v[116:119], v181 offset:4096
    v_mfma_f32_16x16x32_bf16 v[76:79], v[176:179], v[152:155], v[76:79]
    s_add_u32 m0, s39, 4096
    s_add_u32 s41, s36, s58
    s_add_u32 s41, s41, 4096
    buffer_load_dwordx4 v186, s[8:11], s41 offen sc1 lds
    v_mfma_f32_16x16x32_bf16 v[80:83], v[160:163], v[156:159], v[80:83]
    v_mfma_f32_16x16x32_bf16 v[84:87], v[164:167], v[156:159], v[84:87]
    v_mfma_f32_16x16x32_bf16 v[88:91], v[168:171], v[156:159], v[88:91]
    v_mfma_f32_16x16x32_bf16 v[92:95], v[172:175], v[156:159], v[92:95]
    v_mfma_f32_16x16x32_bf16 v[96:99], v[176:179], v[156:159], v[96:99]
    s_branch L_o_loop0
L_g2:
    buffer_load_dword v187, v188, s[80:83], 0 offen sc1
    s_sub_u32 s49, s49, 1
    s_cmp_lt_i32 s49, 0
    s_cbranch_scc1 L_g2_back
    s_waitcnt vmcnt(0)
    v_readfirstlane_b32 s54, v187
    s_nop 0
    s_bfe_u32 s54, s54, 0x40008
    s_cmp_eq_u32 s54, 15
    s_cbranch_scc1 L_g2_back
    s_sleep 8
    s_branch L_g2
L_g3:
    buffer_load_dword v198, v189, s[80:83], 0 offen sc1
    s_sub_u32 s49, s49, 1
    s_cmp_lt_i32 s49, 0
    s_cbranch_scc1 L_g3_back
    s_waitcnt vmcnt(0)
    v_readfirstlane_b32 s54, v198
    s_nop 0
    s_bfe_u32 s54, s54, 0x40000
    s_cmp_eq_u32 s54, 15
    s_cbranch_scc1 L_g3_back
    s_sleep 8
    s_branch L_g3
L_o_1:
    v_lshrrev_b32 v191, 2, v190
    v_mul_u32_u24 v191, 1280, v191
    v_bfe_u32 v195, v190, 4, 1
    v_lshlrev_b32 v195, 1, v195
    v_and_b32 v186, 3, v190
    v_xor_b32 v186, v186, v195
    v_lshl_add_u32 v186, v186, 4, v191
    s_and_b32 s39, s32, 1
    s_mul_i32 s39, s39, 5120
    s_lshl_b32 s40, s39, 2
    s_and_b32 s54, s35, 3
    s_mul_i32 s54, s54, 320
    s_add_u32 s40, s40, s54
    s_add_u32 s39, s39, 10240
    s_add_u32 s55, s35, s34
    s_add_u32 s54, s55, 0
    s_and_b32 s54, s54, 3
    s_mul_i32 s56, s54, 40960
    s_add_u32 s54, s55, 1
    s_and_b32 s54, s54, 3
    s_mul_i32 s57, s54, 40960
    s_add_u32 s54, s55, 2
    s_and_b32 s54, s54, 3
    s_mul_i32 s58, s54, 40960
    s_add_u32 s54, s55, 3
    s_and_b32 s54, s54, 3
    s_mul_i32 s59, s54, 40960
    s_add_u32 s39, s39, s41
    s_mov_b32 s8, s28
    s_mov_b32 s9, s29
    s_mov_b32 s10, s30
    s_and_b32 s54, s37, 3
    s_and_b32 s55, s35, 4
    s_add_u32 s54, s54, s55
    s_lshl_b32 s54, s54, 2
    s_lshr_b32 s55, s37, 2
    s_lshl_b32 s55, s55, 1
    s_add_u32 s54, s54, s55
    s_add_u32 s54, s54, s43
    s_mul_i32 s54, s54, 163840
    s_add_u32 s36, s40, s54
    s_add_u32 s37, s37, 1
    s_waitcnt vmcnt(18)
    s_barrier
    ds_read_b64_tr_b16 v[120:121], v185 offset:2048
    ds_read_b64_tr_b16 v[122:123], v185 offset:7168
    ds_read_b128 v[100:103], v181
    ds_read_b64_tr_b16 v[124:125], v183 offset:3072
    ds_read_b64_tr_b16 v[126:127], v183 offset:8192
    ds_read_b128 v[104:107], v181 offset:1024
    ds_read_b64_tr_b16 v[128:129], v185 offset:3072
    ds_read_b64_tr_b16 v[130:131], v185 offset:8192
    ds_read_b128 v[108:111], v181 offset:2048
    ds_read_b64_tr_b16 v[132:133], v183 offset:4096
    ds_read_b64_tr_b16 v[134:135], v183 offset:9216
    ds_read_b128 v[112:115], v181 offset:3072
    ds_read_b64_tr_b16 v[136:137], v185 offset:4096
    ds_read_b64_tr_b16 v[138:139], v185 offset:9216
    ds_read_b128 v[116:119], v181 offset:4096
    v_pk_mov_b32 v[0:1], 0, 0
    v_pk_mov_b32 v[2:3], 0, 0
    v_pk_mov_b32 v[4:5], 0, 0
    v_pk_mov_b32 v[6:7], 0, 0
    v_pk_mov_b32 v[8:9], 0, 0
    v_pk_mov_b32 v[10:11], 0, 0
    v_pk_mov_b32 v[12:13], 0, 0
    v_pk_mov_b32 v[14:15], 0, 0
    v_pk_mov_b32 v[16:17], 0, 0
    v_pk_mov_b32 v[18:19], 0, 0
    v_pk_mov_b32 v[20:21], 0, 0
    v_pk_mov_b32 v[22:23], 0, 0
    v_pk_mov_b32 v[24:25], 0, 0
    v_pk_mov_b32 v[26:27], 0, 0
    v_pk_mov_b32 v[28:29], 0, 0
    v_pk_mov_b32 v[30:31], 0, 0
    v_pk_mov_b32 v[32:33], 0, 0
    v_pk_mov_b32 v[34:35], 0, 0
    v_pk_mov_b32 v[36:37], 0, 0
    v_pk_mov_b32 v[38:39], 0, 0
    v_pk_mov_b32 v[40:41], 0, 0
    v_pk_mov_b32 v[42:43], 0, 0
    v_pk_mov_b32 v[44:45], 0, 0
    v_pk_mov_b32 v[46:47], 0, 0
    v_pk_mov_b32 v[48:49], 0, 0
    v_pk_mov_b32 v[50:51], 0, 0
    v_pk_mov_b32 v[52:53], 0, 0
    v_pk_mov_b32 v[54:55], 0, 0
    v_pk_mov_b32 v[56:57], 0, 0
    v_pk_mov_b32 v[58:59], 0, 0
    v_pk_mov_b32 v[60:61], 0, 0
    v_pk_mov_b32 v[62:63], 0, 0
    v_pk_mov_b32 v[64:65], 0, 0
    v_pk_mov_b32 v[66:67], 0, 0
    v_pk_mov_b32 v[68:69], 0, 0
    v_pk_mov_b32 v[70:71], 0, 0
    v_pk_mov_b32 v[72:73], 0, 0
    v_pk_mov_b32 v[74:75], 0, 0
    v_pk_mov_b32 v[76:77], 0, 0
    v_pk_mov_b32 v[78:79], 0, 0
    v_pk_mov_b32 v[80:81], 0, 0
    v_pk_mov_b32 v[82:83], 0, 0
    v_pk_mov_b32 v[84:85], 0, 0
    v_pk_mov_b32 v[86:87], 0, 0
    v_pk_mov_b32 v[88:89], 0, 0
    v_pk_mov_b32 v[90:91], 0, 0
    v_pk_mov_b32 v[92:93], 0, 0
    v_pk_mov_b32 v[94:95], 0, 0
    v_pk_mov_b32 v[96:97], 0, 0
    v_pk_mov_b32 v[98:99], 0, 0
    v_mov_b32 v188, s53
    v_xor_b32 v189, 4, v188
    v_mov_b32 v187, 0
    v_mov_b32 v198, 0
    s_and_b32 s44, s35, 3
    s_mov_b32 s49, 0x8000
    s_mul_i32 s41, s32, 13312
    v_add_u32 v192, s41, v196
    s_xor_b32 s42, s32, 4
    s_mul_i32 s41, s42, 13312
    v_add_u32 v193, s41, v196
    s_lshl_b32 s41, s2, 3
    s_add_u32 s41, s41, s32
    s_mul_i32 s60, s41, 4224
    s_add_u32 s60, s60, 41943040
    s_xor_b32 s41, s41, 8
    s_mul_i32 s61, s41, 4224
    s_add_u32 s61, s61, 41943040
    v_bfe_u32 v194, v196, 4, 4
    v_mul_u32_u24 v194, 1280, v194
    v_bfe_u32 v191, v196, 8, 1
    v_lshl_add_u32 v199, v191, 5, v194
    v_lshrrev_b32 v191, 9, v196
    v_lshl_add_u32 v199, v191, 4, v199
    v_lshrrev_b32 v191, 8, v196
    v_lshl_add_u32 v194, v191, 3, v194
    s_mul_i32 s62, s34, 204800
    s_and_b32 s41, s32, 1
    s_mul_i32 s41, s41, 102400
    s_add_u32 s62, s62, s41
    s_mul_i32 s41, s44, 320
    s_add_u32 s62, s62, s41
    s_bfe_u32 s41, s32, 0x10001
    s_mul_i32 s41, s41, 160
    s_add_u32 s62, s62, s41
    s_lshr_b32 s63, s35, 2
    s_lshl_b32 s42, s43, 1
    s_add_u32 s63, s63, s42
    s_and_b32 s42, s91, s33
    s_cselect_b64 vcc, -1, 0
    s_add_u32 m0, s39, 0
    s_add_u32 s41, s36, s58
    buffer_load_dwordx4 v186, s[8:11], s41 offen lds
    s_add_u32 m0, s39, 960
    s_nop 0
    buffer_load_dwordx4 v186, s[8:11], s41 offen offset:64 lds
    s_add_u32 m0, s39, 1920
    s_nop 0
    buffer_load_dwordx4 v186, s[8:11], s41 offen offset:128 lds
    s_add_u32 m0, s39, 2880
    s_nop 0
    buffer_load_dwordx4 v186, s[8:11], s41 offen offset:192 lds
    s_add_u32 m0, s39, 3840
    s_nop 0
    buffer_load_dwordx4 v186, s[8:11], s41 offen offset:256 lds
    s_waitcnt vmcnt(13)
    s_branch L_o_in1
L_o_loop1:
    s_waitcnt vmcnt(5)
L_o_in1:
    s_waitcnt lgkmcnt(0)
    s_setprio 3
    s_barrier
    v_mfma_f32_16x16x32_bf16 v[0:3], v[120:123], v[100:103], v[0:3]
    ds_read_b64_tr_b16 v[160:161], v185 offset:43008
    ds_read_b64_tr_b16 v[162:163], v185 offset:48128
    v_mfma_f32_16x16x32_bf16 v[4:7], v[124:127], v[100:103], v[4:7]
    s_add_u32 m0, s39, 40960
    s_add_u32 s41, s36, s59
    buffer_load_dwordx4 v186, s[8:11], s41 offen lds
    v_mfma_f32_16x16x32_bf16 v[8:11], v[128:131], v[100:103], v[8:11]
    ds_read_b128 v[140:143], v181 offset:40960
    v_mfma_f32_16x16x32_bf16 v[12:15], v[132:135], v[100:103], v[12:15]
    v_mfma_f32_16x16x32_bf16 v[16:19], v[136:139], v[100:103], v[16:19]
    ds_read_b64_tr_b16 v[164:165], v183 offset:44032
    ds_read_b64_tr_b16 v[166:167], v183 offset:49152
    s_add_u32 m0, s39, 41920
    s_nop 0
    buffer_load_dwordx4 v186, s[8:11], s41 offen offset:64 lds
    v_mfma_f32_16x16x32_bf16 v[20:23], v[120:123], v[104:107], v[20:23]
    s_setprio 2
    v_mfma_f32_16x16x32_bf16 v[24:27], v[124:127], v[104:107], v[24:27]
    ds_read_b128 v[144:147], v181 offset:41984
    v_mfma_f32_16x16x32_bf16 v[28:31], v[128:131], v[104:107], v[28:31]
    v_mfma_f32_16x16x32_bf16 v[32:35], v[132:135], v[104:107], v[32:35]
    ds_read_b64_tr_b16 v[168:169], v185 offset:44032
    ds_read_b64_tr_b16 v[170:171], v185 offset:49152
    s_add_u32 m0, s39, 42880
    s_nop 0
    buffer_load_dwordx4 v186, s[8:11], s41 offen offset:128 lds
    v_mfma_f32_16x16x32_bf16 v[36:39], v[136:139], v[104:107], v[36:39]
    v_mfma_f32_16x16x32_bf16 v[40:43], v[120:123], v[108:111], v[40:43]
    ds_read_b128 v[148:151], v181 offset:43008
    v_mfma_f32_16x16x32_bf16 v[44:47], v[124:127], v[108:111], v[44:47]
    s_setprio 1
    v_mfma_f32_16x16x32_bf16 v[48:51], v[128:131], v[108:111], v[48:51]
    ds_read_b64_tr_b16 v[172:173], v183 offset:45056
    ds_read_b64_tr_b16 v[174:175], v183 offset:50176
    s_add_u32 m0, s39, 43840
    s_nop 0
    buffer_load_dwordx4 v186, s[8:11], s41 offen offset:192 lds
    v_mfma_f32_16x16x32_bf16 v[52:55], v[132:135], v[108:111], v[52:55]
    v_mfma_f32_16x16x32_bf16 v[56:59], v[136:139], v[108:111], v[56:59]
    ds_read_b128 v[152:155], v181 offset:44032
    v_mfma_f32_16x16x32_bf16 v[60:63], v[120:123], v[112:115], v[60:63]
    v_mfma_f32_16x16x32_bf16 v[64:67], v[124:127], v[112:115], v[64:67]
    ds_read_b64_tr_b16 v[176:177], v185 offset:45056
    ds_read_b64_tr_b16 v[178:179], v185 offset:50176
    s_add_u32 m0, s39, 44800
    s_nop 0
    buffer_load_dwordx4 v186, s[8:11], s41 offen offset:256 lds
    v_mfma_f32_16x16x32_bf16 v[68:71], v[128:131], v[112:115], v[68:71]
    s_setprio 0
    v_mfma_f32_16x16x32_bf16 v[72:75], v[132:135], v[112:115], v[72:75]
    ds_read_b128 v[156:159], v181 offset:45056
    v_mfma_f32_16x16x32_bf16 v[76:79], v[136:139], v[112:115], v[76:79]
    v_mfma_f32_16x16x32_bf16 v[80:83], v[120:123], v[116:119], v[80:83]
    s_and_b32 s54, s37, 3
    s_and_b32 s55, s35, 4
    s_add_u32 s54, s54, s55
    s_lshl_b32 s54, s54, 2
    s_lshr_b32 s55, s37, 2
    s_lshl_b32 s55, s55, 1
    s_add_u32 s54, s54, s55
    s_add_u32 s54, s54, s43
    s_mul_i32 s54, s54, 163840
    s_add_u32 s36, s40, s54
    s_add_u32 s37, s37, 1
    s_cmp_gt_u32 s37, 8
    s_cselect_b32 s10, 0, s10
    v_mfma_f32_16x16x32_bf16 v[84:87], v[124:127], v[116:119], v[84:87]
    v_mfma_f32_16x16x32_bf16 v[88:91], v[128:131], v[116:119], v[88:91]
    v_mfma_f32_16x16x32_bf16 v[92:95], v[132:135], v[116:119], v[92:95]
    v_mfma_f32_16x16x32_bf16 v[96:99], v[136:139], v[116:119], v[96:99]
    s_waitcnt vmcnt(5) lgkmcnt(0)
    s_setprio 3
    s_barrier
    v_mfma_f32_16x16x32_bf16 v[0:3], v[160:163], v[140:143], v[0:3]
    ds_read_b64_tr_b16 v[120:121], v184 offset:2048
    ds_read_b64_tr_b16 v[122:123], v184 offset:7168
    v_mfma_f32_16x16x32_bf16 v[4:7], v[164:167], v[140:143], v[4:7]
    s_lshl_b32 s54, s37, 3
    s_add_u32 s54, s54, s32
    s_cmp_lg_u32 s54, 18
    s_cbranch_scc1 L_nofl2
    s_lshl_b32 s54, 0x100, s44
    v_mov_b32 v190, s54
    v_mov_b32 v191, s53
    s_mov_b64 exec, 1
    buffer_atomic_or v190, v191, s[80:83], 0 offen sc1
    s_mov_b64 exec, -1
L_nofl2:
    v_mfma_f32_16x16x32_bf16 v[8:11], v[168:171], v[140:143], v[8:11]
    ds_read_b128 v[100:103], v180
    v_mfma_f32_16x16x32_bf16 v[12:15], v[172:175], v[140:143], v[12:15]
    v_mfma_f32_16x16x32_bf16 v[16:19], v[176:179], v[140:143], v[16:19]
    ds_read_b64_tr_b16 v[124:125], v182 offset:3072
    ds_read_b64_tr_b16 v[126:127], v182 offset:8192
    s_add_u32 m0, s39, 81920
    s_add_u32 s41, s36, s56
    buffer_load_dwordx4 v186, s[8:11], s41 offen lds
    v_mfma_f32_16x16x32_bf16 v[20:23], v[160:163], v[144:147], v[20:23]
    s_setprio 2
    v_mfma_f32_16x16x32_bf16 v[24:27], v[164:167], v[144:147], v[24:27]
    ds_read_b128 v[104:107], v180 offset:1024
    v_mfma_f32_16x16x32_bf16 v[28:31], v[168:171], v[144:147], v[28:31]
    v_mfma_f32_16x16x32_bf16 v[32:35], v[172:175], v[144:147], v[32:35]
    ds_read_b64_tr_b16 v[128:129], v184 offset:3072
    ds_read_b64_tr_b16 v[130:131], v184 offset:8192
    s_add_u32 m0, s39, 82880
    s_nop 0
    buffer_load_dwordx4 v186, s[8:11], s41 offen offset:64 lds
    v_mfma_f32_16x16x32_bf16 v[36:39], v[176:179], v[144:147], v[36:39]
    v_mfma_f32_16x16x32_bf16 v[40:43], v[160:163], v[148:151], v[40:43]
    ds_read_b128 v[108:111], v180 offset:2048
    v_mfma_f32_16x16x32_bf16 v[44:47], v[164:167], v[148:151], v[44:47]
    s_setprio 1
    v_mfma_f32_16x16x32_bf16 v[48:51], v[168:171], v[148:151], v[48:51]
    ds_read_b64_tr_b16 v[132:133], v182 offset:4096
    ds_read_b64_tr_b16 v[134:135], v182 offset:9216
    s_add_u32 m0, s39, 83840
    s_nop 0
    buffer_load_dwordx4 v186, s[8:11], s41 offen offset:128 lds
    v_mfma_f32_16x16x32_bf16 v[52:55], v[172:175], v[148:151], v[52:55]
    v_mfma_f32_16x16x32_bf16 v[56:59], v[176:179], v[148:151], v[56:59]
    ds_read_b128 v[112:115], v180 offset:3072
    v_mfma_f32_16x16x32_bf16 v[60:63], v[160:163], v[152:155], v[60:63]
    v_mfma_f32_16x16x32_bf16 v[64:67], v[164:167], v[152:155], v[64:67]
    ds_read_b64_tr_b16 v[136:137], v184 offset:4096
    ds_read_b64_tr_b16 v[138:139], v184 offset:9216
    s_add_u32 m0, s39, 84800
    s_nop 0
    buffer_load_dwordx4 v186, s[8:11], s41 offen offset:192 lds
    v_mfma_f32_16x16x32_bf16 v[68:71], v[168:171], v[152:155], v[68:71]
    s_setprio 0
    v_mfma_f32_16x16x32_bf16 v[72:75], v[172:175], v[152:155], v[72:75]
    ds_read_b128 v[116:119], v180 offset:4096
    v_mfma_f32_16x16x32_bf16 v[76:79], v[176:179], v[152:155], v[76:79]
    v_mfma_f32_16x16x32_bf16 v[80:83], v[160:163], v[156:159], v[80:83]
    s_add_u32 m0, s39, 85760
    s_nop 0
    buffer_load_dwordx4 v186, s[8:11], s41 offen offset:256 lds
    v_mfma_f32_16x16x32_bf16 v[84:87], v[164:167], v[156:159], v[84:87]
    v_mfma_f32_16x16x32_bf16 v[88:91], v[168:171], v[156:159], v[88:91]
    v_mfma_f32_16x16x32_bf16 v[92:95], v[172:175], v[156:159], v[92:95]
    v_mfma_f32_16x16x32_bf16 v[96:99], v[176:179], v[156:159], v[96:99]
    s_waitcnt vmcnt(5) lgkmcnt(0)
    s_setprio 3
    s_barrier
    v_mfma_f32_16x16x32_bf16 v[0:3], v[120:123], v[100:103], v[0:3]
    ds_read_b64_tr_b16 v[160:161], v184 offset:43008
    ds_read_b64_tr_b16 v[162:163], v184 offset:48128
    v_mfma_f32_16x16x32_bf16 v[4:7], v[124:127], v[100:103], v[4:7]
    s_add_u32 m0, s39, 122880
    s_add_u32 s41, s36, s57
    buffer_load_dwordx4 v186, s[8:11], s41 offen lds
    v_mfma_f32_16x16x32_bf16 v[8:11], v[128:131], v[100:103], v[8:11]
    ds_read_b128 v[140:143], v180 offset:40960
    v_mfma_f32_16x16x32_bf16 v[12:15], v[132:135], v[100:103], v[12:15]
    v_mfma_f32_16x16x32_bf16 v[16:19], v[136:139], v[100:103], v[16:19]
    ds_read_b64_tr_b16 v[164:165], v182 offset:44032
    ds_read_b64_tr_b16 v[166:167], v182 offset:49152
    s_add_u32 m0, s39, 123840
    s_nop 0
    buffer_load_dwordx4 v186, s[8:11], s41 offen offset:64 lds
    v_mfma_f32_16x16x32_bf16 v[20:23], v[120:123], v[104:107], v[20:23]
    s_setprio 2
    v_mfma_f32_16x16x32_bf16 v[24:27], v[124:127], v[104:107], v[24:27]
    ds_read_b128 v[144:147], v180 offset:41984
    v_mfma_f32_16x16x32_bf16 v[28:31], v[128:131], v[104:107], v[28:31]
    v_mfma_f32_16x16x32_bf16 v[32:35], v[132:135], v[104:107], v[32:35]
    ds_read_b64_tr_b16 v[168:169], v184 offset:44032
    ds_read_b64_tr_b16 v[170:171], v184 offset:49152
    s_add_u32 m0, s39, 124800
    s_nop 0
    buffer_load_dwordx4 v186, s[8:11], s41 offen offset:128 lds
    v_mfma_f32_16x16x32_bf16 v[36:39], v[136:139], v[104:107], v[36:39]
    v_mfma_f32_16x16x32_bf16 v[40:43], v[120:123], v[108:111], v[40:43]
    ds_read_b128 v[148:151], v180 offset:43008
    v_mfma_f32_16x16x32_bf16 v[44:47], v[124:127], v[108:111], v[44:47]
    s_setprio 1
    v_mfma_f32_16x16x32_bf16 v[48:51], v[128:131], v[108:111], v[48:51]
    ds_read_b64_tr_b16 v[172:173], v182 offset:45056
    ds_read_b64_tr_b16 v[174:175], v182 offset:50176
    s_add_u32 m0, s39, 125760
    s_nop 0
    buffer_load_dwordx4 v186, s[8:11], s41 offen offset:192 lds
    v_mfma_f32_16x16x32_bf16 v[52:55], v[132:135], v[108:111], v[52:55]
    v_mfma_f32_16x16x32_bf16 v[56:59], v[136:139], v[108:111], v[56:59]
    ds_read_b128 v[152:155], v180 offset:44032
    v_mfma_f32_16x16x32_bf16 v[60:63], v[120:123], v[112:115], v[60:63]
    v_mfma_f32_16x16x32_bf16 v[64:67], v[124:127], v[112:115], v[64:67]
    ds_read_b64_tr_b16 v[176:177], v184 offset:45056
    ds_read_b64_tr_b16 v[178:179], v184 offset:50176
    s_add_u32 m0, s39, 126720
    s_nop 0
    buffer_load_dwordx4 v186, s[8:11], s41 offen offset:256 lds
    v_mfma_f32_16x16x32_bf16 v[68:71], v[128:131], v[112:115], v[68:71]
    s_setprio 0
    v_mfma_f32_16x16x32_bf16 v[72:75], v[132:135], v[112:115], v[72:75]
    ds_read_b128 v[156:159], v180 offset:45056
    v_mfma_f32_16x16x32_bf16 v[76:79], v[136:139], v[112:115], v[76:79]
    v_mfma_f32_16x16x32_bf16 v[80:83], v[120:123], v[116:119], v[80:83]
    s_cmp_gt_u32 s37, 8
    v_mfma_f32_16x16x32_bf16 v[84:87], v[124:127], v[116:119], v[84:87]
    v_mfma_f32_16x16x32_bf16 v[88:91], v[128:131], v[116:119], v[88:91]
    v_mfma_f32_16x16x32_bf16 v[92:95], v[132:135], v[116:119], v[92:95]
    v_mfma_f32_16x16x32_bf16 v[96:99], v[136:139], v[116:119], v[96:99]
    s_cbranch_scc1 L_o_fin
    s_waitcnt vmcnt(5) lgkmcnt(0)
    s_setprio 3
    s_barrier
    v_mfma_f32_16x16x32_bf16 v[0:3], v[160:163], v[140:143], v[0:3]
    ds_read_b64_tr_b16 v[120:121], v185 offset:2048
    ds_read_b64_tr_b16 v[122:123], v185 offset:7168
    v_mfma_f32_16x16x32_bf16 v[4:7], v[164:167], v[140:143], v[4:7]
    s_add_u32 m0, s39, 0
    s_add_u32 s41, s36, s58
    buffer_load_dwordx4 v186, s[8:11], s41 offen lds
    v_mfma_f32_16x16x32_bf16 v[8:11], v[168:171], v[140:143], v[8:11]
    ds_read_b128 v[100:103], v181
    v_mfma_f32_16x16x32_bf16 v[12:15], v[172:175], v[140:143], v[12:15]
    v_mfma_f32_16x16x32_bf16 v[16:19], v[176:179], v[140:143], v[16:19]
    ds_read_b64_tr_b16 v[124:125], v183 offset:3072
    ds_read_b64_tr_b16 v[126:127], v183 offset:8192
    v_mfma_f32_16x16x32_bf16 v[20:23], v[160:163], v[144:147], v[20:23]
    s_add_u32 m0, s39, 960
    s_nop 0
    buffer_load_dwordx4 v186, s[8:11], s41 offen offset:64 lds
    s_setprio 2
    v_mfma_f32_16x16x32_bf16 v[24:27], v[164:167], v[144:147], v[24:27]
    ds_read_b128 v[104:107], v181 offset:1024
    v_mfma_f32_16x16x32_bf16 v[28:31], v[168:171], v[144:147], v[28:31]
    v_mfma_f32_16x16x32_bf16 v[32:35], v[172:175], v[144:147], v[32:35]
    ds_read_b64_tr_b16 v[128:129], v185 offset:3072
    ds_read_b64_tr_b16 v[130:131], v185 offset:8192
    v_mfma_f32_16x16x32_bf16 v[36:39], v[176:179], v[144:147], v[36:39]
    v_mfma_f32_16x16x32_bf16 v[40:43], v[160:163], v[148:151], v[40:43]
    ds_read_b128 v[108:111], v181 offset:2048
    s_add_u32 m0, s39, 1920
    s_nop 0
    buffer_load_dwordx4 v186, s[8:11], s41 offen offset:128 lds
    v_mfma_f32_16x16x32_bf16 v[44:47], v[164:167], v[148:151], v[44:47]
    s_setprio 1
    v_mfma_f32_16x16x32_bf16 v[48:51], v[168:171], v[148:151], v[48:51]
    ds_read_b64_tr_b16 v[132:133], v183 offset:4096
    ds_read_b64_tr_b16 v[134:135], v183 offset:9216
    v_mfma_f32_16x16x32_bf16 v[52:55], v[172:175], v[148:151], v[52:55]
    v_mfma_f32_16x16x32_bf16 v[56:59], v[176:179], v[148:151], v[56:59]
    ds_read_b128 v[112:115], v181 offset:3072
    s_add_u32 m0, s39, 2880
    s_nop 0
    buffer_load_dwordx4 v186, s[8:11], s41 offen offset:192 lds
    v_mfma_f32_16x16x32_bf16 v[60:63], v[160:163], v[152:155], v[60:63]
    v_mfma_f32_16x16x32_bf16 v[64:67], v[164:167], v[152:155], v[64:67]
    ds_read_b64_tr_b16 v[136:137], v185 offset:4096
    ds_read_b64_tr_b16 v[138:139], v185 offset:9216
    v_mfma_f32_16x16x32_bf16 v[68:71], v[168:171], v[152:155], v[68:71]
    s_setprio 0
    v_mfma_f32_16x16x32_bf16 v[72:75], v[172:175], v[152:155], v[72:75]
    ds_read_b128 v[116:119], v181 offset:4096
    v_mfma_f32_16x16x32_bf16 v[76:79], v[176:179], v[152:155], v[76:79]
    s_add_u32 m0, s39, 3840
    s_nop 0
    buffer_load_dwordx4 v186, s[8:11], s41 offen offset:256 lds
    v_mfma_f32_16x16x32_bf16 v[80:83], v[160:163], v[156:159], v[80:83]
    v_mfma_f32_16x16x32_bf16 v[84:87], v[164:167], v[156:159], v[84:87]
    v_mfma_f32_16x16x32_bf16 v[88:91], v[168:171], v[156:159], v[88:91]
    v_mfma_f32_16x16x32_bf16 v[92:95], v[172:175], v[156:159], v[92:95]
    v_mfma_f32_16x16x32_bf16 v[96:99], v[176:179], v[156:159], v[96:99]
    s_branch L_o_loop1
L_o_fin:
    s_waitcnt vmcnt(0) lgkmcnt(0)
    s_barrier
    s_cmp_eq_u32 s63, 1
    s_cbranch_scc1 L_o_epi1
    s_cmp_eq_u32 s63, 2
    s_cbranch_scc1 L_o_epi2
    s_cmp_eq_u32 s63, 3
    s_cbranch_scc1 L_o_epi3
L_o_epi0:
    v_mfma_f32_16x16x32_bf16 v[52:55], v[172:175], v[148:151], v[52:55]
    v_mfma_f32_16x16x32_bf16 v[56:59], v[176:179], v[148:151], v[56:59]
    v_mfma_f32_16x16x32_bf16 v[60:63], v[160:163], v[152:155], v[60:63]
    v_mfma_f32_16x16x32_bf16 v[64:67], v[164:167], v[152:155], v[64:67]
    v_mfma_f32_16x16x32_bf16 v[68:71], v[168:171], v[152:155], v[68:71]
    s_nop 3
    ds_write_b128 v192, v[52:55]
    v_mfma_f32_16x16x32_bf16 v[72:75], v[172:175], v[152:155], v[72:75]
    ds_write_b128 v192, v[56:59] offset:1024
    v_mfma_f32_16x16x32_bf16 v[76:79], v[176:179], v[152:155], v[76:79]
    ds_write_b128 v192, v[60:63] offset:2048
    v_mfma_f32_16x16x32_bf16 v[80:83], v[160:163], v[156:159], v[80:83]
    ds_write_b128 v192, v[64:67] offset:3072
    v_mfma_f32_16x16x32_bf16 v[84:87], v[164:167], v[156:159], v[84:87]
    v_mfma_f32_16x16x32_bf16 v[88:91], v[168:171], v[156:159], v[88:91]
    ds_write_b128 v192, v[68:71] offset:4096
    v_mfma_f32_16x16x32_bf16 v[92:95], v[172:175], v[156:159], v[92:95]
    ds_write_b128 v192, v[72:75] offset:5120
    v_mfma_f32_16x16x32_bf16 v[96:99], v[176:179], v[156:159], v[96:99]
    ds_write_b128 v192, v[76:79] offset:6144
    v_mfma_f32_16x16x32_bf16 v[28:31], v[168:171], v[144:147], v[28:31]
    ds_write_b128 v192, v[80:83] offset:7168
    v_mfma_f32_16x16x32_bf16 v[32:35], v[172:175], v[144:147], v[32:35]
    v_mfma_f32_16x16x32_bf16 v[36:39], v[176:179], v[144:147], v[36:39]
    ds_write_b128 v192, v[84:87] offset:8192
    v_mfma_f32_16x16x32_bf16 v[40:43], v[160:163], v[148:151], v[40:43]
    ds_write_b128 v192, v[88:91] offset:9216
    v_mfma_f32_16x16x32_bf16 v[44:47], v[164:167], v[148:151], v[44:47]
    ds_write_b128 v192, v[92:95] offset:10240
    v_mfma_f32_16x16x32_bf16 v[48:51], v[168:171], v[148:151], v[48:51]
    ds_write_b128 v192, v[96:99] offset:11264
    v_mfma_f32_16x16x32_bf16 v[0:3], v[160:163], v[140:143], v[0:3]
    v_mfma_f32_16x16x32_bf16 v[4:7], v[164:167], v[140:143], v[4:7]
    v_mfma_f32_16x16x32_bf16 v[8:11], v[168:171], v[140:143], v[8:11]
    v_mfma_f32_16x16x32_bf16 v[12:15], v[172:175], v[140:143], v[12:15]
    v_mfma_f32_16x16x32_bf16 v[16:19], v[176:179], v[140:143], v[16:19]
    v_mfma_f32_16x16x32_bf16 v[20:23], v[160:163], v[144:147], v[20:23]
    v_mfma_f32_16x16x32_bf16 v[24:27], v[164:167], v[144:147], v[24:27]
    s_waitcnt lgkmcnt(0)
    s_barrier
    ds_read_b128 v[200:203], v193 offset:7168
    ds_read_b128 v[204:207], v193 offset:8192
    ds_read_b128 v[208:211], v193 offset:9216
    ds_read_b128 v[212:215], v193 offset:10240
    ds_read_b128 v[216:219], v193 offset:11264
    ds_read_b128 v[220:223], v193 offset:12288
    ds_read_b128 v[224:227], v193
    ds_read_b128 v[228:231], v193 offset:1024
    ds_read_b128 v[232:235], v193 offset:2048
    ds_read_b128 v[236:239], v193 offset:3072
    ds_read_b128 v[240:243], v193 offset:4096
    ds_read_b128 v[244:247], v193 offset:5120
    ds_read_b128 v[248:251], v193 offset:6144
    s_waitcnt lgkmcnt(12)
    v_pk_add_f32 v[28:29], v[28:29], v[200:201]
    v_pk_add_f32 v[30:31], v[30:31], v[202:203]
    v_cvt_pk_bf16_f32 v100, v28, v29
    v_cvt_pk_bf16_f32 v101, v30, v31
    s_waitcnt lgkmcnt(11)
    v_pk_add_f32 v[32:33], v[32:33], v[204:205]
    v_pk_add_f32 v[34:35], v[34:35], v[206:207]
    v_cvt_pk_bf16_f32 v102, v32, v33
    v_cvt_pk_bf16_f32 v103, v34, v35
    s_cbranch_vccz L_slow20
    buffer_store_dwordx4 v[100:103], v196, s[24:27], s60 offen
L_slowb20:
    s_waitcnt lgkmcnt(10)
    v_pk_add_f32 v[36:37], v[36:37], v[208:209]
    v_pk_add_f32 v[38:39], v[38:39], v[210:211]
    v_cvt_pk_bf16_f32 v104, v36, v37
    v_cvt_pk_bf16_f32 v105, v38, v39
    s_waitcnt lgkmcnt(9)
    v_pk_add_f32 v[40:41], v[40:41], v[212:213]
    v_pk_add_f32 v[42:43], v[42:43], v[214:215]
    v_cvt_pk_bf16_f32 v106, v40, v41
    v_cvt_pk_bf16_f32 v107, v42, v43
    s_cbranch_vccz L_slow21
    buffer_store_dwordx4 v[104:107], v196, s[24:27], s60 offen offset:1024
L_slowb21:
    s_waitcnt lgkmcnt(8)
    v_pk_add_f32 v[44:45], v[44:45], v[216:217]
    v_pk_add_f32 v[46:47], v[46:47], v[218:219]
    v_cvt_pk_bf16_f32 v108, v44, v45
    v_cvt_pk_bf16_f32 v109, v46, v47
    s_waitcnt lgkmcnt(7)
    v_pk_add_f32 v[48:49], v[48:49], v[220:221]
    v_pk_add_f32 v[50:51], v[50:51], v[222:223]
    v_cvt_pk_bf16_f32 v110, v48, v49
    v_cvt_pk_bf16_f32 v111, v50, v51
    s_cbranch_vccz L_slow22
    buffer_store_dwordx4 v[108:111], v196, s[24:27], s60 offen offset:2048
L_slowb22:
    s_waitcnt lgkmcnt(6)
    v_pk_add_f32 v[0:1], v[0:1], v[224:225]
    v_pk_add_f32 v[2:3], v[2:3], v[226:227]
    s_waitcnt lgkmcnt(5)
    v_pk_add_f32 v[4:5], v[4:5], v[228:229]
    v_pk_add_f32 v[6:7], v[6:7], v[230:231]
    s_waitcnt lgkmcnt(4)
    v_pk_add_f32 v[8:9], v[8:9], v[232:233]
    v_pk_add_f32 v[10:11], v[10:11], v[234:235]
    s_waitcnt lgkmcnt(3)
    v_pk_add_f32 v[12:13], v[12:13], v[236:237]
    v_pk_add_f32 v[14:15], v[14:15], v[238:239]
    s_waitcnt lgkmcnt(2)
    v_pk_add_f32 v[16:17], v[16:17], v[240:241]
    v_pk_add_f32 v[18:19], v[18:19], v[242:243]
    s_waitcnt lgkmcnt(1)
    v_pk_add_f32 v[20:21], v[20:21], v[244:245]
    v_pk_add_f32 v[22:23], v[22:23], v[246:247]
    s_waitcnt lgkmcnt(0)
    v_pk_add_f32 v[24:25], v[24:25], v[248:249]
    v_pk_add_f32 v[26:27], v[26:27], v[250:251]
    v_mov_b32 v198, 1
    v_mov_b32 v188, 4096
    s_waitcnt vmcnt(0)
    s_mov_b64 exec, 1
    s_cbranch_vccz L_slow23
    buffer_store_dword v198, v188, s[24:27], s60 offen
L_slowb23:
L_x0:
    buffer_load_dword v187, v188, s[24:27], s61 offen sc1
    s_sub_u32 s49, s49, 1
    s_cmp_lt_i32 s49, 0
    s_cbranch_scc1 L_x0_ok
    s_waitcnt vmcnt(0)
    v_readfirstlane_b32 s54, v187
    s_nop 0
    s_cmp_eq_u32 s54, 1
    s_cbranch_scc1 L_x0_ok
    s_sleep 2
    s_branch L_x0
L_x0_ok:
    s_mov_b64 exec, -1
    s_cbranch_vccz L_xl0
    buffer_load_dwordx4 v[200:203], v196, s[24:27], s61 offen
    buffer_load_dwordx4 v[204:207], v196, s[24:27], s61 offen offset:1024
    buffer_load_dwordx4 v[208:211], v196, s[24:27], s61 offen offset:2048
    buffer_load_dwordx4 v[212:215], v196, s[24:27], s61 offen offset:3072
L_xl0_b:
    s_waitcnt vmcnt(0)
    v_lshlrev_b32 v216, 16, v200
    v_and_b32 v217, 0xffff0000, v200
    v_lshlrev_b32 v218, 16, v201
    v_and_b32 v219, 0xffff0000, v201
    v_pk_add_f32 v[0:1], v[0:1], v[216:217]
    v_pk_add_f32 v[2:3], v[2:3], v[218:219]
    v_cvt_pk_bf16_f32 v0, v0, v1
    v_cvt_pk_bf16_f32 v1, v2, v3
    v_lshlrev_b32 v216, 16, v202
    v_and_b32 v217, 0xffff0000, v202
    v_lshlrev_b32 v218, 16, v203
    v_and_b32 v219, 0xffff0000, v203
    v_pk_add_f32 v[4:5], v[4:5], v[216:217]
    v_pk_add_f32 v[6:7], v[6:7], v[218:219]
    v_cvt_pk_bf16_f32 v2, v4, v5
    v_cvt_pk_bf16_f32 v3, v6, v7
    s_add_u32 s41, s62, 0
    v_permlane16_swap_b32 v0, v2
    v_permlane16_swap_b32 v1, v3
    buffer_store_dwordx4 v[0:3], v199, s[76:79], s41 offen
    v_lshlrev_b32 v216, 16, v204
    v_and_b32 v217, 0xffff0000, v204
    v_lshlrev_b32 v218, 16, v205
    v_and_b32 v219, 0xffff0000, v205
    v_pk_add_f32 v[8:9], v[8:9], v[216:217]
    v_pk_add_f32 v[10:11], v[10:11], v[218:219]
    v_cvt_pk_bf16_f32 v8, v8, v9
    v_cvt_pk_bf16_f32 v9, v10, v11
    v_lshlrev_b32 v216, 16, v206
    v_and_b32 v217, 0xffff0000, v206
    v_lshlrev_b32 v218, 16, v207
    v_and_b32 v219, 0xffff0000, v207
    v_pk_add_f32 v[12:13], v[12:13], v[216:217]
    v_pk_add_f32 v[14:15], v[14:15], v[218:219]
    v_cvt_pk_bf16_f32 v10, v12, v13
    v_cvt_pk_bf16_f32 v11, v14, v15
    s_add_u32 s41, s62, 0
    v_permlane16_swap_b32 v8, v10
    v_permlane16_swap_b32 v9, v11
    buffer_store_dwordx4 v[8:11], v199, s[76:79], s41 offen offset:64
    v_lshlrev_b32 v216, 16, v208
    v_and_b32 v217, 0xffff0000, v208
    v_lshlrev_b32 v218, 16, v209
    v_and_b32 v219, 0xffff0000, v209
    v_pk_add_f32 v[16:17], v[16:17], v[216:217]
    v_pk_add_f32 v[18:19], v[18:19], v[218:219]
    v_cvt_pk_bf16_f32 v16, v16, v17
    v_cvt_pk_bf16_f32 v17, v18, v19
    s_add_u32 s41, s62, 0
    buffer_store_dwordx2 v[16:17], v194, s[76:79], s41 offen offset:128
    v_lshlrev_b32 v216, 16, v210
    v_and_b32 v217, 0xffff0000, v210
    v_lshlrev_b32 v218, 16, v211
    v_and_b32 v219, 0xffff0000, v211
    v_pk_add_f32 v[20:21], v[20:21], v[216:217]
    v_pk_add_f32 v[22:23], v[22:23], v[218:219]
    v_cvt_pk_bf16_f32 v20, v20, v21
    v_cvt_pk_bf16_f32 v21, v22, v23
    v_lshlrev_b32 v216, 16, v212
    v_and_b32 v217, 0xffff0000, v212
    v_lshlrev_b32 v218, 16, v213
    v_and_b32 v219, 0xffff0000, v213
    v_pk_add_f32 v[24:25], v[24:25], v[216:217]
    v_pk_add_f32 v[26:27], v[26:27], v[218:219]
    v_cvt_pk_bf16_f32 v22, v24, v25
    v_cvt_pk_bf16_f32 v23, v26, v27
    s_add_u32 s41, s62, 20480
    v_permlane16_swap_b32 v20, v22
    v_permlane16_swap_b32 v21, v23
    buffer_store_dwordx4 v[20:23], v199, s[76:79], s41 offen
    s_endpgm
L_o_epi1:
    v_mfma_f32_16x16x32_bf16 v[52:55], v[172:175], v[148:151], v[52:55]
    v_mfma_f32_16x16x32_bf16 v[56:59], v[176:179], v[148:151], v[56:59]
    v_mfma_f32_16x16x32_bf16 v[60:63], v[160:163], v[152:155], v[60:63]
    v_mfma_f32_16x16x32_bf16 v[64:67], v[164:167], v[152:155], v[64:67]
    v_mfma_f32_16x16x32_bf16 v[68:71], v[168:171], v[152:155], v[68:71]
    s_nop 3
    ds_write_b128 v192, v[52:55]
    v_mfma_f32_16x16x32_bf16 v[72:75], v[172:175], v[152:155], v[72:75]
    ds_write_b128 v192, v[56:59] offset:1024
    v_mfma_f32_16x16x32_bf16 v[76:79], v[176:179], v[152:155], v[76:79]
    ds_write_b128 v192, v[60:63] offset:2048
    v_mfma_f32_16x16x32_bf16 v[80:83], v[160:163], v[156:159], v[80:83]
    ds_write_b128 v192, v[64:67] offset:3072
    v_mfma_f32_16x16x32_bf16 v[84:87], v[164:167], v[156:159], v[84:87]
    v_mfma_f32_16x16x32_bf16 v[88:91], v[168:171], v[156:159], v[88:91]
    ds_write_b128 v192, v[68:71] offset:4096
    v_mfma_f32_16x16x32_bf16 v[92:95], v[172:175], v[156:159], v[92:95]
    ds_write_b128 v192, v[72:75] offset:5120
    v_mfma_f32_16x16x32_bf16 v[96:99], v[176:179], v[156:159], v[96:99]
    ds_write_b128 v192, v[76:79] offset:6144
    v_mfma_f32_16x16x32_bf16 v[0:3], v[160:163], v[140:143], v[0:3]
    ds_write_b128 v192, v[80:83] offset:7168
    v_mfma_f32_16x16x32_bf16 v[4:7], v[164:167], v[140:143], v[4:7]
    v_mfma_f32_16x16x32_bf16 v[8:11], v[168:171], v[140:143], v[8:11]
    ds_write_b128 v192, v[84:87] offset:8192
    v_mfma_f32_16x16x32_bf16 v[12:15], v[172:175], v[140:143], v[12:15]
    ds_write_b128 v192, v[88:91] offset:9216
    v_mfma_f32_16x16x32_bf16 v[16:19], v[176:179], v[140:143], v[16:19]
    ds_write_b128 v192, v[92:95] offset:10240
    v_mfma_f32_16x16x32_bf16 v[20:23], v[160:163], v[144:147], v[20:23]
    ds_write_b128 v192, v[96:99] offset:11264
    v_mfma_f32_16x16x32_bf16 v[24:27], v[164:167], v[144:147], v[24:27]
    v_mfma_f32_16x16x32_bf16 v[28:31], v[168:171], v[144:147], v[28:31]
    v_mfma_f32_16x16x32_bf16 v[32:35], v[172:175], v[144:147], v[32:35]
    v_mfma_f32_16x16x32_bf16 v[36:39], v[176:179], v[144:147], v[36:39]
    v_mfma_f32_16x16x32_bf16 v[40:43], v[160:163], v[148:151], v[40:43]
    v_mfma_f32_16x16x32_bf16 v[44:47], v[164:167], v[148:151], v[44:47]
    v_mfma_f32_16x16x32_bf16 v[48:51], v[168:171], v[148:151], v[48:51]
    s_waitcnt lgkmcnt(0)
    s_barrier
    ds_read_b128 v[200:203], v193
    ds_read_b128 v[204:207], v193 offset:1024
    ds_read_b128 v[208:211], v193 offset:2048
    ds_read_b128 v[212:215], v193 offset:3072
    ds_read_b128 v[216:219], v193 offset:4096
    ds_read_b128 v[220:223], v193 offset:5120
    ds_read_b128 v[224:227], v193 offset:6144
    ds_read_b128 v[228:231], v193 offset:7168
    ds_read_b128 v[232:235], v193 offset:8192
    ds_read_b128 v[236:239], v193 offset:9216
    ds_read_b128 v[240:243], v193 offset:10240
    ds_read_b128 v[244:247], v193 offset:11264
    ds_read_b128 v[248:251], v193 offset:12288
    s_waitcnt lgkmcnt(12)
    v_pk_add_f32 v[0:1], v[0:1], v[200:201]
    v_pk_add_f32 v[2:3], v[2:3], v[202:203]
    v_cvt_pk_bf16_f32 v100, v0, v1
    v_cvt_pk_bf16_f32 v101, v2, v3
    s_waitcnt lgkmcnt(11)
    v_pk_add_f32 v[4:5], v[4:5], v[204:205]
    v_pk_add_f32 v[6:7], v[6:7], v[206:207]
    v_cvt_pk_bf16_f32 v102, v4, v5
    v_cvt_pk_bf16_f32 v103, v6, v7
    s_cbranch_vccz L_slow25
    buffer_store_dwordx4 v[100:103], v196, s[24:27], s60 offen
L_slowb25:
    s_waitcnt lgkmcnt(10)
    v_pk_add_f32 v[8:9], v[8:9], v[208:209]
    v_pk_add_f32 v[10:11], v[10:11], v[210:211]
    v_cvt_pk_bf16_f32 v104, v8, v9
    v_cvt_pk_bf16_f32 v105, v10, v11
    s_waitcnt lgkmcnt(9)
    v_pk_add_f32 v[12:13], v[12:13], v[212:213]
    v_pk_add_f32 v[14:15], v[14:15], v[214:215]
    v_cvt_pk_bf16_f32 v106, v12, v13
    v_cvt_pk_bf16_f32 v107, v14, v15
    s_cbranch_vccz L_slow26
    buffer_store_dwordx4 v[104:107], v196, s[24:27], s60 offen offset:1024
L_slowb26:
    s_waitcnt lgkmcnt(8)
    v_pk_add_f32 v[16:17], v[16:17], v[216:217]
    v_pk_add_f32 v[18:19], v[18:19], v[218:219]
    v_cvt_pk_bf16_f32 v108, v16, v17
    v_cvt_pk_bf16_f32 v109, v18, v19
    s_waitcnt lgkmcnt(7)
    v_pk_add_f32 v[20:21], v[20:21], v[220:221]
    v_pk_add_f32 v[22:23], v[22:23], v[222:223]
    v_cvt_pk_bf16_f32 v110, v20, v21
    v_cvt_pk_bf16_f32 v111, v22, v23
    s_cbranch_vccz L_slow27
    buffer_store_dwordx4 v[108:111], v196, s[24:27], s60 offen offset:2048
L_slowb27:
    s_waitcnt lgkmcnt(6)
    v_pk_add_f32 v[24:25], v[24:25], v[224:225]
    v_pk_add_f32 v[26:27], v[26:27], v[226:227]
    v_cvt_pk_bf16_f32 v112, v24, v25
    v_cvt_pk_bf16_f32 v113, v26, v27
    s_cbranch_vccz L_slow28
    buffer_store_dwordx4 v[112:115], v196, s[24:27], s60 offen offset:3072
L_slowb28:
    s_waitcnt lgkmcnt(5)
    v_pk_add_f32 v[28:29], v[28:29], v[228:229]
    v_pk_add_f32 v[30:31], v[30:31], v[230:231]
    s_waitcnt lgkmcnt(4)
    v_pk_add_f32 v[32:33], v[32:33], v[232:233]
    v_pk_add_f32 v[34:35], v[34:35], v[234:235]
    s_waitcnt lgkmcnt(3)
    v_pk_add_f32 v[36:37], v[36:37], v[236:237]
    v_pk_add_f32 v[38:39], v[38:39], v[238:239]
    s_waitcnt lgkmcnt(2)
    v_pk_add_f32 v[40:41], v[40:41], v[240:241]
    v_pk_add_f32 v[42:43], v[42:43], v[242:243]
    s_waitcnt lgkmcnt(1)
    v_pk_add_f32 v[44:45], v[44:45], v[244:245]
    v_pk_add_f32 v[46:47], v[46:47], v[246:247]
    s_waitcnt lgkmcnt(0)
    v_pk_add_f32 v[48:49], v[48:49], v[248:249]
    v_pk_add_f32 v[50:51], v[50:51], v[250:251]
    v_mov_b32 v198, 1
    v_mov_b32 v188, 4096
    s_waitcnt vmcnt(0)
    s_mov_b64 exec, 1
    s_cbranch_vccz L_slow29
    buffer_store_dword v198, v188, s[24:27], s60 offen
L_slowb29:
L_x1:
    buffer_load_dword v187, v188, s[24:27], s61 offen sc1
    s_sub_u32 s49, s49, 1
    s_cmp_lt_i32 s49, 0
    s_cbranch_scc1 L_x1_ok
    s_waitcnt vmcnt(0)
    v_readfirstlane_b32 s54, v187
    s_nop 0
    s_cmp_eq_u32 s54, 1
    s_cbranch_scc1 L_x1_ok
    s_sleep 2
    s_branch L_x1
L_x1_ok:
    s_mov_b64 exec, -1
    s_cbranch_vccz L_xl1
    buffer_load_dwordx4 v[200:203], v196, s[24:27], s61 offen
    buffer_load_dwordx4 v[204:207], v196, s[24:27], s61 offen offset:1024
    buffer_load_dwordx4 v[208:211], v196, s[24:27], s61 offen offset:2048
L_xl1_b:
    s_waitcnt vmcnt(0)
    v_lshlrev_b32 v216, 16, v200
    v_and_b32 v217, 0xffff0000, v200
    v_lshlrev_b32 v218, 16, v201
    v_and_b32 v219, 0xffff0000, v201
    v_pk_add_f32 v[28:29], v[28:29], v[216:217]
    v_pk_add_f32 v[30:31], v[30:31], v[218:219]
    v_cvt_pk_bf16_f32 v28, v28, v29
    v_cvt_pk_bf16_f32 v29, v30, v31
    v_lshlrev_b32 v216, 16, v202
    v_and_b32 v217, 0xffff0000, v202
    v_lshlrev_b32 v218, 16, v203
    v_and_b32 v219, 0xffff0000, v203
    v_pk_add_f32 v[32:33], v[32:33], v[216:217]
    v_pk_add_f32 v[34:35], v[34:35], v[218:219]
    v_cvt_pk_bf16_f32 v30, v32, v33
    v_cvt_pk_bf16_f32 v31, v34, v35
    s_add_u32 s41, s62, 20480
    v_permlane16_swap_b32 v28, v30
    v_permlane16_swap_b32 v29, v31
    buffer_store_dwordx4 v[28:31], v199, s[76:79], s41 offen offset:64
    v_lshlrev_b32 v216, 16, v204
    v_and_b32 v217, 0xffff0000, v204
    v_lshlrev_b32 v218, 16, v205
    v_and_b32 v219, 0xffff0000, v205
    v_pk_add_f32 v[36:37], v[36:37], v[216:217]
    v_pk_add_f32 v[38:39], v[38:39], v[218:219]
    v_cvt_pk_bf16_f32 v36, v36, v37
    v_cvt_pk_bf16_f32 v37, v38, v39
    s_add_u32 s41, s62, 20480
    buffer_store_dwordx2 v[36:37], v194, s[76:79], s41 offen offset:128
    v_lshlrev_b32 v216, 16, v206
    v_and_b32 v217, 0xffff0000, v206
    v_lshlrev_b32 v218, 16, v207
    v_and_b32 v219, 0xffff0000, v207
    v_pk_add_f32 v[40:41], v[40:41], v[216:217]
    v_pk_add_f32 v[42:43], v[42:43], v[218:219]
    v_cvt_pk_bf16_f32 v40, v40, v41
    v_cvt_pk_bf16_f32 v41, v42, v43
    v_lshlrev_b32 v216, 16, v208
    v_and_b32 v217, 0xffff0000, v208
    v_lshlrev_b32 v218, 16, v209
    v_and_b32 v219, 0xffff0000, v209
    v_pk_add_f32 v[44:45], v[44:45], v[216:217]
    v_pk_add_f32 v[46:47], v[46:47], v[218:219]
    v_cvt_pk_bf16_f32 v42, v44, v45
    v_cvt_pk_bf16_f32 v43, v46, v47
    s_add_u32 s41, s62, 40960
    v_permlane16_swap_b32 v40, v42
    v_permlane16_swap_b32 v41, v43
    buffer_store_dwordx4 v[40:43], v199, s[76:79], s41 offen
    v_lshlrev_b32 v216, 16, v210
    v_and_b32 v217, 0xffff0000, v210
    v_lshlrev_b32 v218, 16, v211
    v_and_b32 v219, 0xffff0000, v211
    v_pk_add_f32 v[48:49], v[48:49], v[216:217]
    v_pk_add_f32 v[50:51], v[50:51], v[218:219]
    v_cvt_pk_bf16_f32 v48, v48, v49
    v_cvt_pk_bf16_f32 v49, v50, v51
    s_add_u32 s41, s62, 40960
    buffer_store_dwordx2 v[48:49], v194, s[76:79], s41 offen offset:64
    s_endpgm
L_o_epi2:
    v_mfma_f32_16x16x32_bf16 v[0:3], v[160:163], v[140:143], v[0:3]
    v_mfma_f32_16x16x32_bf16 v[4:7], v[164:167], v[140:143], v[4:7]
    v_mfma_f32_16x16x32_bf16 v[8:11], v[168:171], v[140:143], v[8:11]
    v_mfma_f32_16x16x32_bf16 v[12:15], v[172:175], v[140:143], v[12:15]
    v_mfma_f32_16x16x32_bf16 v[16:19], v[176:179], v[140:143], v[16:19]
    s_nop 3
    ds_write_b128 v192, v[0:3]
    v_mfma_f32_16x16x32_bf16 v[20:23], v[160:163], v[144:147], v[20:23]
    ds_write_b128 v192, v[4:7] offset:1024
    v_mfma_f32_16x16x32_bf16 v[24:27], v[164:167], v[144:147], v[24:27]
    ds_write_b128 v192, v[8:11] offset:2048
    v_mfma_f32_16x16x32_bf16 v[28:31], v[168:171], v[144:147], v[28:31]
    ds_write_b128 v192, v[12:15] offset:3072
    v_mfma_f32_16x16x32_bf16 v[32:35], v[172:175], v[144:147], v[32:35]
    ds_write_b128 v192, v[16:19] offset:4096
    v_mfma_f32_16x16x32_bf16 v[36:39], v[176:179], v[144:147], v[36:39]
    ds_write_b128 v192, v[20:23] offset:5120
    v_mfma_f32_16x16x32_bf16 v[40:43], v[160:163], v[148:151], v[40:43]
    ds_write_b128 v192, v[24:27] offset:6144
    v_mfma_f32_16x16x32_bf16 v[44:47], v[164:167], v[148:151], v[44:47]
    v_mfma_f32_16x16x32_bf16 v[48:51], v[168:171], v[148:151], v[48:51]
    ds_write_b128 v192, v[28:31] offset:7168
    v_mfma_f32_16x16x32_bf16 v[76:79], v[176:179], v[152:155], v[76:79]
    ds_write_b128 v192, v[32:35] offset:8192
    v_mfma_f32_16x16x32_bf16 v[80:83], v[160:163], v[156:159], v[80:83]
    ds_write_b128 v192, v[36:39] offset:9216
    v_mfma_f32_16x16x32_bf16 v[84:87], v[164:167], v[156:159], v[84:87]
    ds_write_b128 v192, v[40:43] offset:10240
    v_mfma_f32_16x16x32_bf16 v[88:91], v[168:171], v[156:159], v[88:91]
    ds_write_b128 v192, v[44:47] offset:11264
    v_mfma_f32_16x16x32_bf16 v[92:95], v[172:175], v[156:159], v[92:95]
    ds_write_b128 v192, v[48:51] offset:12288
    v_mfma_f32_16x16x32_bf16 v[96:99], v[176:179], v[156:159], v[96:99]
    v_mfma_f32_16x16x32_bf16 v[52:55], v[172:175], v[148:151], v[52:55]
    v_mfma_f32_16x16x32_bf16 v[56:59], v[176:179], v[148:151], v[56:59]
    v_mfma_f32_16x16x32_bf16 v[60:63], v[160:163], v[152:155], v[60:63]
    v_mfma_f32_16x16x32_bf16 v[64:67], v[164:167], v[152:155], v[64:67]
    v_mfma_f32_16x16x32_bf16 v[68:71], v[168:171], v[152:155], v[68:71]
    v_mfma_f32_16x16x32_bf16 v[72:75], v[172:175], v[152:155], v[72:75]
    s_waitcnt lgkmcnt(0)
    s_barrier
    ds_read_b128 v[200:203], v193 offset:6144
    ds_read_b128 v[204:207], v193 offset:7168
    ds_read_b128 v[208:211], v193 offset:8192
    ds_read_b128 v[212:215], v193 offset:9216
    ds_read_b128 v[216:219], v193 offset:10240
    ds_read_b128 v[220:223], v193 offset:11264
    ds_read_b128 v[224:227], v193
    ds_read_b128 v[228:231], v193 offset:1024
    ds_read_b128 v[232:235], v193 offset:2048
    ds_read_b128 v[236:239], v193 offset:3072
    ds_read_b128 v[240:243], v193 offset:4096
    ds_read_b128 v[244:247], v193 offset:5120
    s_waitcnt lgkmcnt(11)
    v_pk_add_f32 v[76:77], v[76:77], v[200:201]
    v_pk_add_f32 v[78:79], v[78:79], v[202:203]
    v_cvt_pk_bf16_f32 v100, v76, v77
    v_cvt_pk_bf16_f32 v101, v78, v79
    s_waitcnt lgkmcnt(10)
    v_pk_add_f32 v[80:81], v[80:81], v[204:205]
    v_pk_add_f32 v[82:83], v[82:83], v[206:207]
    v_cvt_pk_bf16_f32 v102, v80, v81
    v_cvt_pk_bf16_f32 v103, v82, v83
    s_cbranch_vccz L_slow31
    buffer_store_dwordx4 v[100:103], v196, s[24:27], s60 offen
L_slowb31:
    s_waitcnt lgkmcnt(9)
    v_pk_add_f32 v[84:85], v[84:85], v[208:209]
    v_pk_add_f32 v[86:87], v[86:87], v[210:211]
    v_cvt_pk_bf16_f32 v104, v84, v85
    v_cvt_pk_bf16_f32 v105, v86, v87
    s_waitcnt lgkmcnt(8)
    v_pk_add_f32 v[88:89], v[88:89], v[212:213]
    v_pk_add_f32 v[90:91], v[90:91], v[214:215]
    v_cvt_pk_bf16_f32 v106, v88, v89
    v_cvt_pk_bf16_f32 v107, v90, v91
    s_cbranch_vccz L_slow32
    buffer_store_dwordx4 v[104:107], v196, s[24:27], s60 offen offset:1024
L_slowb32:
    s_waitcnt lgkmcnt(7)
    v_pk_add_f32 v[92:93], v[92:93], v[216:217]
    v_pk_add_f32 v[94:95], v[94:95], v[218:219]
    v_cvt_pk_bf16_f32 v108, v92, v93
    v_cvt_pk_bf16_f32 v109, v94, v95
    s_waitcnt lgkmcnt(6)
    v_pk_add_f32 v[96:97], v[96:97], v[220:221]
    v_pk_add_f32 v[98:99], v[98:99], v[222:223]
    v_cvt_pk_bf16_f32 v110, v96, v97
    v_cvt_pk_bf16_f32 v111, v98, v99
    s_cbranch_vccz L_slow33
    buffer_store_dwordx4 v[108:111], v196, s[24:27], s60 offen offset:2048
L_slowb33:
    s_waitcnt lgkmcnt(5)
    v_pk_add_f32 v[52:53], v[52:53], v[224:225]
    v_pk_add_f32 v[54:55], v[54:55], v[226:227]
    s_waitcnt lgkmcnt(4)
    v_pk_add_f32 v[56:57], v[56:57], v[228:229]
    v_pk_add_f32 v[58:59], v[58:59], v[230:231]
    s_waitcnt lgkmcnt(3)
    v_pk_add_f32 v[60:61], v[60:61], v[232:233]
    v_pk_add_f32 v[62:63], v[62:63], v[234:235]
    s_waitcnt lgkmcnt(2)
    v_pk_add_f32 v[64:65], v[64:65], v[236:237]
    v_pk_add_f32 v[66:67], v[66:67], v[238:239]
    s_waitcnt lgkmcnt(1)
    v_pk_add_f32 v[68:69], v[68:69], v[240:241]
    v_pk_add_f32 v[70:71], v[70:71], v[242:243]
    s_waitcnt lgkmcnt(0)
    v_pk_add_f32 v[72:73], v[72:73], v[244:245]
    v_pk_add_f32 v[74:75], v[74:75], v[246:247]
    v_mov_b32 v198, 1
    v_mov_b32 v188, 4096
    s_waitcnt vmcnt(0)
    s_mov_b64 exec, 1
    s_cbranch_vccz L_slow34
    buffer_store_dword v198, v188, s[24:27], s60 offen
L_slowb34:
L_x2:
    buffer_load_dword v187, v188, s[24:27], s61 offen sc1
    s_sub_u32 s49, s49, 1
    s_cmp_lt_i32 s49, 0
    s_cbranch_scc1 L_x2_ok
    s_waitcnt vmcnt(0)
    v_readfirstlane_b32 s54, v187
    s_nop 0
    s_cmp_eq_u32 s54, 1
    s_cbranch_scc1 L_x2_ok
    s_sleep 2
    s_branch L_x2
L_x2_ok:
    s_mov_b64 exec, -1
    s_cbranch_vccz L_xl2
    buffer_load_dwordx4 v[200:203], v196, s[24:27], s61 offen
    buffer_load_dwordx4 v[204:207], v196, s[24:27], s61 offen offset:1024
    buffer_load_dwordx4 v[208:211], v196, s[24:27], s61 offen offset:2048
L_xl2_b:
    s_waitcnt vmcnt(0)
    v_lshlrev_b32 v216, 16, v200
    v_and_b32 v217, 0xffff0000, v200
    v_lshlrev_b32 v218, 16, v201
    v_and_b32 v219, 0xffff0000, v201
    v_pk_add_f32 v[52:53], v[52:53], v[216:217]
    v_pk_add_f32 v[54:55], v[54:55], v[218:219]
    v_cvt_pk_bf16_f32 v52, v52, v53
    v_cvt_pk_bf16_f32 v53, v54, v55
    v_lshlrev_b32 v216, 16, v202
    v_and_b32 v217, 0xffff0000, v202
    v_lshlrev_b32 v218, 16, v203
    v_and_b32 v219, 0xffff0000, v203
    v_pk_add_f32 v[56:57], v[56:57], v[216:217]
    v_pk_add_f32 v[58:59], v[58:59], v[218:219]
    v_cvt_pk_bf16_f32 v54, v56, v57
    v_cvt_pk_bf16_f32 v55, v58, v59
    s_add_u32 s41, s62, 40960
    v_permlane16_swap_b32 v52, v54
    v_permlane16_swap_b32 v53, v55
    buffer_store_dwordx4 v[52:55], v199, s[76:79], s41 offen offset:96
    v_lshlrev_b32 v216, 16, v204
    v_and_b32 v217, 0xffff0000, v204
    v_lshlrev_b32 v218, 16, v205
    v_and_b32 v219, 0xffff0000, v205
    v_pk_add_f32 v[60:61], v[60:61], v[216:217]
    v_pk_add_f32 v[62:63], v[62:63], v[218:219]
    v_cvt_pk_bf16_f32 v60, v60, v61
    v_cvt_pk_bf16_f32 v61, v62, v63
    v_lshlrev_b32 v216, 16, v206
    v_and_b32 v217, 0xffff0000, v206
    v_lshlrev_b32 v218, 16, v207
    v_and_b32 v219, 0xffff0000, v207
    v_pk_add_f32 v[64:65], v[64:65], v[216:217]
    v_pk_add_f32 v[66:67], v[66:67], v[218:219]
    v_cvt_pk_bf16_f32 v62, v64, v65
    v_cvt_pk_bf16_f32 v63, v66, v67
    s_add_u32 s41, s62, 61440
    v_permlane16_swap_b32 v60, v62
    v_permlane16_swap_b32 v61, v63
    buffer_store_dwordx4 v[60:63], v199, s[76:79], s41 offen
    v_lshlrev_b32 v216, 16, v208
    v_and_b32 v217, 0xffff0000, v208
    v_lshlrev_b32 v218, 16, v209
    v_and_b32 v219, 0xffff0000, v209
    v_pk_add_f32 v[68:69], v[68:69], v[216:217]
    v_pk_add_f32 v[70:71], v[70:71], v[218:219]
    v_cvt_pk_bf16_f32 v68, v68, v69
    v_cvt_pk_bf16_f32 v69, v70, v71
    v_lshlrev_b32 v216, 16, v210
    v_and_b32 v217, 0xffff0000, v210
    v_lshlrev_b32 v218, 16, v211
    v_and_b32 v219, 0xffff0000, v211
    v_pk_add_f32 v[72:73], v[72:73], v[216:217]
    v_pk_add_f32 v[74:75], v[74:75], v[218:219]
    v_cvt_pk_bf16_f32 v70, v72, v73
    v_cvt_pk_bf16_f32 v71, v74, v75
    s_add_u32 s41, s62, 61440
    v_permlane16_swap_b32 v68, v70
    v_permlane16_swap_b32 v69, v71
    buffer_store_dwordx4 v[68:71], v199, s[76:79], s41 offen offset:64
    s_endpgm
L_o_epi3:
    v_mfma_f32_16x16x32_bf16 v[0:3], v[160:163], v[140:143], v[0:3]
    v_mfma_f32_16x16x32_bf16 v[4:7], v[164:167], v[140:143], v[4:7]
    v_mfma_f32_16x16x32_bf16 v[8:11], v[168:171], v[140:143], v[8:11]
    v_mfma_f32_16x16x32_bf16 v[12:15], v[172:175], v[140:143], v[12:15]
    v_mfma_f32_16x16x32_bf16 v[16:19], v[176:179], v[140:143], v[16:19]
    s_nop 3
    ds_write_b128 v192, v[0:3]
    v_mfma_f32_16x16x32_bf16 v[20:23], v[160:163], v[144:147], v[20:23]
    ds_write_b128 v192, v[4:7] offset:1024
    v_mfma_f32_16x16x32_bf16 v[24:27], v[164:167], v[144:147], v[24:27]
    ds_write_b128 v192, v[8:11] offset:2048
    v_mfma_f32_16x16x32_bf16 v[28:31], v[168:171], v[144:147], v[28:31]
    ds_write_b128 v192, v[12:15] offset:3072
    v_mfma_f32_16x16x32_bf16 v[32:35], v[172:175], v[144:147], v[32:35]
    ds_write_b128 v192, v[16:19] offset:4096
    v_mfma_f32_16x16x32_bf16 v[36:39], v[176:179], v[144:147], v[36:39]
    ds_write_b128 v192, v[20:23] offset:5120
    v_mfma_f32_16x16x32_bf16 v[40:43], v[160:163], v[148:151], v[40:43]
    ds_write_b128 v192, v[24:27] offset:6144
    v_mfma_f32_16x16x32_bf16 v[44:47], v[164:167], v[148:151], v[44:47]
    v_mfma_f32_16x16x32_bf16 v[48:51], v[168:171], v[148:151], v[48:51]
    ds_write_b128 v192, v[28:31] offset:7168
    v_mfma_f32_16x16x32_bf16 v[52:55], v[172:175], v[148:151], v[52:55]
    ds_write_b128 v192, v[32:35] offset:8192
    v_mfma_f32_16x16x32_bf16 v[56:59], v[176:179], v[148:151], v[56:59]
    ds_write_b128 v192, v[36:39] offset:9216
    v_mfma_f32_16x16x32_bf16 v[60:63], v[160:163], v[152:155], v[60:63]
    ds_write_b128 v192, v[40:43] offset:10240
    v_mfma_f32_16x16x32_bf16 v[64:67], v[164:167], v[152:155], v[64:67]
    ds_write_b128 v192, v[44:47] offset:11264
    v_mfma_f32_16x16x32_bf16 v[68:71], v[168:171], v[152:155], v[68:71]
    ds_write_b128 v192, v[48:51] offset:12288
    v_mfma_f32_16x16x32_bf16 v[72:75], v[172:175], v[152:155], v[72:75]
    v_mfma_f32_16x16x32_bf16 v[76:79], v[176:179], v[152:155], v[76:79]
    v_mfma_f32_16x16x32_bf16 v[80:83], v[160:163], v[156:159], v[80:83]
    v_mfma_f32_16x16x32_bf16 v[84:87], v[164:167], v[156:159], v[84:87]
    v_mfma_f32_16x16x32_bf16 v[88:91], v[168:171], v[156:159], v[88:91]
    v_mfma_f32_16x16x32_bf16 v[92:95], v[172:175], v[156:159], v[92:95]
    v_mfma_f32_16x16x32_bf16 v[96:99], v[176:179], v[156:159], v[96:99]
    s_waitcnt lgkmcnt(0)
    s_barrier
    ds_read_b128 v[200:203], v193
    ds_read_b128 v[204:207], v193 offset:1024
    ds_read_b128 v[208:211], v193 offset:2048
    ds_read_b128 v[212:215], v193 offset:3072
    ds_read_b128 v[216:219], v193 offset:4096
    ds_read_b128 v[220:223], v193 offset:5120
    ds_read_b128 v[224:227], v193 offset:6144
    ds_read_b128 v[228:231], v193 offset:7168
    ds_read_b128 v[232:235], v193 offset:8192
    ds_read_b128 v[236:239], v193 offset:9216
    ds_read_b128 v[240:243], v193 offset:10240
    ds_read_b128 v[244:247], v193 offset:11264
    s_waitcnt lgkmcnt(11)
    v_pk_add_f32 v[52:53], v[52:53], v[200:201]
    v_pk_add_f32 v[54:55], v[54:55], v[202:203]
    v_cvt_pk_bf16_f32 v100, v52, v53
    v_cvt_pk_bf16_f32 v101, v54, v55
    s_waitcnt lgkmcnt(10)
    v_pk_add_f32 v[56:57], v[56:57], v[204:205]
    v_pk_add_f32 v[58:59], v[58:59], v[206:207]
    v_cvt_pk_bf16_f32 v102, v56, v57
    v_cvt_pk_bf16_f32 v103, v58, v59
    s_cbranch_vccz L_slow36
    buffer_store_dwordx4 v[100:103], v196, s[24:27], s60 offen
L_slowb36:
    s_waitcnt lgkmcnt(9)
    v_pk_add_f32 v[60:61], v[60:61], v[208:209]
    v_pk_add_f32 v[62:63], v[62:63], v[210:211]
    v_cvt_pk_bf16_f32 v104, v60, v61
    v_cvt_pk_bf16_f32 v105, v62, v63
    s_waitcnt lgkmcnt(8)
    v_pk_add_f32 v[64:65], v[64:65], v[212:213]
    v_pk_add_f32 v[66:67], v[66:67], v[214:215]
    v_cvt_pk_bf16_f32 v106, v64, v65
    v_cvt_pk_bf16_f32 v107, v66, v67
    s_cbranch_vccz L_slow37
    buffer_store_dwordx4 v[104:107], v196, s[24:27], s60 offen offset:1024
L_slowb37:
    s_waitcnt lgkmcnt(7)
    v_pk_add_f32 v[68:69], v[68:69], v[216:217]
    v_pk_add_f32 v[70:71], v[70:71], v[218:219]
    v_cvt_pk_bf16_f32 v108, v68, v69
    v_cvt_pk_bf16_f32 v109, v70, v71
    s_waitcnt lgkmcnt(6)
    v_pk_add_f32 v[72:73], v[72:73], v[220:221]
    v_pk_add_f32 v[74:75], v[74:75], v[222:223]
    v_cvt_pk_bf16_f32 v110, v72, v73
    v_cvt_pk_bf16_f32 v111, v74, v75
    s_cbranch_vccz L_slow38
    buffer_store_dwordx4 v[108:111], v196, s[24:27], s60 offen offset:2048
L_slowb38:
    s_waitcnt lgkmcnt(5)
    v_pk_add_f32 v[76:77], v[76:77], v[224:225]
    v_pk_add_f32 v[78:79], v[78:79], v[226:227]
    s_waitcnt lgkmcnt(4)
    v_pk_add_f32 v[80:81], v[80:81], v[228:229]
    v_pk_add_f32 v[82:83], v[82:83], v[230:231]
    s_waitcnt lgkmcnt(3)
    v_pk_add_f32 v[84:85], v[84:85], v[232:233]
    v_pk_add_f32 v[86:87], v[86:87], v[234:235]
    s_waitcnt lgkmcnt(2)
    v_pk_add_f32 v[88:89], v[88:89], v[236:237]
    v_pk_add_f32 v[90:91], v[90:91], v[238:239]
    s_waitcnt lgkmcnt(1)
    v_pk_add_f32 v[92:93], v[92:93], v[240:241]
    v_pk_add_f32 v[94:95], v[94:95], v[242:243]
    s_waitcnt lgkmcnt(0)
    v_pk_add_f32 v[96:97], v[96:97], v[244:245]
    v_pk_add_f32 v[98:99], v[98:99], v[246:247]
    v_mov_b32 v198, 1
    v_mov_b32 v188, 4096
    s_waitcnt vmcnt(0)
    s_mov_b64 exec, 1
    s_cbranch_vccz L_slow39
    buffer_store_dword v198, v188, s[24:27], s60 offen
L_slowb39:
L_x3:
    buffer_load_dword v187, v188, s[24:27], s61 offen sc1
    s_sub_u32 s49, s49, 1
    s_cmp_lt_i32 s49, 0
    s_cbranch_scc1 L_x3_ok
    s_waitcnt vmcnt(0)
    v_readfirstlane_b32 s54, v187
    s_nop 0
    s_cmp_eq_u32 s54, 1
    s_cbranch_scc1 L_x3_ok
    s_sleep 2
    s_branch L_x3
L_x3_ok:
    s_mov_b64 exec, -1
    s_cbranch_vccz L_xl3
    buffer_load_dwordx4 v[200:203], v196, s[24:27], s61 offen
    buffer_load_dwordx4 v[204:207], v196, s[24:27], s61 offen offset:1024
    buffer_load_dwordx4 v[208:211], v196, s[24:27], s61 offen offset:2048
L_xl3_b:
    s_waitcnt vmcnt(0)
    v_lshlrev_b32 v216, 16, v200
    v_and_b32 v217, 0xffff0000, v200
    v_lshlrev_b32 v218, 16, v201
    v_and_b32 v219, 0xffff0000, v201
    v_pk_add_f32 v[76:77], v[76:77], v[216:217]
    v_pk_add_f32 v[78:79], v[78:79], v[218:219]
    v_cvt_pk_bf16_f32 v76, v76, v77
    v_cvt_pk_bf16_f32 v77, v78, v79
    s_add_u32 s41, s62, 61440
    buffer_store_dwordx2 v[76:77], v194, s[76:79], s41 offen offset:128
    v_lshlrev_b32 v216, 16, v202
    v_and_b32 v217, 0xffff0000, v202
    v_lshlrev_b32 v218, 16, v203
    v_and_b32 v219, 0xffff0000, v203
    v_pk_add_f32 v[80:81], v[80:81], v[216:217]
    v_pk_add_f32 v[82:83], v[82:83], v[218:219]
    v_cvt_pk_bf16_f32 v80, v80, v81
    v_cvt_pk_bf16_f32 v81, v82, v83
    v_lshlrev_b32 v216, 16, v204
    v_and_b32 v217, 0xffff0000, v204
    v_lshlrev_b32 v218, 16, v205
    v_and_b32 v219, 0xffff0000, v205
    v_pk_add_f32 v[84:85], v[84:85], v[216:217]
    v_pk_add_f32 v[86:87], v[86:87], v[218:219]
    v_cvt_pk_bf16_f32 v82, v84, v85
    v_cvt_pk_bf16_f32 v83, v86, v87
    s_add_u32 s41, s62, 81920
    v_permlane16_swap_b32 v80, v82
    v_permlane16_swap_b32 v81, v83
    buffer_store_dwordx4 v[80:83], v199, s[76:79], s41 offen
    v_lshlrev_b32 v216, 16, v206
    v_and_b32 v217, 0xffff0000, v206
    v_lshlrev_b32 v218, 16, v207
    v_and_b32 v219, 0xffff0000, v207
    v_pk_add_f32 v[88:89], v[88:89], v[216:217]
    v_pk_add_f32 v[90:91], v[90:91], v[218:219]
    v_cvt_pk_bf16_f32 v88, v88, v89
    v_cvt_pk_bf16_f32 v89, v90, v91
    v_lshlrev_b32 v216, 16, v208
    v_and_b32 v217, 0xffff0000, v208
    v_lshlrev_b32 v218, 16, v209
    v_and_b32 v219, 0xffff0000, v209
    v_pk_add_f32 v[92:93], v[92:93], v[216:217]
    v_pk_add_f32 v[94:95], v[94:95], v[218:219]
    v_cvt_pk_bf16_f32 v90, v92, v93
    v_cvt_pk_bf16_f32 v91, v94, v95
    s_add_u32 s41, s62, 81920
    v_permlane16_swap_b32 v88, v90
    v_permlane16_swap_b32 v89, v91
    buffer_store_dwordx4 v[88:91], v199, s[76:79], s41 offen offset:64
    v_lshlrev_b32 v216, 16, v210
    v_and_b32 v217, 0xffff0000, v210
    v_lshlrev_b32 v218, 16, v211
    v_and_b32 v219, 0xffff0000, v211
    v_pk_add_f32 v[96:97], v[96:97], v[216:217]
    v_pk_add_f32 v[98:99], v[98:99], v[218:219]
    v_cvt_pk_bf16_f32 v96, v96, v97
    v_cvt_pk_bf16_f32 v97, v98, v99
    s_add_u32 s41, s62, 81920
    buffer_store_dwordx2 v[96:97], v194, s[76:79], s41 offen offset:128
    s_endpgm
KEND:
L_rare_w2_0:
    s_nop 15
    v_max3_f32 v138, v104, v105, v106
    v_max3_f32 v138, v138, v107, v112
    v_max3_f32 v138, v138, v113, v114
    v_max_f32 v138, v138, v115
    v_mov_b32 v140, v138
    s_nop 1
    v_permlane32_swap_b32 v138, v140
    v_max_f32 v138, v138, v140
    v_mov_b32 v140, v138
    s_nop 1
    v_permlane16_swap_b32 v138, v140
    v_max_f32 v138, v138, v140
    v_max_f32 v138, 0, v138
    v_sub_f32 v141, 0, v138
    v_exp_f32 v141, v141
    v_sub_f32 v96, v96, v138
    v_sub_f32 v97, v97, v138
    v_sub_f32 v98, v98, v138
    v_sub_f32 v99, v99, v138
    v_sub_f32 v104, v104, v138
    v_sub_f32 v105, v105, v138
    v_sub_f32 v106, v106, v138
    v_sub_f32 v107, v107, v138
    v_sub_f32 v112, v112, v138
    v_sub_f32 v113, v113, v138
    v_sub_f32 v114, v114, v138
    v_sub_f32 v115, v115, v138
    v_mul_f32 v136, v136, v141
    v_mul_f32 v0, v0, v141
    v_mul_f32 v1, v1, v141
    v_mul_f32 v2, v2, v141
    v_mul_f32 v3, v3, v141
    v_mul_f32 v8, v8, v141
    v_mul_f32 v9, v9, v141
    v_mul_f32 v10, v10, v141
    v_mul_f32 v11, v11, v141
    v_mul_f32 v16, v16, v141
    v_mul_f32 v17, v17, v141
    v_mul_f32 v18, v18, v141
    v_mul_f32 v19, v19, v141
    v_mul_f32 v24, v24, v141
    v_mul_f32 v25, v25, v141
    v_mul_f32 v26, v26, v141
    v_mul_f32 v27, v27, v141
    v_mul_f32 v32, v32, v141
    v_mul_f32 v33, v33, v141
    v_mul_f32 v34, v34, v141
    v_mul_f32 v35, v35, v141
    v_mul_f32 v40, v40, v141
    v_mul_f32 v41, v41, v141
    v_mul_f32 v42, v42, v141
    v_mul_f32 v43, v43, v141
    v_mul_f32 v48, v48, v141
    v_mul_f32 v49, v49, v141
    v_mul_f32 v50, v50, v141
    v_mul_f32 v51, v51, v141
    v_mul_f32 v56, v56, v141
    v_mul_f32 v57, v57, v141
    v_mul_f32 v58, v58, v141
    v_mul_f32 v59, v59, v141
    v_max3_f32 v139, v108, v109, v110
    v_max3_f32 v139, v139, v111, v116
    v_max3_f32 v139, v139, v117, v118
    v_max_f32 v139, v139, v119
    v_mov_b32 v140, v139
    s_nop 1
    v_permlane32_swap_b32 v139, v140
    v_max_f32 v139, v139, v140
    v_mov_b32 v140, v139
    s_nop 1
    v_permlane16_swap_b32 v139, v140
    v_max_f32 v139, v139, v140
    v_max_f32 v139, 0, v139
    v_sub_f32 v141, 0, v139
    v_exp_f32 v141, v141
    v_sub_f32 v100, v100, v139
    v_sub_f32 v101, v101, v139
    v_sub_f32 v102, v102, v139
    v_sub_f32 v103, v103, v139
    v_sub_f32 v108, v108, v139
    v_sub_f32 v109, v109, v139
    v_sub_f32 v110, v110, v139
    v_sub_f32 v111, v111, v139
    v_sub_f32 v116, v116, v139
    v_sub_f32 v117, v117, v139
    v_sub_f32 v118, v118, v139
    v_sub_f32 v119, v119, v139
    v_mul_f32 v137, v137, v141
    v_mul_f32 v4, v4, v141
    v_mul_f32 v5, v5, v141
    v_mul_f32 v6, v6, v141
    v_mul_f32 v7, v7, v141
    v_mul_f32 v12, v12, v141
    v_mul_f32 v13, v13, v141
    v_mul_f32 v14, v14, v141
    v_mul_f32 v15, v15, v141
    v_mul_f32 v20, v20, v141
    v_mul_f32 v21, v21, v141
    v_mul_f32 v22, v22, v141
    v_mul_f32 v23, v23, v141
    v_mul_f32 v28, v28, v141
    v_mul_f32 v29, v29, v141
    v_mul_f32 v30, v30, v141
    v_mul_f32 v31, v31, v141
    v_mul_f32 v36, v36, v141
    v_mul_f32 v37, v37, v141
    v_mul_f32 v38, v38, v141
    v_mul_f32 v39, v39, v141
    v_mul_f32 v44, v44, v141
    v_mul_f32 v45, v45, v141
    v_mul_f32 v46, v46, v141
    v_mul_f32 v47, v47, v141
    v_mul_f32 v52, v52, v141
    v_mul_f32 v53, v53, v141
    v_mul_f32 v54, v54, v141
    v_mul_f32 v55, v55, v141
    v_mul_f32 v60, v60, v141
    v_mul_f32 v61, v61, v141
    v_mul_f32 v62, v62, v141
    v_mul_f32 v63, v63, v141
    v_exp_f32 v140, v104
    v_exp_f32 v141, v105
    v_exp_f32 v142, v106
    v_add_f32 v138, v140, v141
    v_cvt_pk_bf16_f32 v120, v140, v141
    v_exp_f32 v143, v107
    v_exp_f32 v140, v108
    v_add_f32 v138, v138, v142
    v_cvt_pk_bf16_f32 v121, v142, v143
    v_add_f32 v138, v138, v143
    v_exp_f32 v141, v109
    v_exp_f32 v142, v110
    v_add_f32 v139, v140, v141
    v_cvt_pk_bf16_f32 v124, v140, v141
    v_exp_f32 v143, v111
    v_exp_f32 v140, v112
    v_add_f32 v139, v139, v142
    v_cvt_pk_bf16_f32 v125, v142, v143
    v_add_f32 v139, v139, v143
    v_exp_f32 v141, v113
    v_exp_f32 v142, v114
    v_add_f32 v138, v138, v140
    v_cvt_pk_bf16_f32 v122, v140, v141
    v_add_f32 v138, v138, v141
    v_exp_f32 v143, v115
    v_exp_f32 v140, v116
    v_add_f32 v138, v138, v142
    v_cvt_pk_bf16_f32 v123, v142, v143
    v_add_f32 v138, v138, v143
    v_exp_f32 v141, v117
    v_exp_f32 v142, v118
    v_add_f32 v139, v139, v140
    v_cvt_pk_bf16_f32 v126, v140, v141
    v_add_f32 v139, v139, v141
    v_exp_f32 v143, v119
    v_add_f32 v139, v139, v142
    v_cvt_pk_bf16_f32 v127, v142, v143
    v_add_f32 v139, v139, v143
    s_nop 3
    s_setpc_b64 s[46:47]
L_rare_w2_1:
    s_nop 15
    v_max3_f32 v138, v104, v105, v106
    v_max3_f32 v138, v138, v107, v112
    v_max3_f32 v138, v138, v113, v114
    v_max_f32 v138, v138, v115
    v_mov_b32 v140, v138
    s_nop 1
    v_permlane32_swap_b32 v138, v140
    v_max_f32 v138, v138, v140
    v_mov_b32 v140, v138
    s_nop 1
    v_permlane16_swap_b32 v138, v140
    v_max_f32 v138, v138, v140
    v_max_f32 v138, 0, v138
    v_sub_f32 v141, 0, v138
    v_exp_f32 v141, v141
    v_sub_f32 v96, v96, v138
    v_sub_f32 v97, v97, v138
    v_sub_f32 v98, v98, v138
    v_sub_f32 v99, v99, v138
    v_sub_f32 v104, v104, v138
    v_sub_f32 v105, v105, v138
    v_sub_f32 v106, v106, v138
    v_sub_f32 v107, v107, v138
    v_sub_f32 v112, v112, v138
    v_sub_f32 v113, v113, v138
    v_sub_f32 v114, v114, v138
    v_sub_f32 v115, v115, v138
    v_mul_f32 v136, v136, v141
    v_mul_f32 v0, v0, v141
    v_mul_f32 v1, v1, v141
    v_mul_f32 v2, v2, v141
    v_mul_f32 v3, v3, v141
    v_mul_f32 v8, v8, v141
    v_mul_f32 v9, v9, v141
    v_mul_f32 v10, v10, v141
    v_mul_f32 v11, v11, v141
    v_mul_f32 v16, v16, v141
    v_mul_f32 v17, v17, v141
    v_mul_f32 v18, v18, v141
    v_mul_f32 v19, v19, v141
    v_mul_f32 v24, v24, v141
    v_mul_f32 v25, v25, v141
    v_mul_f32 v26, v26, v141
    v_mul_f32 v27, v27, v141
    v_mul_f32 v32, v32, v141
    v_mul_f32 v33, v33, v141
    v_mul_f32 v34, v34, v141
    v_mul_f32 v35, v35, v141
    v_mul_f32 v40, v40, v141
    v_mul_f32 v41, v41, v141
    v_mul_f32 v42, v42, v141
    v_mul_f32 v43, v43, v141
    v_mul_f32 v48, v48, v141
    v_mul_f32 v49, v49, v141
    v_mul_f32 v50, v50, v141
    v_mul_f32 v51, v51, v141
    v_mul_f32 v56, v56, v141
    v_mul_f32 v57, v57, v141
    v_mul_f32 v58, v58, v141
    v_mul_f32 v59, v59, v141
    v_max3_f32 v139, v108, v109, v110
    v_max3_f32 v139, v139, v111, v116
    v_max3_f32 v139, v139, v117, v118
    v_max_f32 v139, v139, v119
    v_mov_b32 v140, v139
    s_nop 1
    v_permlane32_swap_b32 v139, v140
    v_max_f32 v139, v139, v140
    v_mov_b32 v140, v139
    s_nop 1
    v_permlane16_swap_b32 v139, v140
    v_max_f32 v139, v139, v140
    v_max_f32 v139, 0, v139
    v_sub_f32 v141, 0, v139
    v_exp_f32 v141, v141
    v_sub_f32 v100, v100, v139
    v_sub_f32 v101, v101, v139
    v_sub_f32 v102, v102, v139
    v_sub_f32 v103, v103, v139
    v_sub_f32 v108, v108, v139
    v_sub_f32 v109, v109, v139
    v_sub_f32 v110, v110, v139
    v_sub_f32 v111, v111, v139
    v_sub_f32 v116, v116, v139
    v_sub_f32 v117, v117, v139
    v_sub_f32 v118, v118, v139
    v_sub_f32 v119, v119, v139
    v_mul_f32 v137, v137, v141
    v_mul_f32 v4, v4, v141
    v_mul_f32 v5, v5, v141
    v_mul_f32 v6, v6, v141
    v_mul_f32 v7, v7, v141
    v_mul_f32 v12, v12, v141
    v_mul_f32 v13, v13, v141
    v_mul_f32 v14, v14, v141
    v_mul_f32 v15, v15, v141
    v_mul_f32 v20, v20, v141
    v_mul_f32 v21, v21, v141
    v_mul_f32 v22, v22, v141
    v_mul_f32 v23, v23, v141
    v_mul_f32 v28, v28, v141
    v_mul_f32 v29, v29, v141
    v_mul_f32 v30, v30, v141
    v_mul_f32 v31, v31, v141
    v_mul_f32 v36, v36, v141
    v_mul_f32 v37, v37, v141
    v_mul_f32 v38, v38, v141
    v_mul_f32 v39, v39, v141
    v_mul_f32 v44, v44, v141
    v_mul_f32 v45, v45, v141
    v_mul_f32 v46, v46, v141
    v_mul_f32 v47, v47, v141
    v_mul_f32 v52, v52, v141
    v_mul_f32 v53, v53, v141
    v_mul_f32 v54, v54, v141
    v_mul_f32 v55, v55, v141
    v_mul_f32 v60, v60, v141
    v_mul_f32 v61, v61, v141
    v_mul_f32 v62, v62, v141
    v_mul_f32 v63, v63, v141
    v_exp_f32 v140, v104
    v_exp_f32 v141, v105
    v_exp_f32 v142, v106
    v_add_f32 v138, v140, v141
    v_cvt_pk_bf16_f32 v128, v140, v141
    v_exp_f32 v143, v107
    v_exp_f32 v140, v108
    v_add_f32 v138, v138, v142
    v_cvt_pk_bf16_f32 v129, v142, v143
    v_add_f32 v138, v138, v143
    v_exp_f32 v141, v109
    v_exp_f32 v142, v110
    v_add_f32 v139, v140, v141
    v_cvt_pk_bf16_f32 v132, v140, v141
    v_exp_f32 v143, v111
    v_exp_f32 v140, v112
    v_add_f32 v139, v139, v142
    v_cvt_pk_bf16_f32 v133, v142, v143
    v_add_f32 v139, v139, v143
    v_exp_f32 v141, v113
    v_exp_f32 v142, v114
    v_add_f32 v138, v138, v140
    v_cvt_pk_bf16_f32 v130, v140, v141
    v_add_f32 v138, v138, v141
    v_exp_f32 v143, v115
    v_exp_f32 v140, v116
    v_add_f32 v138, v138, v142
    v_cvt_pk_bf16_f32 v131, v142, v143
    v_add_f32 v138, v138, v143
    v_exp_f32 v141, v117
    v_exp_f32 v142, v118
    v_add_f32 v139, v139, v140
    v_cvt_pk_bf16_f32 v134, v140, v141
    v_add_f32 v139, v139, v141
    v_exp_f32 v143, v119
    v_add_f32 v139, v139, v142
    v_cvt_pk_bf16_f32 v135, v142, v143
    v_add_f32 v139, v139, v143
    s_nop 3
    s_setpc_b64 s[46:47]
L_rare_w3_0:
    s_nop 15
    v_max3_f32 v207, v156, v157, v158
    v_max3_f32 v207, v207, v159, v168
    v_max3_f32 v207, v207, v169, v170
    v_max_f32 v207, v207, v171
    v_mov_b32 v210, v207
    s_nop 1
    v_permlane32_swap_b32 v207, v210
    v_max_f32 v207, v207, v210
    v_mov_b32 v210, v207
    s_nop 1
    v_permlane16_swap_b32 v207, v210
    v_max_f32 v207, v207, v210
    v_max_f32 v207, 0, v207
    v_sub_f32 v211, 0, v207
    v_exp_f32 v211, v211
    v_sub_f32 v144, v144, v207
    v_sub_f32 v145, v145, v207
    v_sub_f32 v146, v146, v207
    v_sub_f32 v147, v147, v207
    v_sub_f32 v156, v156, v207
    v_sub_f32 v157, v157, v207
    v_sub_f32 v158, v158, v207
    v_sub_f32 v159, v159, v207
    v_sub_f32 v168, v168, v207
    v_sub_f32 v169, v169, v207
    v_sub_f32 v170, v170, v207
    v_sub_f32 v171, v171, v207
    v_mul_f32 v204, v204, v211
    v_mul_f32 v0, v0, v211
    v_mul_f32 v1, v1, v211
    v_mul_f32 v2, v2, v211
    v_mul_f32 v3, v3, v211
    v_mul_f32 v12, v12, v211
    v_mul_f32 v13, v13, v211
    v_mul_f32 v14, v14, v211
    v_mul_f32 v15, v15, v211
    v_mul_f32 v24, v24, v211
    v_mul_f32 v25, v25, v211
    v_mul_f32 v26, v26, v211
    v_mul_f32 v27, v27, v211
    v_mul_f32 v36, v36, v211
    v_mul_f32 v37, v37, v211
    v_mul_f32 v38, v38, v211
    v_mul_f32 v39, v39, v211
    v_mul_f32 v48, v48, v211
    v_mul_f32 v49, v49, v211
    v_mul_f32 v50, v50, v211
    v_mul_f32 v51, v51, v211
    v_mul_f32 v60, v60, v211
    v_mul_f32 v61, v61, v211
    v_mul_f32 v62, v62, v211
    v_mul_f32 v63, v63, v211
    v_mul_f32 v72, v72, v211
    v_mul_f32 v73, v73, v211
    v_mul_f32 v74, v74, v211
    v_mul_f32 v75, v75, v211
    v_mul_f32 v84, v84, v211
    v_mul_f32 v85, v85, v211
    v_mul_f32 v86, v86, v211
    v_mul_f32 v87, v87, v211
    v_max3_f32 v208, v160, v161, v162
    v_max3_f32 v208, v208, v163, v172
    v_max3_f32 v208, v208, v173, v174
    v_max_f32 v208, v208, v175
    v_mov_b32 v210, v208
    s_nop 1
    v_permlane32_swap_b32 v208, v210
    v_max_f32 v208, v208, v210
    v_mov_b32 v210, v208
    s_nop 1
    v_permlane16_swap_b32 v208, v210
    v_max_f32 v208, v208, v210
    v_max_f32 v208, 0, v208
    v_sub_f32 v211, 0, v208
    v_exp_f32 v211, v211
    v_sub_f32 v148, v148, v208
    v_sub_f32 v149, v149, v208
    v_sub_f32 v150, v150, v208
    v_sub_f32 v151, v151, v208
    v_sub_f32 v160, v160, v208
    v_sub_f32 v161, v161, v208
    v_sub_f32 v162, v162, v208
    v_sub_f32 v163, v163, v208
    v_sub_f32 v172, v172, v208
    v_sub_f32 v173, v173, v208
    v_sub_f32 v174, v174, v208
    v_sub_f32 v175, v175, v208
    v_mul_f32 v205, v205, v211
    v_mul_f32 v4, v4, v211
    v_mul_f32 v5, v5, v211
    v_mul_f32 v6, v6, v211
    v_mul_f32 v7, v7, v211
    v_mul_f32 v16, v16, v211
    v_mul_f32 v17, v17, v211
    v_mul_f32 v18, v18, v211
    v_mul_f32 v19, v19, v211
    v_mul_f32 v28, v28, v211
    v_mul_f32 v29, v29, v211
    v_mul_f32 v30, v30, v211
    v_mul_f32 v31, v31, v211
    v_mul_f32 v40, v40, v211
    v_mul_f32 v41, v41, v211
    v_mul_f32 v42, v42, v211
    v_mul_f32 v43, v43, v211
    v_mul_f32 v52, v52, v211
    v_mul_f32 v53, v53, v211
    v_mul_f32 v54, v54, v211
    v_mul_f32 v55, v55, v211
    v_mul_f32 v64, v64, v211
    v_mul_f32 v65, v65, v211
    v_mul_f32 v66, v66, v211
    v_mul_f32 v67, v67, v211
    v_mul_f32 v76, v76, v211
    v_mul_f32 v77, v77, v211
    v_mul_f32 v78, v78, v211
    v_mul_f32 v79, v79, v211
    v_mul_f32 v88, v88, v211
    v_mul_f32 v89, v89, v211
    v_mul_f32 v90, v90, v211
    v_mul_f32 v91, v91, v211
    v_max3_f32 v209, v164, v165, v166
    v_max3_f32 v209, v209, v167, v176
    v_max3_f32 v209, v209, v177, v178
    v_max_f32 v209, v209, v179
    v_mov_b32 v210, v209
    s_nop 1
    v_permlane32_swap_b32 v209, v210
    v_max_f32 v209, v209, v210
    v_mov_b32 v210, v209
    s_nop 1
    v_permlane16_swap_b32 v209, v210
    v_max_f32 v209, v209, v210
    v_max_f32 v209, 0, v209
    v_sub_f32 v211, 0, v209
    v_exp_f32 v211, v211
    v_sub_f32 v152, v152, v209
    v_sub_f32 v153, v153, v209
    v_sub_f32 v154, v154, v209
    v_sub_f32 v155, v155, v209
    v_sub_f32 v164, v164, v209
    v_sub_f32 v165, v165, v209
    v_sub_f32 v166, v166, v209
    v_sub_f32 v167, v167, v209
    v_sub_f32 v176, v176, v209
    v_sub_f32 v177, v177, v209
    v_sub_f32 v178, v178, v209
    v_sub_f32 v179, v179, v209
    v_mul_f32 v206, v206, v211
    v_mul_f32 v8, v8, v211
    v_mul_f32 v9, v9, v211
    v_mul_f32 v10, v10, v211
    v_mul_f32 v11, v11, v211
    v_mul_f32 v20, v20, v211
    v_mul_f32 v21, v21, v211
    v_mul_f32 v22, v22, v211
    v_mul_f32 v23, v23, v211
    v_mul_f32 v32, v32, v211
    v_mul_f32 v33, v33, v211
    v_mul_f32 v34, v34, v211
    v_mul_f32 v35, v35, v211
    v_mul_f32 v44, v44, v211
    v_mul_f32 v45, v45, v211
    v_mul_f32 v46, v46, v211
    v_mul_f32 v47, v47, v211
    v_mul_f32 v56, v56, v211
    v_mul_f32 v57, v57, v211
    v_mul_f32 v58, v58, v211
    v_mul_f32 v59, v59, v211
    v_mul_f32 v68, v68, v211
    v_mul_f32 v69, v69, v211
    v_mul_f32 v70, v70, v211
    v_mul_f32 v71, v71, v211
    v_mul_f32 v80, v80, v211
    v_mul_f32 v81, v81, v211
    v_mul_f32 v82, v82, v211
    v_mul_f32 v83, v83, v211
    v_mul_f32 v92, v92, v211
    v_mul_f32 v93, v93, v211
    v_mul_f32 v94, v94, v211
    v_mul_f32 v95, v95, v211
    v_exp_f32 v210, v156
    v_exp_f32 v211, v157
    v_exp_f32 v212, v158
    v_add_f32 v207, v210, v211
    v_cvt_pk_bf16_f32 v180, v210, v211
    v_exp_f32 v213, v159
    v_exp_f32 v210, v160
    v_add_f32 v207, v207, v212
    v_cvt_pk_bf16_f32 v181, v212, v213
    v_add_f32 v207, v207, v213
    v_exp_f32 v211, v161
    v_exp_f32 v212, v162
    v_add_f32 v208, v210, v211
    v_cvt_pk_bf16_f32 v184, v210, v211
    v_exp_f32 v213, v163
    v_exp_f32 v210, v164
    v_add_f32 v208, v208, v212
    v_cvt_pk_bf16_f32 v185, v212, v213
    v_add_f32 v208, v208, v213
    v_exp_f32 v211, v165
    v_exp_f32 v212, v166
    v_add_f32 v209, v210, v211
    v_cvt_pk_bf16_f32 v188, v210, v211
    v_exp_f32 v213, v167
    v_exp_f32 v210, v168
    v_add_f32 v209, v209, v212
    v_cvt_pk_bf16_f32 v189, v212, v213
    v_add_f32 v209, v209, v213
    v_exp_f32 v211, v169
    v_exp_f32 v212, v170
    v_add_f32 v207, v207, v210
    v_cvt_pk_bf16_f32 v182, v210, v211
    v_add_f32 v207, v207, v211
    v_exp_f32 v213, v171
    v_exp_f32 v210, v172
    v_add_f32 v207, v207, v212
    v_cvt_pk_bf16_f32 v183, v212, v213
    v_add_f32 v207, v207, v213
    v_exp_f32 v211, v173
    v_exp_f32 v212, v174
    v_add_f32 v208, v208, v210
    v_cvt_pk_bf16_f32 v186, v210, v211
    v_add_f32 v208, v208, v211
    v_exp_f32 v213, v175
    v_exp_f32 v210, v176
    v_add_f32 v208, v208, v212
    v_cvt_pk_bf16_f32 v187, v212, v213
    v_add_f32 v208, v208, v213
    v_exp_f32 v211, v177
    v_exp_f32 v212, v178
    v_add_f32 v209, v209, v210
    v_cvt_pk_bf16_f32 v190, v210, v211
    v_add_f32 v209, v209, v211
    v_exp_f32 v213, v179
    v_add_f32 v209, v209, v212
    v_cvt_pk_bf16_f32 v191, v212, v213
    v_add_f32 v209, v209, v213
    s_nop 3
    s_setpc_b64 s[46:47]
L_rare_w3_1:
    s_nop 15
    v_max3_f32 v207, v156, v157, v158
    v_max3_f32 v207, v207, v159, v168
    v_max3_f32 v207, v207, v169, v170
    v_max_f32 v207, v207, v171
    v_mov_b32 v210, v207
    s_nop 1
    v_permlane32_swap_b32 v207, v210
    v_max_f32 v207, v207, v210
    v_mov_b32 v210, v207
    s_nop 1
    v_permlane16_swap_b32 v207, v210
    v_max_f32 v207, v207, v210
    v_max_f32 v207, 0, v207
    v_sub_f32 v211, 0, v207
    v_exp_f32 v211, v211
    v_sub_f32 v144, v144, v207
    v_sub_f32 v145, v145, v207
    v_sub_f32 v146, v146, v207
    v_sub_f32 v147, v147, v207
    v_sub_f32 v156, v156, v207
    v_sub_f32 v157, v157, v207
    v_sub_f32 v158, v158, v207
    v_sub_f32 v159, v159, v207
    v_sub_f32 v168, v168, v207
    v_sub_f32 v169, v169, v207
    v_sub_f32 v170, v170, v207
    v_sub_f32 v171, v171, v207
    v_mul_f32 v204, v204, v211
    v_mul_f32 v0, v0, v211
    v_mul_f32 v1, v1, v211
    v_mul_f32 v2, v2, v211
    v_mul_f32 v3, v3, v211
    v_mul_f32 v12, v12, v211
    v_mul_f32 v13, v13, v211
    v_mul_f32 v14, v14, v211
    v_mul_f32 v15, v15, v211
    v_mul_f32 v24, v24, v211
    v_mul_f32 v25, v25, v211
    v_mul_f32 v26, v26, v211
    v_mul_f32 v27, v27, v211
    v_mul_f32 v36, v36, v211
    v_mul_f32 v37, v37, v211
    v_mul_f32 v38, v38, v211
    v_mul_f32 v39, v39, v211
    v_mul_f32 v48, v48, v211
    v_mul_f32 v49, v49, v211
    v_mul_f32 v50, v50, v211
    v_mul_f32 v51, v51, v211
    v_mul_f32 v60, v60, v211
    v_mul_f32 v61, v61, v211
    v_mul_f32 v62, v62, v211
    v_mul_f32 v63, v63, v211
    v_mul_f32 v72, v72, v211
    v_mul_f32 v73, v73, v211
    v_mul_f32 v74, v74, v211
    v_mul_f32 v75, v75, v211
    v_mul_f32 v84, v84, v211
    v_mul_f32 v85, v85, v211
    v_mul_f32 v86, v86, v211
    v_mul_f32 v87, v87, v211
    v_max3_f32 v208, v160, v161, v162
    v_max3_f32 v208, v208, v163, v172
    v_max3_f32 v208, v208, v173, v174
    v_max_f32 v208, v208, v175
    v_mov_b32 v210, v208
    s_nop 1
    v_permlane32_swap_b32 v208, v210
    v_max_f32 v208, v208, v210
    v_mov_b32 v210, v208
    s_nop 1
    v_permlane16_swap_b32 v208, v210
    v_max_f32 v208, v208, v210
    v_max_f32 v208, 0, v208
    v_sub_f32 v211, 0, v208
    v_exp_f32 v211, v211
    v_sub_f32 v148, v148, v208
    v_sub_f32 v149, v149, v208
    v_sub_f32 v150, v150, v208
    v_sub_f32 v151, v151, v208
    v_sub_f32 v160, v160, v208
    v_sub_f32 v161, v161, v208
    v_sub_f32 v162, v162, v208
    v_sub_f32 v163, v163, v208
    v_sub_f32 v172, v172, v208
    v_sub_f32 v173, v173, v208
    v_sub_f32 v174, v174, v208
    v_sub_f32 v175, v175, v208
    v_mul_f32 v205, v205, v211
    v_mul_f32 v4, v4, v211
    v_mul_f32 v5, v5, v211
    v_mul_f32 v6, v6, v211
    v_mul_f32 v7, v7, v211
    v_mul_f32 v16, v16, v211
    v_mul_f32 v17, v17, v211
    v_mul_f32 v18, v18, v211
    v_mul_f32 v19, v19, v211
    v_mul_f32 v28, v28, v211
    v_mul_f32 v29, v29, v211
    v_mul_f32 v30, v30, v211
    v_mul_f32 v31, v31, v211
    v_mul_f32 v40, v40, v211
    v_mul_f32 v41, v41, v211
    v_mul_f32 v42, v42, v211
    v_mul_f32 v43, v43, v211
    v_mul_f32 v52, v52, v211
    v_mul_f32 v53, v53, v211
    v_mul_f32 v54, v54, v211
    v_mul_f32 v55, v55, v211
    v_mul_f32 v64, v64, v211
    v_mul_f32 v65, v65, v211
    v_mul_f32 v66, v66, v211
    v_mul_f32 v67, v67, v211
    v_mul_f32 v76, v76, v211
    v_mul_f32 v77, v77, v211
    v_mul_f32 v78, v78, v211
    v_mul_f32 v79, v79, v211
    v_mul_f32 v88, v88, v211
    v_mul_f32 v89, v89, v211
    v_mul_f32 v90, v90, v211
    v_mul_f32 v91, v91, v211
    v_max3_f32 v209, v164, v165, v166
    v_max3_f32 v209, v209, v167, v176
    v_max3_f32 v209, v209, v177, v178
    v_max_f32 v209, v209, v179
    v_mov_b32 v210, v209
    s_nop 1
    v_permlane32_swap_b32 v209, v210
    v_max_f32 v209, v209, v210
    v_mov_b32 v210, v209
    s_nop 1
    v_permlane16_swap_b32 v209, v210
    v_max_f32 v209, v209, v210
    v_max_f32 v209, 0, v209
    v_sub_f32 v211, 0, v209
    v_exp_f32 v211, v211
    v_sub_f32 v152, v152, v209
    v_sub_f32 v153, v153, v209
    v_sub_f32 v154, v154, v209
    v_sub_f32 v155, v155, v209
    v_sub_f32 v164, v164, v209
    v_sub_f32 v165, v165, v209
    v_sub_f32 v166, v166, v209
    v_sub_f32 v167, v167, v209
    v_sub_f32 v176, v176, v209
    v_sub_f32 v177, v177, v209
    v_sub_f32 v178, v178, v209
    v_sub_f32 v179, v179, v209
    v_mul_f32 v206, v206, v211
    v_mul_f32 v8, v8, v211
    v_mul_f32 v9, v9, v211
    v_mul_f32 v10, v10, v211
    v_mul_f32 v11, v11, v211
    v_mul_f32 v20, v20, v211
    v_mul_f32 v21, v21, v211
    v_mul_f32 v22, v22, v211
    v_mul_f32 v23, v23, v211
    v_mul_f32 v32, v32, v211
    v_mul_f32 v33, v33, v211
    v_mul_f32 v34, v34, v211
    v_mul_f32 v35, v35, v211
    v_mul_f32 v44, v44, v211
    v_mul_f32 v45, v45, v211
    v_mul_f32 v46, v46, v211
    v_mul_f32 v47, v47, v211
    v_mul_f32 v56, v56, v211
    v_mul_f32 v57, v57, v211
    v_mul_f32 v58, v58, v211
    v_mul_f32 v59, v59, v211
    v_mul_f32 v68, v68, v211
    v_mul_f32 v69, v69, v211
    v_mul_f32 v70, v70, v211
    v_mul_f32 v71, v71, v211
    v_mul_f32 v80, v80, v211
    v_mul_f32 v81, v81, v211
    v_mul_f32 v82, v82, v211
    v_mul_f32 v83, v83, v211
    v_mul_f32 v92, v92, v211
    v_mul_f32 v93, v93, v211
    v_mul_f32 v94, v94, v211
    v_mul_f32 v95, v95, v211
    v_exp_f32 v210, v156
    v_exp_f32 v211, v157
    v_exp_f32 v212, v158
    v_add_f32 v207, v210, v211
    v_cvt_pk_bf16_f32 v192, v210, v211
    v_exp_f32 v213, v159
    v_exp_f32 v210, v160
    v_add_f32 v207, v207, v212
    v_cvt_pk_bf16_f32 v193, v212, v213
    v_add_f32 v207, v207, v213
    v_exp_f32 v211, v161
    v_exp_f32 v212, v162
    v_add_f32 v208, v210, v211
    v_cvt_pk_bf16_f32 v196, v210, v211
    v_exp_f32 v213, v163
    v_exp_f32 v210, v164
    v_add_f32 v208, v208, v212
    v_cvt_pk_bf16_f32 v197, v212, v213
    v_add_f32 v208, v208, v213
    v_exp_f32 v211, v165
    v_exp_f32 v212, v166
    v_add_f32 v209, v210, v211
    v_cvt_pk_bf16_f32 v200, v210, v211
    v_exp_f32 v213, v167
    v_exp_f32 v210, v168
    v_add_f32 v209, v209, v212
    v_cvt_pk_bf16_f32 v201, v212, v213
    v_add_f32 v209, v209, v213
    v_exp_f32 v211, v169
    v_exp_f32 v212, v170
    v_add_f32 v207, v207, v210
    v_cvt_pk_bf16_f32 v194, v210, v211
    v_add_f32 v207, v207, v211
    v_exp_f32 v213, v171
    v_exp_f32 v210, v172
    v_add_f32 v207, v207, v212
    v_cvt_pk_bf16_f32 v195, v212, v213
    v_add_f32 v207, v207, v213
    v_exp_f32 v211, v173
    v_exp_f32 v212, v174
    v_add_f32 v208, v208, v210
    v_cvt_pk_bf16_f32 v198, v210, v211
    v_add_f32 v208, v208, v211
    v_exp_f32 v213, v175
    v_exp_f32 v210, v176
    v_add_f32 v208, v208, v212
    v_cvt_pk_bf16_f32 v199, v212, v213
    v_add_f32 v208, v208, v213
    v_exp_f32 v211, v177
    v_exp_f32 v212, v178
    v_add_f32 v209, v209, v210
    v_cvt_pk_bf16_f32 v202, v210, v211
    v_add_f32 v209, v209, v211
    v_exp_f32 v213, v179
    v_add_f32 v209, v209, v212
    v_cvt_pk_bf16_f32 v203, v212, v213
    v_add_f32 v209, v209, v213
    s_nop 3
    s_setpc_b64 s[46:47]
L_slow0:
    buffer_store_dwordx4 v[64:67], v185, s[24:27], s42 offen sc1
    s_branch L_slowb0
L_slow1:
    buffer_store_dwordx4 v[68:71], v185, s[24:27], s42 offen offset:1024 sc1
    s_branch L_slowb1
L_slow2:
    buffer_store_dwordx4 v[72:75], v185, s[24:27], s42 offen sc1
    s_branch L_slowb2
L_slow3:
    buffer_store_dwordx4 v[76:79], v185, s[24:27], s42 offen offset:1024 sc1
    s_branch L_slowb3
L_slow4:
    buffer_store_dwordx4 v[80:83], v185, s[24:27], s42 offen sc1
    s_branch L_slowb4
L_slow5:
    buffer_store_dwordx4 v[84:87], v185, s[24:27], s42 offen offset:1024 sc1
    s_branch L_slowb5
L_slow6:
    buffer_store_dwordx4 v[88:91], v185, s[24:27], s42 offen sc1
    s_branch L_slowb6
L_slow7:
    buffer_store_dwordx4 v[92:95], v185, s[24:27], s42 offen offset:1024 sc1
    s_branch L_slowb7
L_slow8:
    buffer_store_dwordx4 v[96:99], v253, s[24:27], s42 offen sc1
    s_branch L_slowb8
L_slow9:
    buffer_store_dwordx4 v[100:103], v253, s[24:27], s42 offen offset:1024 sc1
    s_branch L_slowb9
L_slow10:
    buffer_store_dwordx4 v[104:107], v253, s[24:27], s42 offen offset:2048 sc1
    s_branch L_slowb10
L_slow11:
    buffer_store_dwordx4 v[108:111], v253, s[24:27], s42 offen sc1
    s_branch L_slowb11
L_slow12:
    buffer_store_dwordx4 v[112:115], v253, s[24:27], s42 offen offset:1024 sc1
    s_branch L_slowb12
L_slow13:
    buffer_store_dwordx4 v[116:119], v253, s[24:27], s42 offen offset:2048 sc1
    s_branch L_slowb13
L_slow14:
    buffer_store_dwordx4 v[120:123], v253, s[24:27], s42 offen sc1
    s_branch L_slowb14
L_slow15:
    buffer_store_dwordx4 v[124:127], v253, s[24:27], s42 offen offset:1024 sc1
    s_branch L_slowb15
L_slow16:
    buffer_store_dwordx4 v[128:131], v253, s[24:27], s42 offen offset:2048 sc1
    s_branch L_slowb16
L_slow17:
    buffer_store_dwordx4 v[132:135], v253, s[24:27], s42 offen sc1
    s_branch L_slowb17
L_slow18:
    buffer_store_dwordx4 v[136:139], v253, s[24:27], s42 offen offset:1024 sc1
    s_branch L_slowb18
L_slow19:
    buffer_store_dwordx4 v[140:143], v253, s[24:27], s42 offen offset:2048 sc1
    s_branch L_slowb19
L_slow20:
    buffer_store_dwordx4 v[100:103], v196, s[24:27], s60 offen sc1
    s_branch L_slowb20
L_slow21:
    buffer_store_dwordx4 v[104:107], v196, s[24:27], s60 offen offset:1024 sc1
    s_branch L_slowb21
L_slow22:
    buffer_store_dwordx4 v[108:111], v196, s[24:27], s60 offen offset:2048 sc1
    s_branch L_slowb22
L_slow23:
    buffer_store_dword v198, v188, s[24:27], s60 offen sc1
    s_branch L_slowb23
L_xl0:
    buffer_load_dwordx4 v[200:203], v196, s[24:27], s61 offen sc1
    buffer_load_dwordx4 v[204:207], v196, s[24:27], s61 offen offset:1024 sc1
    buffer_load_dwordx4 v[208:211], v196, s[24:27], s61 offen offset:2048 sc1
    buffer_load_dwordx4 v[212:215], v196, s[24:27], s61 offen offset:3072 sc1
    s_branch L_xl0_b
L_slow25:
    buffer_store_dwordx4 v[100:103], v196, s[24:27], s60 offen sc1
    s_branch L_slowb25
L_slow26:
    buffer_store_dwordx4 v[104:107], v196, s[24:27], s60 offen offset:1024 sc1
    s_branch L_slowb26
L_slow27:
    buffer_store_dwordx4 v[108:111], v196, s[24:27], s60 offen offset:2048 sc1
    s_branch L_slowb27
L_slow28:
    buffer_store_dwordx4 v[112:115], v196, s[24:27], s60 offen offset:3072 sc1
    s_branch L_slowb28
L_slow29:
    buffer_store_dword v198, v188, s[24:27], s60 offen sc1
    s_branch L_slowb29
L_xl1:
    buffer_load_dwordx4 v[200:203], v196, s[24:27], s61 offen sc1
    buffer_load_dwordx4 v[204:207], v196, s[24:27], s61 offen offset:1024 sc1
    buffer_load_dwordx4 v[208:211], v196, s[24:27], s61 offen offset:2048 sc1
    s_branch L_xl1_b
L_slow31:
    buffer_store_dwordx4 v[100:103], v196, s[24:27], s60 offen sc1
    s_branch L_slowb31
L_slow32:
    buffer_store_dwordx4 v[104:107], v196, s[24:27], s60 offen offset:1024 sc1
    s_branch L_slowb32
L_slow33:
    buffer_store_dwordx4 v[108:111], v196, s[24:27], s60 offen offset:2048 sc1
    s_branch L_slowb33
L_slow34:
    buffer_store_dword v198, v188, s[24:27], s60 offen sc1
    s_branch L_slowb34
L_xl2:
    buffer_load_dwordx4 v[200:203], v196, s[24:27], s61 offen sc1
    buffer_load_dwordx4 v[204:207], v196, s[24:27], s61 offen offset:1024 sc1
    buffer_load_dwordx4 v[208:211], v196, s[24:27], s61 offen offset:2048 sc1
    s_branch L_xl2_b
L_slow36:
    buffer_store_dwordx4 v[100:103], v196, s[24:27], s60 offen sc1
    s_branch L_slowb36
L_slow37:
    buffer_store_dwordx4 v[104:107], v196, s[24:27], s60 offen offset:1024 sc1
    s_branch L_slowb37
L_slow38:
    buffer_store_dwordx4 v[108:111], v196, s[24:27], s60 offen offset:2048 sc1
    s_branch L_slowb38
L_slow39:
    buffer_store_dword v198, v188, s[24:27], s60 offen sc1
    s_branch L_slowb39
L_xl3:
    buffer_load_dwordx4 v[200:203], v196, s[24:27], s61 offen sc1
    buffer_load_dwordx4 v[204:207], v196, s[24:27], s61 offen offset:1024 sc1
    buffer_load_dwordx4 v[208:211], v196, s[24:27], s61 offen offset:2048 sc1
    s_branch L_xl3_b
L_stub0:
    s_call_b64 s[46:47], L_rare_w2_1
    s_branch L_back0
L_stub1:
    s_call_b64 s[46:47], L_rare_w2_0
    s_branch L_back1
L_stub2:
    s_call_b64 s[46:47], L_rare_w2_1
    s_branch L_back2
L_stub3:
    s_call_b64 s[46:47], L_rare_w2_0
    s_branch L_back3
L_stub4:
    s_call_b64 s[46:47], L_rare_w2_1
    s_branch L_back4
L_stub5:
    s_call_b64 s[46:47], L_rare_w2_0
    s_branch L_back5
L_stub6:
    s_call_b64 s[46:47], L_rare_w2_1
    s_branch L_back6
L_stub7:
    s_call_b64 s[46:47], L_rare_w2_0
    s_branch L_back7
L_stub8:
    s_call_b64 s[46:47], L_rare_w2_1
    s_branch L_back8
L_stub9:
    s_call_b64 s[46:47], L_rare_w2_0
    s_branch L_back9
L_stub10:
    s_call_b64 s[46:47], L_rare_w2_1
    s_branch L_back10
L_stub11:
    s_call_b64 s[46:47], L_rare_w2_0
    s_branch L_back11
L_stub12:
    s_call_b64 s[46:47], L_rare_w2_1
    s_branch L_back12
L_stub13:
    s_call_b64 s[46:47], L_rare_w2_0
    s_branch L_back13
L_stub14:
    s_call_b64 s[46:47], L_rare_w2_1
    s_branch L_back14
L_stub15:
    s_call_b64 s[46:47], L_rare_w3_1
    s_branch L_back15
L_stub16:
    s_call_b64 s[46:47], L_rare_w3_0
    s_branch L_back16
L_stub17:
    s_call_b64 s[46:47], L_rare_w3_1
    s_branch L_back17
.section .rodata,"a"
.p2align 6
.amdhsa_kernel standalone__mha_block_cached__near_ridge_kernel
  .amdhsa_next_free_vgpr 256
  .amdhsa_next_free_sgpr 102
  .amdhsa_accum_offset 256
  .amdhsa_group_segment_fixed_size 0
  .amdhsa_kernarg_size 64
  .amdhsa_user_sgpr_count 2
  .amdhsa_user_sgpr_kernarg_segment_ptr 1
  .amdhsa_system_sgpr_workgroup_id_x 1
.end_amdhsa_kernel
```
